```python
import torch

def _softmax(x, axis=-1):
    return torch.softmax(x, dim=axis)

def _gelu(x):
    return torch.nn.functional.gelu(x, approximate='tanh')

def _silu(x):
    return torch.nn.functional.silu(x)

def _sigmoid(x):
    return torch.sigmoid(x)

def _layernorm(x, axis=-1, eps=1e-05):
    m = x.mean(dim=axis, keepdim=True)
    v = x.var(dim=axis, keepdim=True, unbiased=False)
    return (x - m) / torch.sqrt(v + eps)

def _scatter_add(tgt, idx, src, axis=0):
    return tgt.clone().index_add_(axis, idx, src)

def _segment_sum(src, seg, n):
    out = torch.zeros((n,) + src.shape[1:], dtype=src.dtype)
    return out.index_add_(0, seg, src)

def _pad(x, pw):
    flat = tuple((v for pair in reversed(pw) for v in pair))
    return torch.nn.functional.pad(x, flat)
kernel_name = 'sequential_preLN__memory_aug_recurrent_mem_tr__swiglu_ffn__prompt'

def setup_inputs():

    _w = lambda a: (lambda t: t.to(torch.bfloat16) if t.is_floating_point() else t)(torch.as_tensor(a))

    def _A_setup():
        B, S, Dm = (1, 2048, 448)
        H, Dh = (16, 256)
        M, seg = (8, 32)
        seg = min(seg, S)
        S = S // seg * seg
        return {'x': _w((lambda *s: torch.randn(*s, dtype=torch.bfloat16) * 0.05)(B, S, Dm)), 'mem0': _w((lambda *s: torch.randn(*s, dtype=torch.bfloat16) * 0.2)(B, M, Dm)), 'Wq': _w((lambda *s: torch.randn(*s, dtype=torch.bfloat16) * 1.6)(Dm, H, Dh) * Dm ** (-0.5)), 'Wk': _w((lambda *s: torch.randn(*s, dtype=torch.bfloat16) * 1.6)(Dm, H, Dh) * Dm ** (-0.5)), 'Wv': _w((lambda *s: torch.randn(*s, dtype=torch.bfloat16) * 0.2)(Dm, H, Dh) * Dm ** (-0.5)), 'Wo': _w((lambda *s: torch.randn(*s, dtype=torch.bfloat16) * 0.2)(H, Dh, Dm) * (H * Dh) ** (-0.5)), 'seg_len': seg}
    _A_in = _A_setup()

    def _B_setup():
        B, S, D, F = (1, 2048, 448, 1792)
        return {'x': _w((lambda *s: torch.randn(*s, dtype=torch.bfloat16) * 0.05)(B, S, D)), 'w_gate': _w((lambda *s: torch.randn(*s, dtype=torch.bfloat16) * 0.05)(D, F)), 'w_up': _w((lambda *s: torch.randn(*s, dtype=torch.bfloat16) * 0.05)(D, F)), 'w_down': _w((lambda *s: torch.randn(*s, dtype=torch.bfloat16) * 0.05)(F, D))}
    _B_in = _B_setup()
    return {'A_x': _A_in['x'], 'A_mem0': _A_in['mem0'], 'A_Wq': _A_in['Wq'], 'A_Wk': _A_in['Wk'], 'A_Wv': _A_in['Wv'], 'A_Wo': _A_in['Wo'], 'A_seg_len': _A_in['seg_len'], 'B_x': _B_in['x'], 'B_w_gate': _B_in['w_gate'], 'B_w_up': _B_in['w_up'], 'B_w_down': _B_in['w_down']}

def reference(A_x, A_mem0, A_Wq, A_Wk, A_Wv, A_Wo, A_seg_len, B_x, B_w_gate, B_w_up, B_w_down):

    def _A_ref(x, mem0, Wq, Wk, Wv, Wo, seg_len):
        B, S, Dm = x.shape
        H, Dh = (Wq.shape[1], Wq.shape[2])
        M = mem0.shape[1]
        scale = Dh ** (-0.5)
        n_seg = S // seg_len
        L = M + seg_len
        idx = torch.arange(L)
        mask = (idx[:, None] < M) | (idx[:, None] >= idx[None, :])
        mem = mem0
        outs = []
        for s in range(n_seg):
            xs = x[:, s * seg_len:(s + 1) * seg_len, :].clone()
            h = torch.concatenate([mem, xs], axis=1)
            q = torch.einsum('btd,dhe->bhte', h, Wq)
            k = torch.einsum('btd,dhe->bhte', h, Wk)
            v = torch.einsum('btd,dhe->bhte', h, Wv)
            scores = torch.einsum('bhqe,bhke->bhqk', q, k) * scale
            scores = torch.where(mask[None, None], scores, -1000000000.0)
            p = _softmax(scores, axis=-1)
            o = torch.einsum('bhqk,bhke->bhqe', p, v)
            o = torch.einsum('bhte,hed->btd', o, Wo)
            mem = o[:, :M, :].clone()
            outs.append(o[:, M:, :])
        return torch.concatenate(outs, axis=1)

    def _B_ref(x, w_gate, w_up, w_down):
        g = _silu(x @ w_gate)
        u = x @ w_up
        return g * u @ w_down
    x = A_x
    h = x + _A_ref(_layernorm(x, axis=-1), A_mem0, A_Wq, A_Wk, A_Wv, A_Wo, A_seg_len)
    h2 = h + _B_ref(_layernorm(h, axis=-1), B_w_gate, B_w_up, B_w_down)
    return h2
```

```asm
; @launch grid=(256,1,1) block=(256,1,1) lds=163840
.amdgcn_target "amdgcn-amd-amdhsa--gfx950"
.text
.globl sequential_preLN__memory_aug_recurrent_mem_tr__swiglu_ffn__prompt_kernel
.p2align 8
.type sequential_preLN__memory_aug_recurrent_mem_tr__swiglu_ffn__prompt_kernel,@function
sequential_preLN__memory_aug_recurrent_mem_tr__swiglu_ffn__prompt_kernel:
    s_cmp_ge_u32 s2, 256
    s_cbranch_scc1 L_exit0
    s_load_dwordx8 s[60:67], s[0:1], 16
    s_load_dwordx2 s[8:9], s[0:1], 104
    s_load_dwordx2 s[20:21], s[0:1], 0
    s_load_dwordx2 s[24:25], s[0:1], 88
    s_load_dwordx2 s[92:93], s[0:1], 96
    s_load_dwordx2 s[56:57], s[0:1], 8
    s_getreg_b32 s79, hwreg(HW_REG_XCC_ID, 0, 4)
    v_lshrrev_b32 v1, 6, v0
    s_nop 0
    v_readfirstlane_b32 s3, v1
    v_and_b32 v0, 63, v0
    s_mov_b32 s10, 268435456
    s_mov_b32 s11, 0x20000
    s_mov_b32 s22, 1835008
    s_mov_b32 s23, 0x20000
    s_mov_b32 s26, 1835008
    s_mov_b32 s27, 0x20000
    s_mov_b32 s94, 256
    s_mov_b32 s95, 0x20000
    s_mov_b32 s58, 7168
    s_mov_b32 s59, 0x20000
    s_mov_b32 s76, 4000000
    s_and_b32 s79, s79, 7
    s_waitcnt lgkmcnt(0)
    s_cmp_eq_u32 s3, 0
    s_cbranch_scc0 P_not
    s_lshl_b32 s29, s79, 5
    v_mov_b32 v6, 0
    v_mov_b32 v7, 1
    v_accvgpr_write_b32 a250, v7
    s_mov_b64 exec, 1
    buffer_atomic_add a250, v6, s[92:95], s29 offen sc0 sc1
    s_mov_b64 exec, -1
P_not:
    s_and_b32 s28, s2, 7
    s_lshr_b32 s29, s2, 3
    s_cmp_eq_u32 s28, 0
    s_cbranch_scc1 P_ln
    s_sub_u32 s28, s28, 1
    s_lshl_b32 s28, s28, 5
    s_add_u32 s28, s28, s29
    s_mul_hi_u32 s30, s28, 613566757
    s_mul_i32 s31, s30, 7
    s_sub_u32 s31, s28, s31
    s_lshl_b32 s78, s30, 4
    s_add_u32 s78, s78, 0
    s_cmp_ge_u32 s30, 16
    s_cbranch_scc1 P_B
    s_mov_b32 s12, s60
    s_mov_b32 s13, s61
    s_mov_b32 s16, s62
    s_mov_b32 s17, s63
    s_mov_b32 s14, 3670016
    s_mov_b32 s15, 0x20000
    s_mov_b32 s18, 3670016
    s_mov_b32 s19, 0x20000
    v_and_b32 v6, 15, v0
    v_lshrrev_b32 v7, 4, v0
    v_lshlrev_b32 v3, 4, v0
    v_lshrrev_b32 v8, 5, v0
    v_and_b32 v9, 31, v0
    s_lshl_b32 s33, s30, 9
    v_add_u32 v10, 0, v8
    v_xor_b32 v11, v9, v10
    v_lshlrev_b32 v11, 4, v11
    v_lshl_add_u32 v11, v10, 13, v11
    v_add_u32 v40, s33, v11
    v_add_u32 v10, 2, v8
    v_xor_b32 v11, v9, v10
    v_lshlrev_b32 v11, 4, v11
    v_lshl_add_u32 v11, v10, 13, v11
    v_add_u32 v41, s33, v11
    v_add_u32 v10, 4, v8
    v_xor_b32 v11, v9, v10
    v_lshlrev_b32 v11, 4, v11
    v_lshl_add_u32 v11, v10, 13, v11
    v_add_u32 v42, s33, v11
    v_add_u32 v10, 6, v8
    v_xor_b32 v11, v9, v10
    v_lshlrev_b32 v11, 4, v11
    v_lshl_add_u32 v11, v10, 13, v11
    v_add_u32 v43, s33, v11
    v_add_u32 v10, 8, v8
    v_xor_b32 v11, v9, v10
    v_lshlrev_b32 v11, 4, v11
    v_lshl_add_u32 v11, v10, 13, v11
    v_add_u32 v44, s33, v11
    v_add_u32 v10, 10, v8
    v_xor_b32 v11, v9, v10
    v_lshlrev_b32 v11, 4, v11
    v_lshl_add_u32 v11, v10, 13, v11
    v_add_u32 v45, s33, v11
    v_add_u32 v10, 12, v8
    v_xor_b32 v11, v9, v10
    v_lshlrev_b32 v11, 4, v11
    v_lshl_add_u32 v11, v10, 13, v11
    v_add_u32 v46, s33, v11
    v_add_u32 v10, 14, v8
    v_xor_b32 v11, v9, v10
    v_lshlrev_b32 v11, 4, v11
    v_lshl_add_u32 v11, v10, 13, v11
    v_add_u32 v47, s33, v11
    s_lshl_b32 s32, s31, 6
    s_lshl_b32 s34, s3, 4
    s_add_u32 s32, s32, s34
    s_lshl_b32 s32, s32, 13
    s_lshl_b32 s35, s3, 13
    s_add_u32 m0, s35, 0
    s_nop 0
    buffer_load_dwordx4 v40, s[12:15], s32 offen lds
    s_add_u32 m0, s35, 1024
    s_nop 0
    buffer_load_dwordx4 v41, s[12:15], s32 offen lds
    s_add_u32 m0, s35, 2048
    s_nop 0
    buffer_load_dwordx4 v42, s[12:15], s32 offen lds
    s_add_u32 m0, s35, 3072
    s_nop 0
    buffer_load_dwordx4 v43, s[12:15], s32 offen lds
    s_add_u32 m0, s35, 4096
    s_nop 0
    buffer_load_dwordx4 v44, s[12:15], s32 offen lds
    s_add_u32 m0, s35, 5120
    s_nop 0
    buffer_load_dwordx4 v45, s[12:15], s32 offen lds
    s_add_u32 m0, s35, 6144
    s_nop 0
    buffer_load_dwordx4 v46, s[12:15], s32 offen lds
    s_add_u32 m0, s35, 7168
    s_nop 0
    buffer_load_dwordx4 v47, s[12:15], s32 offen lds
    s_mul_i32 s36, s30, 28
    s_mul_i32 s37, s3, 7
    s_add_u32 s36, s36, s37
    s_mul_i32 s36, s36, 14
    s_lshl_b32 s37, s31, 1
    s_add_u32 s36, s36, s37
    s_lshl_b32 s36, s36, 10
    s_add_u32 s36, s36, 5242880
    s_mov_b32 s38, 1035512379
    s_mul_i32 s39, s3, 917504
    s_mul_i32 s40, s3, 32768
    s_add_u32 s40, s40, 32768
    s_add_u32 s41, s39, 0
    s_add_u32 m0, s40, 0
    s_nop 0
    buffer_load_dwordx4 v40, s[16:19], s41 offen lds
    s_add_u32 m0, s40, 1024
    s_nop 0
    buffer_load_dwordx4 v41, s[16:19], s41 offen lds
    s_add_u32 m0, s40, 2048
    s_nop 0
    buffer_load_dwordx4 v42, s[16:19], s41 offen lds
    s_add_u32 m0, s40, 3072
    s_nop 0
    buffer_load_dwordx4 v43, s[16:19], s41 offen lds
    s_add_u32 m0, s40, 4096
    s_nop 0
    buffer_load_dwordx4 v44, s[16:19], s41 offen lds
    s_add_u32 m0, s40, 5120
    s_nop 0
    buffer_load_dwordx4 v45, s[16:19], s41 offen lds
    s_add_u32 m0, s40, 6144
    s_nop 0
    buffer_load_dwordx4 v46, s[16:19], s41 offen lds
    s_add_u32 m0, s40, 7168
    s_nop 0
    buffer_load_dwordx4 v47, s[16:19], s41 offen lds
    s_add_u32 s41, s39, 131072
    s_add_u32 m0, s40, 8192
    s_nop 0
    buffer_load_dwordx4 v40, s[16:19], s41 offen lds
    s_add_u32 m0, s40, 9216
    s_nop 0
    buffer_load_dwordx4 v41, s[16:19], s41 offen lds
    s_add_u32 m0, s40, 10240
    s_nop 0
    buffer_load_dwordx4 v42, s[16:19], s41 offen lds
    s_add_u32 m0, s40, 11264
    s_nop 0
    buffer_load_dwordx4 v43, s[16:19], s41 offen lds
    s_add_u32 m0, s40, 12288
    s_nop 0
    buffer_load_dwordx4 v44, s[16:19], s41 offen lds
    s_add_u32 m0, s40, 13312
    s_nop 0
    buffer_load_dwordx4 v45, s[16:19], s41 offen lds
    s_add_u32 m0, s40, 14336
    s_nop 0
    buffer_load_dwordx4 v46, s[16:19], s41 offen lds
    s_add_u32 m0, s40, 15360
    s_nop 0
    buffer_load_dwordx4 v47, s[16:19], s41 offen lds
    s_add_u32 s41, s39, 262144
    s_add_u32 m0, s40, 16384
    s_nop 0
    buffer_load_dwordx4 v40, s[16:19], s41 offen lds
    s_add_u32 m0, s40, 17408
    s_nop 0
    buffer_load_dwordx4 v41, s[16:19], s41 offen lds
    s_add_u32 m0, s40, 18432
    s_nop 0
    buffer_load_dwordx4 v42, s[16:19], s41 offen lds
    s_add_u32 m0, s40, 19456
    s_nop 0
    buffer_load_dwordx4 v43, s[16:19], s41 offen lds
    s_add_u32 m0, s40, 20480
    s_nop 0
    buffer_load_dwordx4 v44, s[16:19], s41 offen lds
    s_add_u32 m0, s40, 21504
    s_nop 0
    buffer_load_dwordx4 v45, s[16:19], s41 offen lds
    s_add_u32 m0, s40, 22528
    s_nop 0
    buffer_load_dwordx4 v46, s[16:19], s41 offen lds
    s_add_u32 m0, s40, 23552
    s_nop 0
    buffer_load_dwordx4 v47, s[16:19], s41 offen lds
    s_add_u32 s41, s39, 393216
    s_add_u32 m0, s40, 24576
    s_nop 0
    buffer_load_dwordx4 v40, s[16:19], s41 offen lds
    s_add_u32 m0, s40, 25600
    s_nop 0
    buffer_load_dwordx4 v41, s[16:19], s41 offen lds
    s_add_u32 m0, s40, 26624
    s_nop 0
    buffer_load_dwordx4 v42, s[16:19], s41 offen lds
    s_add_u32 m0, s40, 27648
    s_nop 0
    buffer_load_dwordx4 v43, s[16:19], s41 offen lds
    s_add_u32 m0, s40, 28672
    s_nop 0
    buffer_load_dwordx4 v44, s[16:19], s41 offen lds
    s_add_u32 m0, s40, 29696
    s_nop 0
    buffer_load_dwordx4 v45, s[16:19], s41 offen lds
    s_add_u32 m0, s40, 30720
    s_nop 0
    buffer_load_dwordx4 v46, s[16:19], s41 offen lds
    s_add_u32 m0, s40, 31744
    s_nop 0
    buffer_load_dwordx4 v47, s[16:19], s41 offen lds
    v_lshrrev_b32 v10, 2, v0
    v_lshlrev_b32 v10, 13, v10
    v_and_b32 v11, 3, v0
    v_lshl_add_u32 v10, v11, 7, v10
    v_add_u32 v10, s33, v10
    v_add_u32 v10, 0, v7
    v_xor_b32 v10, v10, v6
    v_lshlrev_b32 v10, 4, v10
    v_lshl_add_u32 v48, v6, 9, v10
    v_add_u32 v10, 4, v7
    v_xor_b32 v10, v10, v6
    v_lshlrev_b32 v10, 4, v10
    v_lshl_add_u32 v49, v6, 9, v10
    v_add_u32 v10, 8, v7
    v_xor_b32 v10, v10, v6
    v_lshlrev_b32 v10, 4, v10
    v_lshl_add_u32 v50, v6, 9, v10
    v_add_u32 v10, 12, v7
    v_xor_b32 v10, v10, v6
    v_lshlrev_b32 v10, 4, v10
    v_lshl_add_u32 v51, v6, 9, v10
    v_add_u32 v10, 16, v7
    v_xor_b32 v10, v10, v6
    v_lshlrev_b32 v10, 4, v10
    v_lshl_add_u32 v52, v6, 9, v10
    v_add_u32 v10, 20, v7
    v_xor_b32 v10, v10, v6
    v_lshlrev_b32 v10, 4, v10
    v_lshl_add_u32 v53, v6, 9, v10
    v_add_u32 v10, 24, v7
    v_xor_b32 v10, v10, v6
    v_lshlrev_b32 v10, 4, v10
    v_lshl_add_u32 v54, v6, 9, v10
    v_add_u32 v10, 28, v7
    v_xor_b32 v10, v10, v6
    v_lshlrev_b32 v10, 4, v10
    v_lshl_add_u32 v55, v6, 9, v10
    s_waitcnt vmcnt(32)
    s_barrier
    v_mov_b32 v136, 0
    buffer_load_dword a252, v136, s[92:95], 0 offen offset:16 sc1
    s_lshl_b32 s44, s30, 2
    s_add_u32 s44, s44, s3
    s_lshl_b32 s44, s44, 8
    s_lshl_b32 s45, s31, 2
    s_add_u32 s44, s44, s45
    s_add_u32 s44, s44, 40960
    v_mov_b32 v137, 1
    ds_read_b128 a[0:3], v48 offset:0
    ds_read_b128 a[4:7], v49 offset:0
    ds_read_b128 a[8:11], v50 offset:0
    ds_read_b128 a[12:15], v51 offset:0
    ds_read_b128 a[16:19], v52 offset:0
    ds_read_b128 a[20:23], v53 offset:0
    ds_read_b128 a[24:27], v54 offset:0
    ds_read_b128 a[28:31], v55 offset:0
    ds_read_b128 a[32:35], v48 offset:8192
    ds_read_b128 a[36:39], v49 offset:8192
    ds_read_b128 a[40:43], v50 offset:8192
    ds_read_b128 a[44:47], v51 offset:8192
    ds_read_b128 a[48:51], v52 offset:8192
    ds_read_b128 a[52:55], v53 offset:8192
    ds_read_b128 a[56:59], v54 offset:8192
    ds_read_b128 a[60:63], v55 offset:8192
    ds_read_b128 a[64:67], v48 offset:16384
    ds_read_b128 a[68:71], v49 offset:16384
    ds_read_b128 a[72:75], v50 offset:16384
    ds_read_b128 a[76:79], v51 offset:16384
    ds_read_b128 a[80:83], v52 offset:16384
    ds_read_b128 a[84:87], v53 offset:16384
    ds_read_b128 a[88:91], v54 offset:16384
    ds_read_b128 a[92:95], v55 offset:16384
    ds_read_b128 a[96:99], v48 offset:24576
    ds_read_b128 a[100:103], v49 offset:24576
    ds_read_b128 a[104:107], v50 offset:24576
    ds_read_b128 a[108:111], v51 offset:24576
    ds_read_b128 a[112:115], v52 offset:24576
    ds_read_b128 a[116:119], v53 offset:24576
    ds_read_b128 a[120:123], v54 offset:24576
    ds_read_b128 a[124:127], v55 offset:24576
    v_add_u32 v56, s40, v48
    v_add_u32 v57, s40, v49
    v_add_u32 v58, s40, v50
    v_add_u32 v59, s40, v51
    v_add_u32 v60, s40, v52
    v_add_u32 v61, s40, v53
    v_add_u32 v62, s40, v54
    v_add_u32 v63, s40, v55
    s_waitcnt lgkmcnt(0)
    v_mov_b32 v12, s38
    v_mov_b32 v13, s38
    s_waitcnt vmcnt(25)
    ds_read_b128 v[64:67], v56 offset:0
    ds_read_b128 v[68:71], v57 offset:0
    ds_read_b128 v[72:75], v58 offset:0
    ds_read_b128 v[76:79], v59 offset:0
    ds_read_b128 v[80:83], v60 offset:0
    ds_read_b128 v[84:87], v61 offset:0
    ds_read_b128 v[88:91], v62 offset:0
    ds_read_b128 v[92:95], v63 offset:0
    s_waitcnt lgkmcnt(7)
    v_mfma_f32_16x16x32_bf16 v[96:99], a[0:3], v[64:67], 0
    v_mfma_f32_16x16x32_bf16 v[100:103], a[32:35], v[64:67], 0
    v_mfma_f32_16x16x32_bf16 v[104:107], a[64:67], v[64:67], 0
    v_mfma_f32_16x16x32_bf16 v[108:111], a[96:99], v[64:67], 0
    s_waitcnt lgkmcnt(6)
    v_mfma_f32_16x16x32_bf16 v[96:99], a[4:7], v[68:71], v[96:99]
    v_mfma_f32_16x16x32_bf16 v[100:103], a[36:39], v[68:71], v[100:103]
    v_mfma_f32_16x16x32_bf16 v[104:107], a[68:71], v[68:71], v[104:107]
    v_mfma_f32_16x16x32_bf16 v[108:111], a[100:103], v[68:71], v[108:111]
    s_waitcnt lgkmcnt(5)
    v_mfma_f32_16x16x32_bf16 v[96:99], a[8:11], v[72:75], v[96:99]
    v_mfma_f32_16x16x32_bf16 v[100:103], a[40:43], v[72:75], v[100:103]
    v_mfma_f32_16x16x32_bf16 v[104:107], a[72:75], v[72:75], v[104:107]
    v_mfma_f32_16x16x32_bf16 v[108:111], a[104:107], v[72:75], v[108:111]
    s_waitcnt lgkmcnt(4)
    v_mfma_f32_16x16x32_bf16 v[96:99], a[12:15], v[76:79], v[96:99]
    v_mfma_f32_16x16x32_bf16 v[100:103], a[44:47], v[76:79], v[100:103]
    v_mfma_f32_16x16x32_bf16 v[104:107], a[76:79], v[76:79], v[104:107]
    v_mfma_f32_16x16x32_bf16 v[108:111], a[108:111], v[76:79], v[108:111]
    s_waitcnt lgkmcnt(3)
    v_mfma_f32_16x16x32_bf16 v[96:99], a[16:19], v[80:83], v[96:99]
    v_mfma_f32_16x16x32_bf16 v[100:103], a[48:51], v[80:83], v[100:103]
    v_mfma_f32_16x16x32_bf16 v[104:107], a[80:83], v[80:83], v[104:107]
    v_mfma_f32_16x16x32_bf16 v[108:111], a[112:115], v[80:83], v[108:111]
    s_waitcnt lgkmcnt(2)
    v_mfma_f32_16x16x32_bf16 v[96:99], a[20:23], v[84:87], v[96:99]
    v_mfma_f32_16x16x32_bf16 v[100:103], a[52:55], v[84:87], v[100:103]
    v_mfma_f32_16x16x32_bf16 v[104:107], a[84:87], v[84:87], v[104:107]
    v_mfma_f32_16x16x32_bf16 v[108:111], a[116:119], v[84:87], v[108:111]
    s_waitcnt lgkmcnt(1)
    v_mfma_f32_16x16x32_bf16 v[96:99], a[24:27], v[88:91], v[96:99]
    v_mfma_f32_16x16x32_bf16 v[100:103], a[56:59], v[88:91], v[100:103]
    v_mfma_f32_16x16x32_bf16 v[104:107], a[88:91], v[88:91], v[104:107]
    v_mfma_f32_16x16x32_bf16 v[108:111], a[120:123], v[88:91], v[108:111]
    s_waitcnt lgkmcnt(0)
    v_mfma_f32_16x16x32_bf16 v[96:99], a[28:31], v[92:95], v[96:99]
    v_mfma_f32_16x16x32_bf16 v[100:103], a[60:63], v[92:95], v[100:103]
    v_mfma_f32_16x16x32_bf16 v[104:107], a[92:95], v[92:95], v[104:107]
    v_mfma_f32_16x16x32_bf16 v[108:111], a[124:127], v[92:95], v[108:111]
    s_add_u32 s41, s39, 524288
    s_add_u32 m0, s40, 0
    s_nop 0
    buffer_load_dwordx4 v40, s[16:19], s41 offen lds
    s_add_u32 m0, s40, 1024
    s_nop 0
    buffer_load_dwordx4 v41, s[16:19], s41 offen lds
    s_add_u32 m0, s40, 2048
    s_nop 0
    buffer_load_dwordx4 v42, s[16:19], s41 offen lds
    s_add_u32 m0, s40, 3072
    s_nop 0
    buffer_load_dwordx4 v43, s[16:19], s41 offen lds
    s_add_u32 m0, s40, 4096
    s_nop 0
    buffer_load_dwordx4 v44, s[16:19], s41 offen lds
    s_add_u32 m0, s40, 5120
    s_nop 0
    buffer_load_dwordx4 v45, s[16:19], s41 offen lds
    s_add_u32 m0, s40, 6144
    s_nop 0
    buffer_load_dwordx4 v46, s[16:19], s41 offen lds
    s_add_u32 m0, s40, 7168
    s_nop 0
    buffer_load_dwordx4 v47, s[16:19], s41 offen lds
    s_waitcnt vmcnt(25)
    ds_read_b128 v[64:67], v56 offset:8192
    ds_read_b128 v[68:71], v57 offset:8192
    ds_read_b128 v[72:75], v58 offset:8192
    ds_read_b128 v[76:79], v59 offset:8192
    ds_read_b128 v[80:83], v60 offset:8192
    ds_read_b128 v[84:87], v61 offset:8192
    ds_read_b128 v[88:91], v62 offset:8192
    ds_read_b128 v[92:95], v63 offset:8192
    s_waitcnt lgkmcnt(7)
    v_mfma_f32_16x16x32_bf16 v[112:115], a[0:3], v[64:67], 0
    v_mfma_f32_16x16x32_bf16 v[116:119], a[32:35], v[64:67], 0
    v_mfma_f32_16x16x32_bf16 v[120:123], a[64:67], v[64:67], 0
    v_mfma_f32_16x16x32_bf16 v[124:127], a[96:99], v[64:67], 0
    s_waitcnt lgkmcnt(6)
    v_mfma_f32_16x16x32_bf16 v[112:115], a[4:7], v[68:71], v[112:115]
    v_mfma_f32_16x16x32_bf16 v[116:119], a[36:39], v[68:71], v[116:119]
    v_mfma_f32_16x16x32_bf16 v[120:123], a[68:71], v[68:71], v[120:123]
    v_mfma_f32_16x16x32_bf16 v[124:127], a[100:103], v[68:71], v[124:127]
    v_pk_mul_f32 v[96:97], v[96:97], v[12:13]
    v_pk_mul_f32 v[98:99], v[98:99], v[12:13]
    v_pk_mul_f32 v[100:101], v[100:101], v[12:13]
    v_pk_mul_f32 v[102:103], v[102:103], v[12:13]
    v_pk_mul_f32 v[104:105], v[104:105], v[12:13]
    v_pk_mul_f32 v[106:107], v[106:107], v[12:13]
    v_pk_mul_f32 v[108:109], v[108:109], v[12:13]
    v_pk_mul_f32 v[110:111], v[110:111], v[12:13]
    v_cvt_pk_bf16_f32 v16, v96, v97
    v_cvt_pk_bf16_f32 v17, v98, v99
    v_cvt_pk_bf16_f32 v18, v100, v101
    v_cvt_pk_bf16_f32 v19, v102, v103
    v_cvt_pk_bf16_f32 v20, v104, v105
    v_cvt_pk_bf16_f32 v21, v106, v107
    v_cvt_pk_bf16_f32 v22, v108, v109
    v_cvt_pk_bf16_f32 v23, v110, v111
    s_add_u32 s37, s36, 0
    buffer_store_dwordx4 v[16:19], v3, s[8:11], s37 offen sc1
    buffer_store_dwordx4 v[20:23], v3, s[8:11], s37 offen offset:1024 sc1
    s_waitcnt lgkmcnt(5)
    v_mfma_f32_16x16x32_bf16 v[112:115], a[8:11], v[72:75], v[112:115]
    v_mfma_f32_16x16x32_bf16 v[116:119], a[40:43], v[72:75], v[116:119]
    v_mfma_f32_16x16x32_bf16 v[120:123], a[72:75], v[72:75], v[120:123]
    v_mfma_f32_16x16x32_bf16 v[124:127], a[104:107], v[72:75], v[124:127]
    s_waitcnt lgkmcnt(4)
    v_mfma_f32_16x16x32_bf16 v[112:115], a[12:15], v[76:79], v[112:115]
    v_mfma_f32_16x16x32_bf16 v[116:119], a[44:47], v[76:79], v[116:119]
    v_mfma_f32_16x16x32_bf16 v[120:123], a[76:79], v[76:79], v[120:123]
    v_mfma_f32_16x16x32_bf16 v[124:127], a[108:111], v[76:79], v[124:127]
    s_waitcnt lgkmcnt(3)
    v_mfma_f32_16x16x32_bf16 v[112:115], a[16:19], v[80:83], v[112:115]
    v_mfma_f32_16x16x32_bf16 v[116:119], a[48:51], v[80:83], v[116:119]
    v_mfma_f32_16x16x32_bf16 v[120:123], a[80:83], v[80:83], v[120:123]
    v_mfma_f32_16x16x32_bf16 v[124:127], a[112:115], v[80:83], v[124:127]
    s_waitcnt lgkmcnt(2)
    v_mfma_f32_16x16x32_bf16 v[112:115], a[20:23], v[84:87], v[112:115]
    v_mfma_f32_16x16x32_bf16 v[116:119], a[52:55], v[84:87], v[116:119]
    v_mfma_f32_16x16x32_bf16 v[120:123], a[84:87], v[84:87], v[120:123]
    v_mfma_f32_16x16x32_bf16 v[124:127], a[116:119], v[84:87], v[124:127]
    s_waitcnt lgkmcnt(1)
    v_mfma_f32_16x16x32_bf16 v[112:115], a[24:27], v[88:91], v[112:115]
    v_mfma_f32_16x16x32_bf16 v[116:119], a[56:59], v[88:91], v[116:119]
    v_mfma_f32_16x16x32_bf16 v[120:123], a[88:91], v[88:91], v[120:123]
    v_mfma_f32_16x16x32_bf16 v[124:127], a[120:123], v[88:91], v[124:127]
    s_waitcnt lgkmcnt(0)
    v_mfma_f32_16x16x32_bf16 v[112:115], a[28:31], v[92:95], v[112:115]
    v_mfma_f32_16x16x32_bf16 v[116:119], a[60:63], v[92:95], v[116:119]
    v_mfma_f32_16x16x32_bf16 v[120:123], a[92:95], v[92:95], v[120:123]
    v_mfma_f32_16x16x32_bf16 v[124:127], a[124:127], v[92:95], v[124:127]
    s_add_u32 s41, s39, 655360
    s_add_u32 m0, s40, 8192
    s_nop 0
    buffer_load_dwordx4 v40, s[16:19], s41 offen lds
    s_add_u32 m0, s40, 9216
    s_nop 0
    buffer_load_dwordx4 v41, s[16:19], s41 offen lds
    s_add_u32 m0, s40, 10240
    s_nop 0
    buffer_load_dwordx4 v42, s[16:19], s41 offen lds
    s_add_u32 m0, s40, 11264
    s_nop 0
    buffer_load_dwordx4 v43, s[16:19], s41 offen lds
    s_add_u32 m0, s40, 12288
    s_nop 0
    buffer_load_dwordx4 v44, s[16:19], s41 offen lds
    s_add_u32 m0, s40, 13312
    s_nop 0
    buffer_load_dwordx4 v45, s[16:19], s41 offen lds
    s_add_u32 m0, s40, 14336
    s_nop 0
    buffer_load_dwordx4 v46, s[16:19], s41 offen lds
    s_add_u32 m0, s40, 15360
    s_nop 0
    buffer_load_dwordx4 v47, s[16:19], s41 offen lds
    s_waitcnt vmcnt(27)
    ds_read_b128 v[64:67], v56 offset:16384
    ds_read_b128 v[68:71], v57 offset:16384
    ds_read_b128 v[72:75], v58 offset:16384
    ds_read_b128 v[76:79], v59 offset:16384
    ds_read_b128 v[80:83], v60 offset:16384
    ds_read_b128 v[84:87], v61 offset:16384
    ds_read_b128 v[88:91], v62 offset:16384
    ds_read_b128 v[92:95], v63 offset:16384
    s_waitcnt lgkmcnt(7)
    v_mfma_f32_16x16x32_bf16 v[96:99], a[0:3], v[64:67], 0
    v_mfma_f32_16x16x32_bf16 v[100:103], a[32:35], v[64:67], 0
    v_mfma_f32_16x16x32_bf16 v[104:107], a[64:67], v[64:67], 0
    v_mfma_f32_16x16x32_bf16 v[108:111], a[96:99], v[64:67], 0
    s_waitcnt lgkmcnt(6)
    v_mfma_f32_16x16x32_bf16 v[96:99], a[4:7], v[68:71], v[96:99]
    v_mfma_f32_16x16x32_bf16 v[100:103], a[36:39], v[68:71], v[100:103]
    v_mfma_f32_16x16x32_bf16 v[104:107], a[68:71], v[68:71], v[104:107]
    v_mfma_f32_16x16x32_bf16 v[108:111], a[100:103], v[68:71], v[108:111]
    v_pk_mul_f32 v[112:113], v[112:113], v[12:13]
    v_pk_mul_f32 v[114:115], v[114:115], v[12:13]
    v_pk_mul_f32 v[116:117], v[116:117], v[12:13]
    v_pk_mul_f32 v[118:119], v[118:119], v[12:13]
    v_pk_mul_f32 v[120:121], v[120:121], v[12:13]
    v_pk_mul_f32 v[122:123], v[122:123], v[12:13]
    v_pk_mul_f32 v[124:125], v[124:125], v[12:13]
    v_pk_mul_f32 v[126:127], v[126:127], v[12:13]
    v_cvt_pk_bf16_f32 v128, v112, v113
    v_cvt_pk_bf16_f32 v129, v114, v115
    v_cvt_pk_bf16_f32 v130, v116, v117
    v_cvt_pk_bf16_f32 v131, v118, v119
    v_cvt_pk_bf16_f32 v132, v120, v121
    v_cvt_pk_bf16_f32 v133, v122, v123
    v_cvt_pk_bf16_f32 v134, v124, v125
    v_cvt_pk_bf16_f32 v135, v126, v127
    s_add_u32 s37, s36, 14336
    buffer_store_dwordx4 v[128:131], v3, s[8:11], s37 offen sc1
    buffer_store_dwordx4 v[132:135], v3, s[8:11], s37 offen offset:1024 sc1
    s_waitcnt lgkmcnt(5)
    v_mfma_f32_16x16x32_bf16 v[96:99], a[8:11], v[72:75], v[96:99]
    v_mfma_f32_16x16x32_bf16 v[100:103], a[40:43], v[72:75], v[100:103]
    v_mfma_f32_16x16x32_bf16 v[104:107], a[72:75], v[72:75], v[104:107]
    v_mfma_f32_16x16x32_bf16 v[108:111], a[104:107], v[72:75], v[108:111]
    s_waitcnt lgkmcnt(4)
    v_mfma_f32_16x16x32_bf16 v[96:99], a[12:15], v[76:79], v[96:99]
    v_mfma_f32_16x16x32_bf16 v[100:103], a[44:47], v[76:79], v[100:103]
    v_mfma_f32_16x16x32_bf16 v[104:107], a[76:79], v[76:79], v[104:107]
    v_mfma_f32_16x16x32_bf16 v[108:111], a[108:111], v[76:79], v[108:111]
    s_waitcnt lgkmcnt(3)
    v_mfma_f32_16x16x32_bf16 v[96:99], a[16:19], v[80:83], v[96:99]
    v_mfma_f32_16x16x32_bf16 v[100:103], a[48:51], v[80:83], v[100:103]
    v_mfma_f32_16x16x32_bf16 v[104:107], a[80:83], v[80:83], v[104:107]
    v_mfma_f32_16x16x32_bf16 v[108:111], a[112:115], v[80:83], v[108:111]
    s_waitcnt lgkmcnt(2)
    v_mfma_f32_16x16x32_bf16 v[96:99], a[20:23], v[84:87], v[96:99]
    v_mfma_f32_16x16x32_bf16 v[100:103], a[52:55], v[84:87], v[100:103]
    v_mfma_f32_16x16x32_bf16 v[104:107], a[84:87], v[84:87], v[104:107]
    v_mfma_f32_16x16x32_bf16 v[108:111], a[116:119], v[84:87], v[108:111]
    s_waitcnt lgkmcnt(1)
    v_mfma_f32_16x16x32_bf16 v[96:99], a[24:27], v[88:91], v[96:99]
    v_mfma_f32_16x16x32_bf16 v[100:103], a[56:59], v[88:91], v[100:103]
    v_mfma_f32_16x16x32_bf16 v[104:107], a[88:91], v[88:91], v[104:107]
    v_mfma_f32_16x16x32_bf16 v[108:111], a[120:123], v[88:91], v[108:111]
    s_waitcnt vmcnt(20)
    v_accvgpr_read_b32 v11, a252
    s_nop 1
    v_readfirstlane_b32 s46, v11
    s_nop 3
    s_cmp_lg_u32 s46, 0
    s_cbranch_scc1 Lci_1_d
Lci_1:
    buffer_load_dword v11, v136, s[92:95], 0 offen offset:16 sc1
    s_waitcnt vmcnt(0)
    v_readfirstlane_b32 s46, v11
    s_nop 3
    s_cmp_lg_u32 s46, 0
    s_cbranch_scc1 Lci_1_d
    s_sleep 2
    s_sub_u32 s76, s76, 1
    s_cbranch_scc0 Lci_1
    s_branch L_exit
Lci_1_d:
    s_waitcnt vmcnt(10)
    s_add_u32 s45, s44, 0
    s_mov_b64 exec, 1
    buffer_store_dword v137, v136, s[8:11], s45 offen sc1
    s_mov_b64 exec, -1
    s_waitcnt lgkmcnt(0)
    v_mfma_f32_16x16x32_bf16 v[96:99], a[28:31], v[92:95], v[96:99]
    v_mfma_f32_16x16x32_bf16 v[100:103], a[60:63], v[92:95], v[100:103]
    v_mfma_f32_16x16x32_bf16 v[104:107], a[92:95], v[92:95], v[104:107]
    v_mfma_f32_16x16x32_bf16 v[108:111], a[124:127], v[92:95], v[108:111]
    s_add_u32 s41, s39, 786432
    s_add_u32 m0, s40, 16384
    s_nop 0
    buffer_load_dwordx4 v40, s[16:19], s41 offen lds
    s_add_u32 m0, s40, 17408
    s_nop 0
    buffer_load_dwordx4 v41, s[16:19], s41 offen lds
    s_add_u32 m0, s40, 18432
    s_nop 0
    buffer_load_dwordx4 v42, s[16:19], s41 offen lds
    s_add_u32 m0, s40, 19456
    s_nop 0
    buffer_load_dwordx4 v43, s[16:19], s41 offen lds
    s_add_u32 m0, s40, 20480
    s_nop 0
    buffer_load_dwordx4 v44, s[16:19], s41 offen lds
    s_add_u32 m0, s40, 21504
    s_nop 0
    buffer_load_dwordx4 v45, s[16:19], s41 offen lds
    s_add_u32 m0, s40, 22528
    s_nop 0
    buffer_load_dwordx4 v46, s[16:19], s41 offen lds
    s_add_u32 m0, s40, 23552
    s_nop 0
    buffer_load_dwordx4 v47, s[16:19], s41 offen lds
    s_waitcnt vmcnt(30)
    ds_read_b128 v[64:67], v56 offset:24576
    ds_read_b128 v[68:71], v57 offset:24576
    ds_read_b128 v[72:75], v58 offset:24576
    ds_read_b128 v[76:79], v59 offset:24576
    ds_read_b128 v[80:83], v60 offset:24576
    ds_read_b128 v[84:87], v61 offset:24576
    ds_read_b128 v[88:91], v62 offset:24576
    ds_read_b128 v[92:95], v63 offset:24576
    s_waitcnt lgkmcnt(7)
    v_mfma_f32_16x16x32_bf16 v[112:115], a[0:3], v[64:67], 0
    v_mfma_f32_16x16x32_bf16 v[116:119], a[32:35], v[64:67], 0
    v_mfma_f32_16x16x32_bf16 v[120:123], a[64:67], v[64:67], 0
    v_mfma_f32_16x16x32_bf16 v[124:127], a[96:99], v[64:67], 0
    s_waitcnt lgkmcnt(6)
    v_mfma_f32_16x16x32_bf16 v[112:115], a[4:7], v[68:71], v[112:115]
    v_mfma_f32_16x16x32_bf16 v[116:119], a[36:39], v[68:71], v[116:119]
    v_mfma_f32_16x16x32_bf16 v[120:123], a[68:71], v[68:71], v[120:123]
    v_mfma_f32_16x16x32_bf16 v[124:127], a[100:103], v[68:71], v[124:127]
    v_pk_mul_f32 v[96:97], v[96:97], v[12:13]
    v_pk_mul_f32 v[98:99], v[98:99], v[12:13]
    v_pk_mul_f32 v[100:101], v[100:101], v[12:13]
    v_pk_mul_f32 v[102:103], v[102:103], v[12:13]
    v_pk_mul_f32 v[104:105], v[104:105], v[12:13]
    v_pk_mul_f32 v[106:107], v[106:107], v[12:13]
    v_pk_mul_f32 v[108:109], v[108:109], v[12:13]
    v_pk_mul_f32 v[110:111], v[110:111], v[12:13]
    v_cvt_pk_bf16_f32 v16, v96, v97
    v_cvt_pk_bf16_f32 v17, v98, v99
    v_cvt_pk_bf16_f32 v18, v100, v101
    v_cvt_pk_bf16_f32 v19, v102, v103
    v_cvt_pk_bf16_f32 v20, v104, v105
    v_cvt_pk_bf16_f32 v21, v106, v107
    v_cvt_pk_bf16_f32 v22, v108, v109
    v_cvt_pk_bf16_f32 v23, v110, v111
    s_add_u32 s37, s36, 28672
    buffer_store_dwordx4 v[16:19], v3, s[8:11], s37 offen sc1
    buffer_store_dwordx4 v[20:23], v3, s[8:11], s37 offen offset:1024 sc1
    s_waitcnt lgkmcnt(5)
    v_mfma_f32_16x16x32_bf16 v[112:115], a[8:11], v[72:75], v[112:115]
    v_mfma_f32_16x16x32_bf16 v[116:119], a[40:43], v[72:75], v[116:119]
    v_mfma_f32_16x16x32_bf16 v[120:123], a[72:75], v[72:75], v[120:123]
    v_mfma_f32_16x16x32_bf16 v[124:127], a[104:107], v[72:75], v[124:127]
    s_waitcnt lgkmcnt(4)
    v_mfma_f32_16x16x32_bf16 v[112:115], a[12:15], v[76:79], v[112:115]
    v_mfma_f32_16x16x32_bf16 v[116:119], a[44:47], v[76:79], v[116:119]
    v_mfma_f32_16x16x32_bf16 v[120:123], a[76:79], v[76:79], v[120:123]
    v_mfma_f32_16x16x32_bf16 v[124:127], a[108:111], v[76:79], v[124:127]
    s_waitcnt lgkmcnt(3)
    v_mfma_f32_16x16x32_bf16 v[112:115], a[16:19], v[80:83], v[112:115]
    v_mfma_f32_16x16x32_bf16 v[116:119], a[48:51], v[80:83], v[116:119]
    v_mfma_f32_16x16x32_bf16 v[120:123], a[80:83], v[80:83], v[120:123]
    v_mfma_f32_16x16x32_bf16 v[124:127], a[112:115], v[80:83], v[124:127]
    s_waitcnt lgkmcnt(2)
    v_mfma_f32_16x16x32_bf16 v[112:115], a[20:23], v[84:87], v[112:115]
    v_mfma_f32_16x16x32_bf16 v[116:119], a[52:55], v[84:87], v[116:119]
    v_mfma_f32_16x16x32_bf16 v[120:123], a[84:87], v[84:87], v[120:123]
    v_mfma_f32_16x16x32_bf16 v[124:127], a[116:119], v[84:87], v[124:127]
    s_waitcnt lgkmcnt(1)
    v_mfma_f32_16x16x32_bf16 v[112:115], a[24:27], v[88:91], v[112:115]
    v_mfma_f32_16x16x32_bf16 v[116:119], a[56:59], v[88:91], v[116:119]
    v_mfma_f32_16x16x32_bf16 v[120:123], a[88:91], v[88:91], v[120:123]
    v_mfma_f32_16x16x32_bf16 v[124:127], a[120:123], v[88:91], v[124:127]
    s_waitcnt vmcnt(11)
    s_add_u32 s45, s44, 32
    s_mov_b64 exec, 1
    buffer_store_dword v137, v136, s[8:11], s45 offen sc1
    s_mov_b64 exec, -1
    s_waitcnt lgkmcnt(0)
    v_mfma_f32_16x16x32_bf16 v[112:115], a[28:31], v[92:95], v[112:115]
    v_mfma_f32_16x16x32_bf16 v[116:119], a[60:63], v[92:95], v[116:119]
    v_mfma_f32_16x16x32_bf16 v[120:123], a[92:95], v[92:95], v[120:123]
    v_mfma_f32_16x16x32_bf16 v[124:127], a[124:127], v[92:95], v[124:127]
    v_lshlrev_b32 v14, 5, v0
    v_mov_b32 v15, 16
    v_cmp_lt_u32 vcc, 7, v0
    s_nop 1
    v_cndmask_b32 v14, v14, v15, vcc
    buffer_load_dword a251, v14, s[92:95], 0 offen sc1
    s_waitcnt vmcnt(25)
    ds_read_b128 v[64:67], v56 offset:0
    ds_read_b128 v[68:71], v57 offset:0
    ds_read_b128 v[72:75], v58 offset:0
    ds_read_b128 v[76:79], v59 offset:0
    ds_read_b128 v[80:83], v60 offset:0
    ds_read_b128 v[84:87], v61 offset:0
    ds_read_b128 v[88:91], v62 offset:0
    ds_read_b128 v[92:95], v63 offset:0
    s_waitcnt lgkmcnt(7)
    v_mfma_f32_16x16x32_bf16 v[96:99], a[0:3], v[64:67], 0
    v_mfma_f32_16x16x32_bf16 v[100:103], a[32:35], v[64:67], 0
    v_mfma_f32_16x16x32_bf16 v[104:107], a[64:67], v[64:67], 0
    v_mfma_f32_16x16x32_bf16 v[108:111], a[96:99], v[64:67], 0
    s_waitcnt lgkmcnt(6)
    v_mfma_f32_16x16x32_bf16 v[96:99], a[4:7], v[68:71], v[96:99]
    v_mfma_f32_16x16x32_bf16 v[100:103], a[36:39], v[68:71], v[100:103]
    v_mfma_f32_16x16x32_bf16 v[104:107], a[68:71], v[68:71], v[104:107]
    v_mfma_f32_16x16x32_bf16 v[108:111], a[100:103], v[68:71], v[108:111]
    v_pk_mul_f32 v[112:113], v[112:113], v[12:13]
    v_pk_mul_f32 v[114:115], v[114:115], v[12:13]
    v_pk_mul_f32 v[116:117], v[116:117], v[12:13]
    v_pk_mul_f32 v[118:119], v[118:119], v[12:13]
    v_pk_mul_f32 v[120:121], v[120:121], v[12:13]
    v_pk_mul_f32 v[122:123], v[122:123], v[12:13]
    v_pk_mul_f32 v[124:125], v[124:125], v[12:13]
    v_pk_mul_f32 v[126:127], v[126:127], v[12:13]
    v_cvt_pk_bf16_f32 v128, v112, v113
    v_cvt_pk_bf16_f32 v129, v114, v115
    v_cvt_pk_bf16_f32 v130, v116, v117
    v_cvt_pk_bf16_f32 v131, v118, v119
    v_cvt_pk_bf16_f32 v132, v120, v121
    v_cvt_pk_bf16_f32 v133, v122, v123
    v_cvt_pk_bf16_f32 v134, v124, v125
    v_cvt_pk_bf16_f32 v135, v126, v127
    s_add_u32 s37, s36, 43008
    buffer_store_dwordx4 v[128:131], v3, s[8:11], s37 offen sc1
    buffer_store_dwordx4 v[132:135], v3, s[8:11], s37 offen offset:1024 sc1
    s_waitcnt lgkmcnt(5)
    v_mfma_f32_16x16x32_bf16 v[96:99], a[8:11], v[72:75], v[96:99]
    v_mfma_f32_16x16x32_bf16 v[100:103], a[40:43], v[72:75], v[100:103]
    v_mfma_f32_16x16x32_bf16 v[104:107], a[72:75], v[72:75], v[104:107]
    v_mfma_f32_16x16x32_bf16 v[108:111], a[104:107], v[72:75], v[108:111]
    s_waitcnt lgkmcnt(4)
    v_mfma_f32_16x16x32_bf16 v[96:99], a[12:15], v[76:79], v[96:99]
    v_mfma_f32_16x16x32_bf16 v[100:103], a[44:47], v[76:79], v[100:103]
    v_mfma_f32_16x16x32_bf16 v[104:107], a[76:79], v[76:79], v[104:107]
    v_mfma_f32_16x16x32_bf16 v[108:111], a[108:111], v[76:79], v[108:111]
    s_waitcnt lgkmcnt(3)
    v_mfma_f32_16x16x32_bf16 v[96:99], a[16:19], v[80:83], v[96:99]
    v_mfma_f32_16x16x32_bf16 v[100:103], a[48:51], v[80:83], v[100:103]
    v_mfma_f32_16x16x32_bf16 v[104:107], a[80:83], v[80:83], v[104:107]
    v_mfma_f32_16x16x32_bf16 v[108:111], a[112:115], v[80:83], v[108:111]
    s_waitcnt lgkmcnt(2)
    v_mfma_f32_16x16x32_bf16 v[96:99], a[20:23], v[84:87], v[96:99]
    v_mfma_f32_16x16x32_bf16 v[100:103], a[52:55], v[84:87], v[100:103]
    v_mfma_f32_16x16x32_bf16 v[104:107], a[84:87], v[84:87], v[104:107]
    v_mfma_f32_16x16x32_bf16 v[108:111], a[116:119], v[84:87], v[108:111]
    s_waitcnt lgkmcnt(1)
    v_mfma_f32_16x16x32_bf16 v[96:99], a[24:27], v[88:91], v[96:99]
    v_mfma_f32_16x16x32_bf16 v[100:103], a[56:59], v[88:91], v[100:103]
    v_mfma_f32_16x16x32_bf16 v[104:107], a[88:91], v[88:91], v[104:107]
    v_mfma_f32_16x16x32_bf16 v[108:111], a[120:123], v[88:91], v[108:111]
    s_waitcnt vmcnt(4)
    s_add_u32 s45, s44, 64
    s_mov_b64 exec, 1
    buffer_store_dword v137, v136, s[8:11], s45 offen sc1
    s_mov_b64 exec, -1
    s_waitcnt lgkmcnt(0)
    v_mfma_f32_16x16x32_bf16 v[96:99], a[28:31], v[92:95], v[96:99]
    v_mfma_f32_16x16x32_bf16 v[100:103], a[60:63], v[92:95], v[100:103]
    v_mfma_f32_16x16x32_bf16 v[104:107], a[92:95], v[92:95], v[104:107]
    v_mfma_f32_16x16x32_bf16 v[108:111], a[124:127], v[92:95], v[108:111]
    s_waitcnt vmcnt(18)
    ds_read_b128 v[64:67], v56 offset:8192
    ds_read_b128 v[68:71], v57 offset:8192
    ds_read_b128 v[72:75], v58 offset:8192
    ds_read_b128 v[76:79], v59 offset:8192
    ds_read_b128 v[80:83], v60 offset:8192
    ds_read_b128 v[84:87], v61 offset:8192
    ds_read_b128 v[88:91], v62 offset:8192
    ds_read_b128 v[92:95], v63 offset:8192
    s_waitcnt lgkmcnt(7)
    v_mfma_f32_16x16x32_bf16 v[112:115], a[0:3], v[64:67], 0
    v_mfma_f32_16x16x32_bf16 v[116:119], a[32:35], v[64:67], 0
    v_mfma_f32_16x16x32_bf16 v[120:123], a[64:67], v[64:67], 0
    v_mfma_f32_16x16x32_bf16 v[124:127], a[96:99], v[64:67], 0
    s_waitcnt lgkmcnt(6)
    v_mfma_f32_16x16x32_bf16 v[112:115], a[4:7], v[68:71], v[112:115]
    v_mfma_f32_16x16x32_bf16 v[116:119], a[36:39], v[68:71], v[116:119]
    v_mfma_f32_16x16x32_bf16 v[120:123], a[68:71], v[68:71], v[120:123]
    v_mfma_f32_16x16x32_bf16 v[124:127], a[100:103], v[68:71], v[124:127]
    v_pk_mul_f32 v[96:97], v[96:97], v[12:13]
    v_pk_mul_f32 v[98:99], v[98:99], v[12:13]
    v_pk_mul_f32 v[100:101], v[100:101], v[12:13]
    v_pk_mul_f32 v[102:103], v[102:103], v[12:13]
    v_pk_mul_f32 v[104:105], v[104:105], v[12:13]
    v_pk_mul_f32 v[106:107], v[106:107], v[12:13]
    v_pk_mul_f32 v[108:109], v[108:109], v[12:13]
    v_pk_mul_f32 v[110:111], v[110:111], v[12:13]
    v_cvt_pk_bf16_f32 v16, v96, v97
    v_cvt_pk_bf16_f32 v17, v98, v99
    v_cvt_pk_bf16_f32 v18, v100, v101
    v_cvt_pk_bf16_f32 v19, v102, v103
    v_cvt_pk_bf16_f32 v20, v104, v105
    v_cvt_pk_bf16_f32 v21, v106, v107
    v_cvt_pk_bf16_f32 v22, v108, v109
    v_cvt_pk_bf16_f32 v23, v110, v111
    s_add_u32 s37, s36, 57344
    buffer_store_dwordx4 v[16:19], v3, s[8:11], s37 offen sc1
    buffer_store_dwordx4 v[20:23], v3, s[8:11], s37 offen offset:1024 sc1
    s_waitcnt lgkmcnt(5)
    v_mfma_f32_16x16x32_bf16 v[112:115], a[8:11], v[72:75], v[112:115]
    v_mfma_f32_16x16x32_bf16 v[116:119], a[40:43], v[72:75], v[116:119]
    v_mfma_f32_16x16x32_bf16 v[120:123], a[72:75], v[72:75], v[120:123]
    v_mfma_f32_16x16x32_bf16 v[124:127], a[104:107], v[72:75], v[124:127]
    s_waitcnt lgkmcnt(4)
    v_mfma_f32_16x16x32_bf16 v[112:115], a[12:15], v[76:79], v[112:115]
    v_mfma_f32_16x16x32_bf16 v[116:119], a[44:47], v[76:79], v[116:119]
    v_mfma_f32_16x16x32_bf16 v[120:123], a[76:79], v[76:79], v[120:123]
    v_mfma_f32_16x16x32_bf16 v[124:127], a[108:111], v[76:79], v[124:127]
    s_waitcnt lgkmcnt(3)
    v_mfma_f32_16x16x32_bf16 v[112:115], a[16:19], v[80:83], v[112:115]
    v_mfma_f32_16x16x32_bf16 v[116:119], a[48:51], v[80:83], v[116:119]
    v_mfma_f32_16x16x32_bf16 v[120:123], a[80:83], v[80:83], v[120:123]
    v_mfma_f32_16x16x32_bf16 v[124:127], a[112:115], v[80:83], v[124:127]
    s_waitcnt lgkmcnt(2)
    v_mfma_f32_16x16x32_bf16 v[112:115], a[20:23], v[84:87], v[112:115]
    v_mfma_f32_16x16x32_bf16 v[116:119], a[52:55], v[84:87], v[116:119]
    v_mfma_f32_16x16x32_bf16 v[120:123], a[84:87], v[84:87], v[120:123]
    v_mfma_f32_16x16x32_bf16 v[124:127], a[116:119], v[84:87], v[124:127]
    s_waitcnt lgkmcnt(1)
    v_mfma_f32_16x16x32_bf16 v[112:115], a[24:27], v[88:91], v[112:115]
    v_mfma_f32_16x16x32_bf16 v[116:119], a[56:59], v[88:91], v[116:119]
    v_mfma_f32_16x16x32_bf16 v[120:123], a[88:91], v[88:91], v[120:123]
    v_mfma_f32_16x16x32_bf16 v[124:127], a[120:123], v[88:91], v[124:127]
    s_waitcnt vmcnt(3)
    s_add_u32 s45, s44, 96
    s_mov_b64 exec, 1
    buffer_store_dword v137, v136, s[8:11], s45 offen sc1
    s_mov_b64 exec, -1
    s_waitcnt lgkmcnt(0)
    v_mfma_f32_16x16x32_bf16 v[112:115], a[28:31], v[92:95], v[112:115]
    v_mfma_f32_16x16x32_bf16 v[116:119], a[60:63], v[92:95], v[116:119]
    v_mfma_f32_16x16x32_bf16 v[120:123], a[92:95], v[92:95], v[120:123]
    v_mfma_f32_16x16x32_bf16 v[124:127], a[124:127], v[92:95], v[124:127]
    s_waitcnt vmcnt(10)
    ds_read_b128 v[64:67], v56 offset:16384
    ds_read_b128 v[68:71], v57 offset:16384
    ds_read_b128 v[72:75], v58 offset:16384
    ds_read_b128 v[76:79], v59 offset:16384
    ds_read_b128 v[80:83], v60 offset:16384
    ds_read_b128 v[84:87], v61 offset:16384
    ds_read_b128 v[88:91], v62 offset:16384
    ds_read_b128 v[92:95], v63 offset:16384
    s_waitcnt lgkmcnt(7)
    v_mfma_f32_16x16x32_bf16 v[96:99], a[0:3], v[64:67], 0
    v_mfma_f32_16x16x32_bf16 v[100:103], a[32:35], v[64:67], 0
    v_mfma_f32_16x16x32_bf16 v[104:107], a[64:67], v[64:67], 0
    v_mfma_f32_16x16x32_bf16 v[108:111], a[96:99], v[64:67], 0
    s_waitcnt lgkmcnt(6)
    v_mfma_f32_16x16x32_bf16 v[96:99], a[4:7], v[68:71], v[96:99]
    v_mfma_f32_16x16x32_bf16 v[100:103], a[36:39], v[68:71], v[100:103]
    v_mfma_f32_16x16x32_bf16 v[104:107], a[68:71], v[68:71], v[104:107]
    v_mfma_f32_16x16x32_bf16 v[108:111], a[100:103], v[68:71], v[108:111]
    v_pk_mul_f32 v[112:113], v[112:113], v[12:13]
    v_pk_mul_f32 v[114:115], v[114:115], v[12:13]
    v_pk_mul_f32 v[116:117], v[116:117], v[12:13]
    v_pk_mul_f32 v[118:119], v[118:119], v[12:13]
    v_pk_mul_f32 v[120:121], v[120:121], v[12:13]
    v_pk_mul_f32 v[122:123], v[122:123], v[12:13]
    v_pk_mul_f32 v[124:125], v[124:125], v[12:13]
    v_pk_mul_f32 v[126:127], v[126:127], v[12:13]
    v_cvt_pk_bf16_f32 v128, v112, v113
    v_cvt_pk_bf16_f32 v129, v114, v115
    v_cvt_pk_bf16_f32 v130, v116, v117
    v_cvt_pk_bf16_f32 v131, v118, v119
    v_cvt_pk_bf16_f32 v132, v120, v121
    v_cvt_pk_bf16_f32 v133, v122, v123
    v_cvt_pk_bf16_f32 v134, v124, v125
    v_cvt_pk_bf16_f32 v135, v126, v127
    s_add_u32 s37, s36, 71680
    buffer_store_dwordx4 v[128:131], v3, s[8:11], s37 offen sc1
    buffer_store_dwordx4 v[132:135], v3, s[8:11], s37 offen offset:1024 sc1
    s_waitcnt lgkmcnt(5)
    v_mfma_f32_16x16x32_bf16 v[96:99], a[8:11], v[72:75], v[96:99]
    v_mfma_f32_16x16x32_bf16 v[100:103], a[40:43], v[72:75], v[100:103]
    v_mfma_f32_16x16x32_bf16 v[104:107], a[72:75], v[72:75], v[104:107]
    v_mfma_f32_16x16x32_bf16 v[108:111], a[104:107], v[72:75], v[108:111]
    s_waitcnt lgkmcnt(4)
    v_mfma_f32_16x16x32_bf16 v[96:99], a[12:15], v[76:79], v[96:99]
    v_mfma_f32_16x16x32_bf16 v[100:103], a[44:47], v[76:79], v[100:103]
    v_mfma_f32_16x16x32_bf16 v[104:107], a[76:79], v[76:79], v[104:107]
    v_mfma_f32_16x16x32_bf16 v[108:111], a[108:111], v[76:79], v[108:111]
    s_waitcnt lgkmcnt(3)
    v_mfma_f32_16x16x32_bf16 v[96:99], a[16:19], v[80:83], v[96:99]
    v_mfma_f32_16x16x32_bf16 v[100:103], a[48:51], v[80:83], v[100:103]
    v_mfma_f32_16x16x32_bf16 v[104:107], a[80:83], v[80:83], v[104:107]
    v_mfma_f32_16x16x32_bf16 v[108:111], a[112:115], v[80:83], v[108:111]
    s_waitcnt lgkmcnt(2)
    v_mfma_f32_16x16x32_bf16 v[96:99], a[20:23], v[84:87], v[96:99]
    v_mfma_f32_16x16x32_bf16 v[100:103], a[52:55], v[84:87], v[100:103]
    v_mfma_f32_16x16x32_bf16 v[104:107], a[84:87], v[84:87], v[104:107]
    v_mfma_f32_16x16x32_bf16 v[108:111], a[116:119], v[84:87], v[108:111]
    s_waitcnt lgkmcnt(1)
    v_mfma_f32_16x16x32_bf16 v[96:99], a[24:27], v[88:91], v[96:99]
    v_mfma_f32_16x16x32_bf16 v[100:103], a[56:59], v[88:91], v[100:103]
    v_mfma_f32_16x16x32_bf16 v[104:107], a[88:91], v[88:91], v[104:107]
    v_mfma_f32_16x16x32_bf16 v[108:111], a[120:123], v[88:91], v[108:111]
    s_waitcnt vmcnt(3)
    s_add_u32 s45, s44, 128
    s_mov_b64 exec, 1
    buffer_store_dword v137, v136, s[8:11], s45 offen sc1
    s_mov_b64 exec, -1
    s_waitcnt lgkmcnt(0)
    v_mfma_f32_16x16x32_bf16 v[96:99], a[28:31], v[92:95], v[96:99]
    v_mfma_f32_16x16x32_bf16 v[100:103], a[60:63], v[92:95], v[100:103]
    v_mfma_f32_16x16x32_bf16 v[104:107], a[92:95], v[92:95], v[104:107]
    v_mfma_f32_16x16x32_bf16 v[108:111], a[124:127], v[92:95], v[108:111]
    v_pk_mul_f32 v[96:97], v[96:97], v[12:13]
    v_pk_mul_f32 v[98:99], v[98:99], v[12:13]
    v_pk_mul_f32 v[100:101], v[100:101], v[12:13]
    v_pk_mul_f32 v[102:103], v[102:103], v[12:13]
    v_pk_mul_f32 v[104:105], v[104:105], v[12:13]
    v_pk_mul_f32 v[106:107], v[106:107], v[12:13]
    s_nop 1
    v_pk_mul_f32 v[108:109], v[108:109], v[12:13]
    v_pk_mul_f32 v[110:111], v[110:111], v[12:13]
    v_cvt_pk_bf16_f32 v16, v96, v97
    v_cvt_pk_bf16_f32 v17, v98, v99
    v_cvt_pk_bf16_f32 v18, v100, v101
    v_cvt_pk_bf16_f32 v19, v102, v103
    v_cvt_pk_bf16_f32 v20, v104, v105
    v_cvt_pk_bf16_f32 v21, v106, v107
    v_cvt_pk_bf16_f32 v22, v108, v109
    v_cvt_pk_bf16_f32 v23, v110, v111
    s_add_u32 s37, s36, 86016
    buffer_store_dwordx4 v[16:19], v3, s[8:11], s37 offen sc1
    buffer_store_dwordx4 v[20:23], v3, s[8:11], s37 offen offset:1024 sc1
    s_waitcnt vmcnt(3)
    s_add_u32 s45, s44, 160
    s_mov_b64 exec, 1
    buffer_store_dword v137, v136, s[8:11], s45 offen sc1
    s_mov_b64 exec, -1
    s_waitcnt vmcnt(1)
    s_add_u32 s45, s44, 192
    s_mov_b64 exec, 1
    buffer_store_dword v137, v136, s[8:11], s45 offen sc1
    s_mov_b64 exec, -1
    s_branch P_done
P_B:
    s_sub_u32 s30, s30, 16
    s_mov_b32 s12, s64
    s_mov_b32 s13, s65
    s_mov_b32 s16, s66
    s_mov_b32 s17, s67
    s_mov_b32 s14, 3670016
    s_mov_b32 s15, 0x20000
    s_mov_b32 s18, 3670016
    s_mov_b32 s19, 0x20000
    v_and_b32 v6, 15, v0
    v_lshrrev_b32 v7, 4, v0
    v_lshlrev_b32 v3, 4, v0
    v_lshrrev_b32 v8, 5, v0
    v_and_b32 v9, 31, v0
    s_lshl_b32 s33, s30, 9
    v_add_u32 v10, 0, v8
    v_xor_b32 v11, v9, v10
    v_lshlrev_b32 v11, 4, v11
    v_lshl_add_u32 v11, v10, 13, v11
    v_add_u32 v40, s33, v11
    v_add_u32 v10, 2, v8
    v_xor_b32 v11, v9, v10
    v_lshlrev_b32 v11, 4, v11
    v_lshl_add_u32 v11, v10, 13, v11
    v_add_u32 v41, s33, v11
    v_add_u32 v10, 4, v8
    v_xor_b32 v11, v9, v10
    v_lshlrev_b32 v11, 4, v11
    v_lshl_add_u32 v11, v10, 13, v11
    v_add_u32 v42, s33, v11
    v_add_u32 v10, 6, v8
    v_xor_b32 v11, v9, v10
    v_lshlrev_b32 v11, 4, v11
    v_lshl_add_u32 v11, v10, 13, v11
    v_add_u32 v43, s33, v11
    v_add_u32 v10, 8, v8
    v_xor_b32 v11, v9, v10
    v_lshlrev_b32 v11, 4, v11
    v_lshl_add_u32 v11, v10, 13, v11
    v_add_u32 v44, s33, v11
    v_add_u32 v10, 10, v8
    v_xor_b32 v11, v9, v10
    v_lshlrev_b32 v11, 4, v11
    v_lshl_add_u32 v11, v10, 13, v11
    v_add_u32 v45, s33, v11
    v_add_u32 v10, 12, v8
    v_xor_b32 v11, v9, v10
    v_lshlrev_b32 v11, 4, v11
    v_lshl_add_u32 v11, v10, 13, v11
    v_add_u32 v46, s33, v11
    v_add_u32 v10, 14, v8
    v_xor_b32 v11, v9, v10
    v_lshlrev_b32 v11, 4, v11
    v_lshl_add_u32 v11, v10, 13, v11
    v_add_u32 v47, s33, v11
    s_lshl_b32 s32, s31, 6
    s_lshl_b32 s34, s3, 4
    s_add_u32 s32, s32, s34
    s_lshl_b32 s32, s32, 13
    s_lshl_b32 s35, s3, 13
    s_add_u32 m0, s35, 0
    s_nop 0
    buffer_load_dwordx4 v40, s[12:15], s32 offen lds
    s_add_u32 m0, s35, 1024
    s_nop 0
    buffer_load_dwordx4 v41, s[12:15], s32 offen lds
    s_add_u32 m0, s35, 2048
    s_nop 0
    buffer_load_dwordx4 v42, s[12:15], s32 offen lds
    s_add_u32 m0, s35, 3072
    s_nop 0
    buffer_load_dwordx4 v43, s[12:15], s32 offen lds
    s_add_u32 m0, s35, 4096
    s_nop 0
    buffer_load_dwordx4 v44, s[12:15], s32 offen lds
    s_add_u32 m0, s35, 5120
    s_nop 0
    buffer_load_dwordx4 v45, s[12:15], s32 offen lds
    s_add_u32 m0, s35, 6144
    s_nop 0
    buffer_load_dwordx4 v46, s[12:15], s32 offen lds
    s_add_u32 m0, s35, 7168
    s_nop 0
    buffer_load_dwordx4 v47, s[12:15], s32 offen lds
    s_mul_i32 s36, s30, 28
    s_mul_i32 s37, s3, 7
    s_add_u32 s36, s36, s37
    s_mul_i32 s36, s36, 14
    s_lshl_b32 s37, s31, 1
    s_add_u32 s36, s36, s37
    s_lshl_b32 s36, s36, 10
    s_add_u32 s36, s36, 12582912
    s_mov_b32 s38, 1035512379
    s_mul_i32 s39, s30, 229376
    s_mul_i32 s40, s3, 7168
    s_add_u32 s39, s39, s40
    v_and_b32 v8, 3, v6
    v_lshrrev_b32 v9, 2, v6
    v_lshl_add_u32 v9, v7, 3, v9
    v_mul_u32_u24 v9, 896, v9
    v_lshl_add_u32 v9, v8, 3, v9
    s_mul_i32 s41, s3, 224
    s_add_u32 s41, s41, 32768
    v_add_u32 v5, s41, v9
    s_add_u32 s41, s39, 0
    s_add_u32 s42, s40, 32768
    s_mov_b32 m0, s42
    s_nop 0
    buffer_load_dwordx4 v3, s[16:19], s41 offen offset:0 lds
    buffer_load_dwordx4 v3, s[16:19], s41 offen offset:1024 lds
    buffer_load_dwordx4 v3, s[16:19], s41 offen offset:2048 lds
    buffer_load_dwordx4 v3, s[16:19], s41 offen offset:3072 lds
    s_add_u32 s41, s41, 4096
    s_add_u32 s42, s42, 4096
    s_mov_b32 m0, s42
    s_nop 0
    buffer_load_dwordx4 v3, s[16:19], s41 offen offset:0 lds
    buffer_load_dwordx4 v3, s[16:19], s41 offen offset:1024 lds
    buffer_load_dwordx4 v3, s[16:19], s41 offen offset:2048 lds
    s_add_u32 s41, s39, 28672
    s_add_u32 s42, s40, 61440
    s_mov_b32 m0, s42
    s_nop 0
    buffer_load_dwordx4 v3, s[16:19], s41 offen offset:0 lds
    buffer_load_dwordx4 v3, s[16:19], s41 offen offset:1024 lds
    buffer_load_dwordx4 v3, s[16:19], s41 offen offset:2048 lds
    buffer_load_dwordx4 v3, s[16:19], s41 offen offset:3072 lds
    s_add_u32 s41, s41, 4096
    s_add_u32 s42, s42, 4096
    s_mov_b32 m0, s42
    s_nop 0
    buffer_load_dwordx4 v3, s[16:19], s41 offen offset:0 lds
    buffer_load_dwordx4 v3, s[16:19], s41 offen offset:1024 lds
    buffer_load_dwordx4 v3, s[16:19], s41 offen offset:2048 lds
    s_add_u32 s41, s39, 57344
    s_add_u32 s42, s40, 90112
    s_mov_b32 m0, s42
    s_nop 0
    buffer_load_dwordx4 v3, s[16:19], s41 offen offset:0 lds
    buffer_load_dwordx4 v3, s[16:19], s41 offen offset:1024 lds
    buffer_load_dwordx4 v3, s[16:19], s41 offen offset:2048 lds
    buffer_load_dwordx4 v3, s[16:19], s41 offen offset:3072 lds
    s_add_u32 s41, s41, 4096
    s_add_u32 s42, s42, 4096
    s_mov_b32 m0, s42
    s_nop 0
    buffer_load_dwordx4 v3, s[16:19], s41 offen offset:0 lds
    buffer_load_dwordx4 v3, s[16:19], s41 offen offset:1024 lds
    buffer_load_dwordx4 v3, s[16:19], s41 offen offset:2048 lds
    v_lshlrev_b32 v10, 7, v0
    s_mul_i32 s43, s30, 229376
    s_mul_i32 s44, s3, 40960
    s_add_u32 s43, s43, s44
    s_add_u32 s43, s43, 86016
    v_add_u32 v10, 0, v7
    v_xor_b32 v10, v10, v6
    v_lshlrev_b32 v10, 4, v10
    v_lshl_add_u32 v48, v6, 9, v10
    v_add_u32 v10, 4, v7
    v_xor_b32 v10, v10, v6
    v_lshlrev_b32 v10, 4, v10
    v_lshl_add_u32 v49, v6, 9, v10
    v_add_u32 v10, 8, v7
    v_xor_b32 v10, v10, v6
    v_lshlrev_b32 v10, 4, v10
    v_lshl_add_u32 v50, v6, 9, v10
    v_add_u32 v10, 12, v7
    v_xor_b32 v10, v10, v6
    v_lshlrev_b32 v10, 4, v10
    v_lshl_add_u32 v51, v6, 9, v10
    v_add_u32 v10, 16, v7
    v_xor_b32 v10, v10, v6
    v_lshlrev_b32 v10, 4, v10
    v_lshl_add_u32 v52, v6, 9, v10
    v_add_u32 v10, 20, v7
    v_xor_b32 v10, v10, v6
    v_lshlrev_b32 v10, 4, v10
    v_lshl_add_u32 v53, v6, 9, v10
    v_add_u32 v10, 24, v7
    v_xor_b32 v10, v10, v6
    v_lshlrev_b32 v10, 4, v10
    v_lshl_add_u32 v54, v6, 9, v10
    v_add_u32 v10, 28, v7
    v_xor_b32 v10, v10, v6
    v_lshlrev_b32 v10, 4, v10
    v_lshl_add_u32 v55, v6, 9, v10
    s_waitcnt vmcnt(21)
    s_barrier
    ds_read_b128 a[0:3], v48 offset:0
    ds_read_b128 a[4:7], v49 offset:0
    ds_read_b128 a[8:11], v50 offset:0
    ds_read_b128 a[12:15], v51 offset:0
    ds_read_b128 a[16:19], v52 offset:0
    ds_read_b128 a[20:23], v53 offset:0
    ds_read_b128 a[24:27], v54 offset:0
    ds_read_b128 a[28:31], v55 offset:0
    ds_read_b128 a[32:35], v48 offset:8192
    ds_read_b128 a[36:39], v49 offset:8192
    ds_read_b128 a[40:43], v50 offset:8192
    ds_read_b128 a[44:47], v51 offset:8192
    ds_read_b128 a[48:51], v52 offset:8192
    ds_read_b128 a[52:55], v53 offset:8192
    ds_read_b128 a[56:59], v54 offset:8192
    ds_read_b128 a[60:63], v55 offset:8192
    ds_read_b128 a[64:67], v48 offset:16384
    ds_read_b128 a[68:71], v49 offset:16384
    ds_read_b128 a[72:75], v50 offset:16384
    ds_read_b128 a[76:79], v51 offset:16384
    ds_read_b128 a[80:83], v52 offset:16384
    ds_read_b128 a[84:87], v53 offset:16384
    ds_read_b128 a[88:91], v54 offset:16384
    ds_read_b128 a[92:95], v55 offset:16384
    ds_read_b128 a[96:99], v48 offset:24576
    ds_read_b128 a[100:103], v49 offset:24576
    ds_read_b128 a[104:107], v50 offset:24576
    ds_read_b128 a[108:111], v51 offset:24576
    ds_read_b128 a[112:115], v52 offset:24576
    ds_read_b128 a[116:119], v53 offset:24576
    ds_read_b128 a[120:123], v54 offset:24576
    ds_read_b128 a[124:127], v55 offset:24576
    s_waitcnt lgkmcnt(0)
    s_waitcnt vmcnt(14)
    s_barrier
    s_add_u32 s41, s39, 86016
    s_add_u32 s42, s40, 118784
    s_mov_b32 m0, s42
    s_nop 0
    buffer_load_dwordx4 v3, s[16:19], s41 offen offset:0 lds
    buffer_load_dwordx4 v3, s[16:19], s41 offen offset:1024 lds
    buffer_load_dwordx4 v3, s[16:19], s41 offen offset:2048 lds
    buffer_load_dwordx4 v3, s[16:19], s41 offen offset:3072 lds
    s_add_u32 s41, s41, 4096
    s_add_u32 s42, s42, 4096
    s_mov_b32 m0, s42
    s_nop 0
    buffer_load_dwordx4 v3, s[16:19], s41 offen offset:0 lds
    buffer_load_dwordx4 v3, s[16:19], s41 offen offset:1024 lds
    buffer_load_dwordx4 v3, s[16:19], s41 offen offset:2048 lds
    v_add_u32 v10, 0, v5
    ds_read_b64_tr_b16 v[64:65], v10 offset:0
    ds_read_b64_tr_b16 v[66:67], v10 offset:3584
    ds_read_b64_tr_b16 v[68:69], v10 offset:32
    ds_read_b64_tr_b16 v[70:71], v10 offset:3616
    ds_read_b64_tr_b16 v[72:73], v10 offset:64
    ds_read_b64_tr_b16 v[74:75], v10 offset:3648
    ds_read_b64_tr_b16 v[76:77], v10 offset:96
    ds_read_b64_tr_b16 v[78:79], v10 offset:3680
    ds_read_b64_tr_b16 v[80:81], v10 offset:128
    ds_read_b64_tr_b16 v[82:83], v10 offset:3712
    ds_read_b64_tr_b16 v[84:85], v10 offset:160
    ds_read_b64_tr_b16 v[86:87], v10 offset:3744
    ds_read_b64_tr_b16 v[88:89], v10 offset:192
    ds_read_b64_tr_b16 v[90:91], v10 offset:3776
    s_waitcnt lgkmcnt(12)
    v_mfma_f32_16x16x32_bf16 v[96:99], a[0:3], v[64:67], 0
    v_mfma_f32_16x16x32_bf16 v[100:103], a[32:35], v[64:67], 0
    v_mfma_f32_16x16x32_bf16 v[104:107], a[64:67], v[64:67], 0
    v_mfma_f32_16x16x32_bf16 v[108:111], a[96:99], v[64:67], 0
    s_waitcnt lgkmcnt(10)
    v_mfma_f32_16x16x32_bf16 v[112:115], a[0:3], v[68:71], 0
    v_mfma_f32_16x16x32_bf16 v[116:119], a[32:35], v[68:71], 0
    v_mfma_f32_16x16x32_bf16 v[120:123], a[64:67], v[68:71], 0
    v_mfma_f32_16x16x32_bf16 v[124:127], a[96:99], v[68:71], 0
    s_waitcnt lgkmcnt(8)
    v_mfma_f32_16x16x32_bf16 v[128:131], a[0:3], v[72:75], 0
    v_mfma_f32_16x16x32_bf16 v[132:135], a[32:35], v[72:75], 0
    v_mfma_f32_16x16x32_bf16 v[136:139], a[64:67], v[72:75], 0
    v_mfma_f32_16x16x32_bf16 v[140:143], a[96:99], v[72:75], 0
    s_waitcnt lgkmcnt(6)
    v_mfma_f32_16x16x32_bf16 v[144:147], a[0:3], v[76:79], 0
    v_mfma_f32_16x16x32_bf16 v[148:151], a[32:35], v[76:79], 0
    v_mfma_f32_16x16x32_bf16 v[152:155], a[64:67], v[76:79], 0
    v_mfma_f32_16x16x32_bf16 v[156:159], a[96:99], v[76:79], 0
    s_waitcnt lgkmcnt(4)
    v_mfma_f32_16x16x32_bf16 v[160:163], a[0:3], v[80:83], 0
    v_mfma_f32_16x16x32_bf16 v[164:167], a[32:35], v[80:83], 0
    v_mfma_f32_16x16x32_bf16 v[168:171], a[64:67], v[80:83], 0
    v_mfma_f32_16x16x32_bf16 v[172:175], a[96:99], v[80:83], 0
    s_waitcnt lgkmcnt(2)
    v_mfma_f32_16x16x32_bf16 v[176:179], a[0:3], v[84:87], 0
    v_mfma_f32_16x16x32_bf16 v[180:183], a[32:35], v[84:87], 0
    v_mfma_f32_16x16x32_bf16 v[184:187], a[64:67], v[84:87], 0
    v_mfma_f32_16x16x32_bf16 v[188:191], a[96:99], v[84:87], 0
    s_waitcnt lgkmcnt(0)
    v_mfma_f32_16x16x32_bf16 v[192:195], a[0:3], v[88:91], 0
    v_mfma_f32_16x16x32_bf16 v[196:199], a[32:35], v[88:91], 0
    v_mfma_f32_16x16x32_bf16 v[200:203], a[64:67], v[88:91], 0
    v_mfma_f32_16x16x32_bf16 v[204:207], a[96:99], v[88:91], 0
    s_waitcnt vmcnt(14)
    s_barrier
    s_add_u32 s41, s39, 114688
    s_add_u32 s42, s40, 32768
    s_mov_b32 m0, s42
    s_nop 0
    buffer_load_dwordx4 v3, s[16:19], s41 offen offset:0 lds
    buffer_load_dwordx4 v3, s[16:19], s41 offen offset:1024 lds
    buffer_load_dwordx4 v3, s[16:19], s41 offen offset:2048 lds
    buffer_load_dwordx4 v3, s[16:19], s41 offen offset:3072 lds
    s_add_u32 s41, s41, 4096
    s_add_u32 s42, s42, 4096
    s_mov_b32 m0, s42
    s_nop 0
    buffer_load_dwordx4 v3, s[16:19], s41 offen offset:0 lds
    buffer_load_dwordx4 v3, s[16:19], s41 offen offset:1024 lds
    buffer_load_dwordx4 v3, s[16:19], s41 offen offset:2048 lds
    v_add_u32 v10, 28672, v5
    ds_read_b64_tr_b16 v[64:65], v10 offset:0
    ds_read_b64_tr_b16 v[66:67], v10 offset:3584
    ds_read_b64_tr_b16 v[68:69], v10 offset:32
    ds_read_b64_tr_b16 v[70:71], v10 offset:3616
    ds_read_b64_tr_b16 v[72:73], v10 offset:64
    ds_read_b64_tr_b16 v[74:75], v10 offset:3648
    ds_read_b64_tr_b16 v[76:77], v10 offset:96
    ds_read_b64_tr_b16 v[78:79], v10 offset:3680
    ds_read_b64_tr_b16 v[80:81], v10 offset:128
    ds_read_b64_tr_b16 v[82:83], v10 offset:3712
    ds_read_b64_tr_b16 v[84:85], v10 offset:160
    ds_read_b64_tr_b16 v[86:87], v10 offset:3744
    ds_read_b64_tr_b16 v[88:89], v10 offset:192
    ds_read_b64_tr_b16 v[90:91], v10 offset:3776
    s_waitcnt lgkmcnt(12)
    v_mfma_f32_16x16x32_bf16 v[96:99], a[4:7], v[64:67], v[96:99]
    v_mfma_f32_16x16x32_bf16 v[100:103], a[36:39], v[64:67], v[100:103]
    v_mfma_f32_16x16x32_bf16 v[104:107], a[68:71], v[64:67], v[104:107]
    v_mfma_f32_16x16x32_bf16 v[108:111], a[100:103], v[64:67], v[108:111]
    s_waitcnt lgkmcnt(10)
    v_mfma_f32_16x16x32_bf16 v[112:115], a[4:7], v[68:71], v[112:115]
    v_mfma_f32_16x16x32_bf16 v[116:119], a[36:39], v[68:71], v[116:119]
    v_mfma_f32_16x16x32_bf16 v[120:123], a[68:71], v[68:71], v[120:123]
    v_mfma_f32_16x16x32_bf16 v[124:127], a[100:103], v[68:71], v[124:127]
    s_waitcnt lgkmcnt(8)
    v_mfma_f32_16x16x32_bf16 v[128:131], a[4:7], v[72:75], v[128:131]
    v_mfma_f32_16x16x32_bf16 v[132:135], a[36:39], v[72:75], v[132:135]
    v_mfma_f32_16x16x32_bf16 v[136:139], a[68:71], v[72:75], v[136:139]
    v_mfma_f32_16x16x32_bf16 v[140:143], a[100:103], v[72:75], v[140:143]
    s_waitcnt lgkmcnt(6)
    v_mfma_f32_16x16x32_bf16 v[144:147], a[4:7], v[76:79], v[144:147]
    v_mfma_f32_16x16x32_bf16 v[148:151], a[36:39], v[76:79], v[148:151]
    v_mfma_f32_16x16x32_bf16 v[152:155], a[68:71], v[76:79], v[152:155]
    v_mfma_f32_16x16x32_bf16 v[156:159], a[100:103], v[76:79], v[156:159]
    s_waitcnt lgkmcnt(4)
    v_mfma_f32_16x16x32_bf16 v[160:163], a[4:7], v[80:83], v[160:163]
    v_mfma_f32_16x16x32_bf16 v[164:167], a[36:39], v[80:83], v[164:167]
    v_mfma_f32_16x16x32_bf16 v[168:171], a[68:71], v[80:83], v[168:171]
    v_mfma_f32_16x16x32_bf16 v[172:175], a[100:103], v[80:83], v[172:175]
    s_waitcnt lgkmcnt(2)
    v_mfma_f32_16x16x32_bf16 v[176:179], a[4:7], v[84:87], v[176:179]
    v_mfma_f32_16x16x32_bf16 v[180:183], a[36:39], v[84:87], v[180:183]
    v_mfma_f32_16x16x32_bf16 v[184:187], a[68:71], v[84:87], v[184:187]
    v_mfma_f32_16x16x32_bf16 v[188:191], a[100:103], v[84:87], v[188:191]
    s_waitcnt lgkmcnt(0)
    v_mfma_f32_16x16x32_bf16 v[192:195], a[4:7], v[88:91], v[192:195]
    v_mfma_f32_16x16x32_bf16 v[196:199], a[36:39], v[88:91], v[196:199]
    v_mfma_f32_16x16x32_bf16 v[200:203], a[68:71], v[88:91], v[200:203]
    v_mfma_f32_16x16x32_bf16 v[204:207], a[100:103], v[88:91], v[204:207]
    s_waitcnt vmcnt(14)
    s_barrier
    s_add_u32 s41, s39, 143360
    s_add_u32 s42, s40, 61440
    s_mov_b32 m0, s42
    s_nop 0
    buffer_load_dwordx4 v3, s[16:19], s41 offen offset:0 lds
    buffer_load_dwordx4 v3, s[16:19], s41 offen offset:1024 lds
    buffer_load_dwordx4 v3, s[16:19], s41 offen offset:2048 lds
    buffer_load_dwordx4 v3, s[16:19], s41 offen offset:3072 lds
    s_add_u32 s41, s41, 4096
    s_add_u32 s42, s42, 4096
    s_mov_b32 m0, s42
    s_nop 0
    buffer_load_dwordx4 v3, s[16:19], s41 offen offset:0 lds
    buffer_load_dwordx4 v3, s[16:19], s41 offen offset:1024 lds
    buffer_load_dwordx4 v3, s[16:19], s41 offen offset:2048 lds
    v_add_u32 v10, 57344, v5
    ds_read_b64_tr_b16 v[64:65], v10 offset:0
    ds_read_b64_tr_b16 v[66:67], v10 offset:3584
    ds_read_b64_tr_b16 v[68:69], v10 offset:32
    ds_read_b64_tr_b16 v[70:71], v10 offset:3616
    ds_read_b64_tr_b16 v[72:73], v10 offset:64
    ds_read_b64_tr_b16 v[74:75], v10 offset:3648
    ds_read_b64_tr_b16 v[76:77], v10 offset:96
    ds_read_b64_tr_b16 v[78:79], v10 offset:3680
    ds_read_b64_tr_b16 v[80:81], v10 offset:128
    ds_read_b64_tr_b16 v[82:83], v10 offset:3712
    ds_read_b64_tr_b16 v[84:85], v10 offset:160
    ds_read_b64_tr_b16 v[86:87], v10 offset:3744
    ds_read_b64_tr_b16 v[88:89], v10 offset:192
    ds_read_b64_tr_b16 v[90:91], v10 offset:3776
    s_waitcnt lgkmcnt(12)
    v_mfma_f32_16x16x32_bf16 v[96:99], a[8:11], v[64:67], v[96:99]
    v_mfma_f32_16x16x32_bf16 v[100:103], a[40:43], v[64:67], v[100:103]
    v_mfma_f32_16x16x32_bf16 v[104:107], a[72:75], v[64:67], v[104:107]
    v_mfma_f32_16x16x32_bf16 v[108:111], a[104:107], v[64:67], v[108:111]
    s_waitcnt lgkmcnt(10)
    v_mfma_f32_16x16x32_bf16 v[112:115], a[8:11], v[68:71], v[112:115]
    v_mfma_f32_16x16x32_bf16 v[116:119], a[40:43], v[68:71], v[116:119]
    v_mfma_f32_16x16x32_bf16 v[120:123], a[72:75], v[68:71], v[120:123]
    v_mfma_f32_16x16x32_bf16 v[124:127], a[104:107], v[68:71], v[124:127]
    s_waitcnt lgkmcnt(8)
    v_mfma_f32_16x16x32_bf16 v[128:131], a[8:11], v[72:75], v[128:131]
    v_mfma_f32_16x16x32_bf16 v[132:135], a[40:43], v[72:75], v[132:135]
    v_mfma_f32_16x16x32_bf16 v[136:139], a[72:75], v[72:75], v[136:139]
    v_mfma_f32_16x16x32_bf16 v[140:143], a[104:107], v[72:75], v[140:143]
    s_waitcnt lgkmcnt(6)
    v_mfma_f32_16x16x32_bf16 v[144:147], a[8:11], v[76:79], v[144:147]
    v_mfma_f32_16x16x32_bf16 v[148:151], a[40:43], v[76:79], v[148:151]
    v_mfma_f32_16x16x32_bf16 v[152:155], a[72:75], v[76:79], v[152:155]
    v_mfma_f32_16x16x32_bf16 v[156:159], a[104:107], v[76:79], v[156:159]
    s_waitcnt lgkmcnt(4)
    v_mfma_f32_16x16x32_bf16 v[160:163], a[8:11], v[80:83], v[160:163]
    v_mfma_f32_16x16x32_bf16 v[164:167], a[40:43], v[80:83], v[164:167]
    v_mfma_f32_16x16x32_bf16 v[168:171], a[72:75], v[80:83], v[168:171]
    v_mfma_f32_16x16x32_bf16 v[172:175], a[104:107], v[80:83], v[172:175]
    s_waitcnt lgkmcnt(2)
    v_mfma_f32_16x16x32_bf16 v[176:179], a[8:11], v[84:87], v[176:179]
    v_mfma_f32_16x16x32_bf16 v[180:183], a[40:43], v[84:87], v[180:183]
    v_mfma_f32_16x16x32_bf16 v[184:187], a[72:75], v[84:87], v[184:187]
    v_mfma_f32_16x16x32_bf16 v[188:191], a[104:107], v[84:87], v[188:191]
    s_waitcnt lgkmcnt(0)
    v_mfma_f32_16x16x32_bf16 v[192:195], a[8:11], v[88:91], v[192:195]
    v_mfma_f32_16x16x32_bf16 v[196:199], a[40:43], v[88:91], v[196:199]
    v_mfma_f32_16x16x32_bf16 v[200:203], a[72:75], v[88:91], v[200:203]
    v_mfma_f32_16x16x32_bf16 v[204:207], a[104:107], v[88:91], v[204:207]
    s_waitcnt vmcnt(14)
    s_barrier
    s_add_u32 s41, s39, 172032
    s_add_u32 s42, s40, 90112
    s_mov_b32 m0, s42
    s_nop 0
    buffer_load_dwordx4 v3, s[16:19], s41 offen offset:0 lds
    buffer_load_dwordx4 v3, s[16:19], s41 offen offset:1024 lds
    buffer_load_dwordx4 v3, s[16:19], s41 offen offset:2048 lds
    buffer_load_dwordx4 v3, s[16:19], s41 offen offset:3072 lds
    s_add_u32 s41, s41, 4096
    s_add_u32 s42, s42, 4096
    s_mov_b32 m0, s42
    s_nop 0
    buffer_load_dwordx4 v3, s[16:19], s41 offen offset:0 lds
    buffer_load_dwordx4 v3, s[16:19], s41 offen offset:1024 lds
    buffer_load_dwordx4 v3, s[16:19], s41 offen offset:2048 lds
    v_add_u32 v10, 86016, v5
    ds_read_b64_tr_b16 v[64:65], v10 offset:0
    ds_read_b64_tr_b16 v[66:67], v10 offset:3584
    ds_read_b64_tr_b16 v[68:69], v10 offset:32
    ds_read_b64_tr_b16 v[70:71], v10 offset:3616
    ds_read_b64_tr_b16 v[72:73], v10 offset:64
    ds_read_b64_tr_b16 v[74:75], v10 offset:3648
    ds_read_b64_tr_b16 v[76:77], v10 offset:96
    ds_read_b64_tr_b16 v[78:79], v10 offset:3680
    ds_read_b64_tr_b16 v[80:81], v10 offset:128
    ds_read_b64_tr_b16 v[82:83], v10 offset:3712
    ds_read_b64_tr_b16 v[84:85], v10 offset:160
    ds_read_b64_tr_b16 v[86:87], v10 offset:3744
    ds_read_b64_tr_b16 v[88:89], v10 offset:192
    ds_read_b64_tr_b16 v[90:91], v10 offset:3776
    s_waitcnt lgkmcnt(12)
    v_mfma_f32_16x16x32_bf16 v[96:99], a[12:15], v[64:67], v[96:99]
    v_mfma_f32_16x16x32_bf16 v[100:103], a[44:47], v[64:67], v[100:103]
    v_mfma_f32_16x16x32_bf16 v[104:107], a[76:79], v[64:67], v[104:107]
    v_mfma_f32_16x16x32_bf16 v[108:111], a[108:111], v[64:67], v[108:111]
    s_waitcnt lgkmcnt(10)
    v_mfma_f32_16x16x32_bf16 v[112:115], a[12:15], v[68:71], v[112:115]
    v_mfma_f32_16x16x32_bf16 v[116:119], a[44:47], v[68:71], v[116:119]
    v_mfma_f32_16x16x32_bf16 v[120:123], a[76:79], v[68:71], v[120:123]
    v_mfma_f32_16x16x32_bf16 v[124:127], a[108:111], v[68:71], v[124:127]
    s_waitcnt lgkmcnt(8)
    v_mfma_f32_16x16x32_bf16 v[128:131], a[12:15], v[72:75], v[128:131]
    v_mfma_f32_16x16x32_bf16 v[132:135], a[44:47], v[72:75], v[132:135]
    v_mfma_f32_16x16x32_bf16 v[136:139], a[76:79], v[72:75], v[136:139]
    v_mfma_f32_16x16x32_bf16 v[140:143], a[108:111], v[72:75], v[140:143]
    s_waitcnt lgkmcnt(6)
    v_mfma_f32_16x16x32_bf16 v[144:147], a[12:15], v[76:79], v[144:147]
    v_mfma_f32_16x16x32_bf16 v[148:151], a[44:47], v[76:79], v[148:151]
    v_mfma_f32_16x16x32_bf16 v[152:155], a[76:79], v[76:79], v[152:155]
    v_mfma_f32_16x16x32_bf16 v[156:159], a[108:111], v[76:79], v[156:159]
    s_waitcnt lgkmcnt(4)
    v_mfma_f32_16x16x32_bf16 v[160:163], a[12:15], v[80:83], v[160:163]
    v_mfma_f32_16x16x32_bf16 v[164:167], a[44:47], v[80:83], v[164:167]
    v_mfma_f32_16x16x32_bf16 v[168:171], a[76:79], v[80:83], v[168:171]
    v_mfma_f32_16x16x32_bf16 v[172:175], a[108:111], v[80:83], v[172:175]
    s_waitcnt lgkmcnt(2)
    v_mfma_f32_16x16x32_bf16 v[176:179], a[12:15], v[84:87], v[176:179]
    v_mfma_f32_16x16x32_bf16 v[180:183], a[44:47], v[84:87], v[180:183]
    v_mfma_f32_16x16x32_bf16 v[184:187], a[76:79], v[84:87], v[184:187]
    v_mfma_f32_16x16x32_bf16 v[188:191], a[108:111], v[84:87], v[188:191]
    s_waitcnt lgkmcnt(0)
    v_mfma_f32_16x16x32_bf16 v[192:195], a[12:15], v[88:91], v[192:195]
    v_mfma_f32_16x16x32_bf16 v[196:199], a[44:47], v[88:91], v[196:199]
    v_mfma_f32_16x16x32_bf16 v[200:203], a[76:79], v[88:91], v[200:203]
    v_mfma_f32_16x16x32_bf16 v[204:207], a[108:111], v[88:91], v[204:207]
    s_waitcnt vmcnt(14)
    s_barrier
    s_add_u32 s41, s39, 200704
    s_add_u32 s42, s40, 118784
    s_mov_b32 m0, s42
    s_nop 0
    buffer_load_dwordx4 v3, s[16:19], s41 offen offset:0 lds
    buffer_load_dwordx4 v3, s[16:19], s41 offen offset:1024 lds
    buffer_load_dwordx4 v3, s[16:19], s41 offen offset:2048 lds
    buffer_load_dwordx4 v3, s[16:19], s41 offen offset:3072 lds
    s_add_u32 s41, s41, 4096
    s_add_u32 s42, s42, 4096
    s_mov_b32 m0, s42
    s_nop 0
    buffer_load_dwordx4 v3, s[16:19], s41 offen offset:0 lds
    buffer_load_dwordx4 v3, s[16:19], s41 offen offset:1024 lds
    buffer_load_dwordx4 v3, s[16:19], s41 offen offset:2048 lds
    v_add_u32 v10, 0, v5
    ds_read_b64_tr_b16 v[64:65], v10 offset:0
    ds_read_b64_tr_b16 v[66:67], v10 offset:3584
    ds_read_b64_tr_b16 v[68:69], v10 offset:32
    ds_read_b64_tr_b16 v[70:71], v10 offset:3616
    ds_read_b64_tr_b16 v[72:73], v10 offset:64
    ds_read_b64_tr_b16 v[74:75], v10 offset:3648
    ds_read_b64_tr_b16 v[76:77], v10 offset:96
    ds_read_b64_tr_b16 v[78:79], v10 offset:3680
    ds_read_b64_tr_b16 v[80:81], v10 offset:128
    ds_read_b64_tr_b16 v[82:83], v10 offset:3712
    ds_read_b64_tr_b16 v[84:85], v10 offset:160
    ds_read_b64_tr_b16 v[86:87], v10 offset:3744
    ds_read_b64_tr_b16 v[88:89], v10 offset:192
    ds_read_b64_tr_b16 v[90:91], v10 offset:3776
    s_waitcnt lgkmcnt(12)
    v_mfma_f32_16x16x32_bf16 v[96:99], a[16:19], v[64:67], v[96:99]
    v_mfma_f32_16x16x32_bf16 v[100:103], a[48:51], v[64:67], v[100:103]
    v_mfma_f32_16x16x32_bf16 v[104:107], a[80:83], v[64:67], v[104:107]
    v_mfma_f32_16x16x32_bf16 v[108:111], a[112:115], v[64:67], v[108:111]
    s_waitcnt lgkmcnt(10)
    v_mfma_f32_16x16x32_bf16 v[112:115], a[16:19], v[68:71], v[112:115]
    v_mfma_f32_16x16x32_bf16 v[116:119], a[48:51], v[68:71], v[116:119]
    v_mfma_f32_16x16x32_bf16 v[120:123], a[80:83], v[68:71], v[120:123]
    v_mfma_f32_16x16x32_bf16 v[124:127], a[112:115], v[68:71], v[124:127]
    s_waitcnt lgkmcnt(8)
    v_mfma_f32_16x16x32_bf16 v[128:131], a[16:19], v[72:75], v[128:131]
    v_mfma_f32_16x16x32_bf16 v[132:135], a[48:51], v[72:75], v[132:135]
    v_mfma_f32_16x16x32_bf16 v[136:139], a[80:83], v[72:75], v[136:139]
    v_mfma_f32_16x16x32_bf16 v[140:143], a[112:115], v[72:75], v[140:143]
    s_waitcnt lgkmcnt(6)
    v_mfma_f32_16x16x32_bf16 v[144:147], a[16:19], v[76:79], v[144:147]
    v_mfma_f32_16x16x32_bf16 v[148:151], a[48:51], v[76:79], v[148:151]
    v_mfma_f32_16x16x32_bf16 v[152:155], a[80:83], v[76:79], v[152:155]
    v_mfma_f32_16x16x32_bf16 v[156:159], a[112:115], v[76:79], v[156:159]
    s_waitcnt lgkmcnt(4)
    v_mfma_f32_16x16x32_bf16 v[160:163], a[16:19], v[80:83], v[160:163]
    v_mfma_f32_16x16x32_bf16 v[164:167], a[48:51], v[80:83], v[164:167]
    v_mfma_f32_16x16x32_bf16 v[168:171], a[80:83], v[80:83], v[168:171]
    v_mfma_f32_16x16x32_bf16 v[172:175], a[112:115], v[80:83], v[172:175]
    s_waitcnt lgkmcnt(2)
    v_mfma_f32_16x16x32_bf16 v[176:179], a[16:19], v[84:87], v[176:179]
    v_mfma_f32_16x16x32_bf16 v[180:183], a[48:51], v[84:87], v[180:183]
    v_mfma_f32_16x16x32_bf16 v[184:187], a[80:83], v[84:87], v[184:187]
    v_mfma_f32_16x16x32_bf16 v[188:191], a[112:115], v[84:87], v[188:191]
    s_waitcnt lgkmcnt(0)
    v_mfma_f32_16x16x32_bf16 v[192:195], a[16:19], v[88:91], v[192:195]
    v_mfma_f32_16x16x32_bf16 v[196:199], a[48:51], v[88:91], v[196:199]
    v_mfma_f32_16x16x32_bf16 v[200:203], a[80:83], v[88:91], v[200:203]
    v_mfma_f32_16x16x32_bf16 v[204:207], a[112:115], v[88:91], v[204:207]
    s_waitcnt vmcnt(14)
    s_barrier
    v_add_u32 v10, 28672, v5
    ds_read_b64_tr_b16 v[64:65], v10 offset:0
    ds_read_b64_tr_b16 v[66:67], v10 offset:3584
    ds_read_b64_tr_b16 v[68:69], v10 offset:32
    ds_read_b64_tr_b16 v[70:71], v10 offset:3616
    ds_read_b64_tr_b16 v[72:73], v10 offset:64
    ds_read_b64_tr_b16 v[74:75], v10 offset:3648
    ds_read_b64_tr_b16 v[76:77], v10 offset:96
    ds_read_b64_tr_b16 v[78:79], v10 offset:3680
    ds_read_b64_tr_b16 v[80:81], v10 offset:128
    ds_read_b64_tr_b16 v[82:83], v10 offset:3712
    ds_read_b64_tr_b16 v[84:85], v10 offset:160
    ds_read_b64_tr_b16 v[86:87], v10 offset:3744
    ds_read_b64_tr_b16 v[88:89], v10 offset:192
    ds_read_b64_tr_b16 v[90:91], v10 offset:3776
    s_waitcnt lgkmcnt(12)
    v_mfma_f32_16x16x32_bf16 v[96:99], a[20:23], v[64:67], v[96:99]
    v_mfma_f32_16x16x32_bf16 v[100:103], a[52:55], v[64:67], v[100:103]
    v_mfma_f32_16x16x32_bf16 v[104:107], a[84:87], v[64:67], v[104:107]
    v_mfma_f32_16x16x32_bf16 v[108:111], a[116:119], v[64:67], v[108:111]
    s_waitcnt lgkmcnt(10)
    v_mfma_f32_16x16x32_bf16 v[112:115], a[20:23], v[68:71], v[112:115]
    v_mfma_f32_16x16x32_bf16 v[116:119], a[52:55], v[68:71], v[116:119]
    v_mfma_f32_16x16x32_bf16 v[120:123], a[84:87], v[68:71], v[120:123]
    v_mfma_f32_16x16x32_bf16 v[124:127], a[116:119], v[68:71], v[124:127]
    s_waitcnt lgkmcnt(8)
    v_mfma_f32_16x16x32_bf16 v[128:131], a[20:23], v[72:75], v[128:131]
    v_mfma_f32_16x16x32_bf16 v[132:135], a[52:55], v[72:75], v[132:135]
    v_mfma_f32_16x16x32_bf16 v[136:139], a[84:87], v[72:75], v[136:139]
    v_mfma_f32_16x16x32_bf16 v[140:143], a[116:119], v[72:75], v[140:143]
    s_waitcnt lgkmcnt(6)
    v_mfma_f32_16x16x32_bf16 v[144:147], a[20:23], v[76:79], v[144:147]
    v_mfma_f32_16x16x32_bf16 v[148:151], a[52:55], v[76:79], v[148:151]
    v_mfma_f32_16x16x32_bf16 v[152:155], a[84:87], v[76:79], v[152:155]
    v_mfma_f32_16x16x32_bf16 v[156:159], a[116:119], v[76:79], v[156:159]
    s_waitcnt lgkmcnt(4)
    v_mfma_f32_16x16x32_bf16 v[160:163], a[20:23], v[80:83], v[160:163]
    v_mfma_f32_16x16x32_bf16 v[164:167], a[52:55], v[80:83], v[164:167]
    v_mfma_f32_16x16x32_bf16 v[168:171], a[84:87], v[80:83], v[168:171]
    v_mfma_f32_16x16x32_bf16 v[172:175], a[116:119], v[80:83], v[172:175]
    s_waitcnt lgkmcnt(2)
    v_mfma_f32_16x16x32_bf16 v[176:179], a[20:23], v[84:87], v[176:179]
    v_mfma_f32_16x16x32_bf16 v[180:183], a[52:55], v[84:87], v[180:183]
    v_mfma_f32_16x16x32_bf16 v[184:187], a[84:87], v[84:87], v[184:187]
    v_mfma_f32_16x16x32_bf16 v[188:191], a[116:119], v[84:87], v[188:191]
    s_waitcnt lgkmcnt(0)
    v_mfma_f32_16x16x32_bf16 v[192:195], a[20:23], v[88:91], v[192:195]
    v_mfma_f32_16x16x32_bf16 v[196:199], a[52:55], v[88:91], v[196:199]
    v_mfma_f32_16x16x32_bf16 v[200:203], a[84:87], v[88:91], v[200:203]
    v_mfma_f32_16x16x32_bf16 v[204:207], a[116:119], v[88:91], v[204:207]
    v_lshlrev_b32 v14, 5, v0
    v_mov_b32 v15, 16
    v_cmp_lt_u32 vcc, 7, v0
    s_nop 1
    v_cndmask_b32 v14, v14, v15, vcc
    buffer_load_dword a251, v14, s[92:95], 0 offen sc1
    s_waitcnt vmcnt(8)
    s_barrier
    v_add_u32 v10, 57344, v5
    ds_read_b64_tr_b16 v[64:65], v10 offset:0
    ds_read_b64_tr_b16 v[66:67], v10 offset:3584
    ds_read_b64_tr_b16 v[68:69], v10 offset:32
    ds_read_b64_tr_b16 v[70:71], v10 offset:3616
    ds_read_b64_tr_b16 v[72:73], v10 offset:64
    ds_read_b64_tr_b16 v[74:75], v10 offset:3648
    ds_read_b64_tr_b16 v[76:77], v10 offset:96
    ds_read_b64_tr_b16 v[78:79], v10 offset:3680
    ds_read_b64_tr_b16 v[80:81], v10 offset:128
    ds_read_b64_tr_b16 v[82:83], v10 offset:3712
    ds_read_b64_tr_b16 v[84:85], v10 offset:160
    ds_read_b64_tr_b16 v[86:87], v10 offset:3744
    ds_read_b64_tr_b16 v[88:89], v10 offset:192
    ds_read_b64_tr_b16 v[90:91], v10 offset:3776
    s_waitcnt lgkmcnt(12)
    v_mfma_f32_16x16x32_bf16 v[96:99], a[24:27], v[64:67], v[96:99]
    v_mfma_f32_16x16x32_bf16 v[100:103], a[56:59], v[64:67], v[100:103]
    v_mfma_f32_16x16x32_bf16 v[104:107], a[88:91], v[64:67], v[104:107]
    v_mfma_f32_16x16x32_bf16 v[108:111], a[120:123], v[64:67], v[108:111]
    s_waitcnt lgkmcnt(10)
    v_mfma_f32_16x16x32_bf16 v[112:115], a[24:27], v[68:71], v[112:115]
    v_mfma_f32_16x16x32_bf16 v[116:119], a[56:59], v[68:71], v[116:119]
    v_mfma_f32_16x16x32_bf16 v[120:123], a[88:91], v[68:71], v[120:123]
    v_mfma_f32_16x16x32_bf16 v[124:127], a[120:123], v[68:71], v[124:127]
    s_waitcnt lgkmcnt(8)
    v_mfma_f32_16x16x32_bf16 v[128:131], a[24:27], v[72:75], v[128:131]
    v_mfma_f32_16x16x32_bf16 v[132:135], a[56:59], v[72:75], v[132:135]
    v_mfma_f32_16x16x32_bf16 v[136:139], a[88:91], v[72:75], v[136:139]
    v_mfma_f32_16x16x32_bf16 v[140:143], a[120:123], v[72:75], v[140:143]
    s_waitcnt lgkmcnt(6)
    v_mfma_f32_16x16x32_bf16 v[144:147], a[24:27], v[76:79], v[144:147]
    v_mfma_f32_16x16x32_bf16 v[148:151], a[56:59], v[76:79], v[148:151]
    v_mfma_f32_16x16x32_bf16 v[152:155], a[88:91], v[76:79], v[152:155]
    v_mfma_f32_16x16x32_bf16 v[156:159], a[120:123], v[76:79], v[156:159]
    s_waitcnt lgkmcnt(4)
    v_mfma_f32_16x16x32_bf16 v[160:163], a[24:27], v[80:83], v[160:163]
    v_mfma_f32_16x16x32_bf16 v[164:167], a[56:59], v[80:83], v[164:167]
    v_mfma_f32_16x16x32_bf16 v[168:171], a[88:91], v[80:83], v[168:171]
    v_mfma_f32_16x16x32_bf16 v[172:175], a[120:123], v[80:83], v[172:175]
    s_waitcnt lgkmcnt(2)
    v_mfma_f32_16x16x32_bf16 v[176:179], a[24:27], v[84:87], v[176:179]
    v_mfma_f32_16x16x32_bf16 v[180:183], a[56:59], v[84:87], v[180:183]
    v_mfma_f32_16x16x32_bf16 v[184:187], a[88:91], v[84:87], v[184:187]
    v_mfma_f32_16x16x32_bf16 v[188:191], a[120:123], v[84:87], v[188:191]
    s_waitcnt lgkmcnt(0)
    v_mfma_f32_16x16x32_bf16 v[192:195], a[24:27], v[88:91], v[192:195]
    v_mfma_f32_16x16x32_bf16 v[196:199], a[56:59], v[88:91], v[196:199]
    v_mfma_f32_16x16x32_bf16 v[200:203], a[88:91], v[88:91], v[200:203]
    v_mfma_f32_16x16x32_bf16 v[204:207], a[120:123], v[88:91], v[204:207]
    s_waitcnt vmcnt(1)
    s_barrier
    v_add_u32 v10, 86016, v5
    ds_read_b64_tr_b16 v[64:65], v10 offset:0
    ds_read_b64_tr_b16 v[66:67], v10 offset:3584
    ds_read_b64_tr_b16 v[68:69], v10 offset:32
    ds_read_b64_tr_b16 v[70:71], v10 offset:3616
    ds_read_b64_tr_b16 v[72:73], v10 offset:64
    ds_read_b64_tr_b16 v[74:75], v10 offset:3648
    ds_read_b64_tr_b16 v[76:77], v10 offset:96
    ds_read_b64_tr_b16 v[78:79], v10 offset:3680
    ds_read_b64_tr_b16 v[80:81], v10 offset:128
    ds_read_b64_tr_b16 v[82:83], v10 offset:3712
    ds_read_b64_tr_b16 v[84:85], v10 offset:160
    ds_read_b64_tr_b16 v[86:87], v10 offset:3744
    ds_read_b64_tr_b16 v[88:89], v10 offset:192
    ds_read_b64_tr_b16 v[90:91], v10 offset:3776
    s_waitcnt lgkmcnt(12)
    v_mfma_f32_16x16x32_bf16 v[96:99], a[28:31], v[64:67], v[96:99]
    v_mfma_f32_16x16x32_bf16 v[100:103], a[60:63], v[64:67], v[100:103]
    v_mfma_f32_16x16x32_bf16 v[104:107], a[92:95], v[64:67], v[104:107]
    v_mfma_f32_16x16x32_bf16 v[108:111], a[124:127], v[64:67], v[108:111]
    s_waitcnt lgkmcnt(10)
    v_mfma_f32_16x16x32_bf16 v[112:115], a[28:31], v[68:71], v[112:115]
    v_mfma_f32_16x16x32_bf16 v[116:119], a[60:63], v[68:71], v[116:119]
    v_mfma_f32_16x16x32_bf16 v[120:123], a[92:95], v[68:71], v[120:123]
    v_mfma_f32_16x16x32_bf16 v[124:127], a[124:127], v[68:71], v[124:127]
    s_waitcnt lgkmcnt(8)
    v_mfma_f32_16x16x32_bf16 v[128:131], a[28:31], v[72:75], v[128:131]
    v_mfma_f32_16x16x32_bf16 v[132:135], a[60:63], v[72:75], v[132:135]
    v_mfma_f32_16x16x32_bf16 v[136:139], a[92:95], v[72:75], v[136:139]
    v_mfma_f32_16x16x32_bf16 v[140:143], a[124:127], v[72:75], v[140:143]
    s_waitcnt lgkmcnt(6)
    v_mfma_f32_16x16x32_bf16 v[144:147], a[28:31], v[76:79], v[144:147]
    v_mfma_f32_16x16x32_bf16 v[148:151], a[60:63], v[76:79], v[148:151]
    v_mfma_f32_16x16x32_bf16 v[152:155], a[92:95], v[76:79], v[152:155]
    v_mfma_f32_16x16x32_bf16 v[156:159], a[124:127], v[76:79], v[156:159]
    s_waitcnt lgkmcnt(4)
    v_mfma_f32_16x16x32_bf16 v[160:163], a[28:31], v[80:83], v[160:163]
    v_mfma_f32_16x16x32_bf16 v[164:167], a[60:63], v[80:83], v[164:167]
    v_mfma_f32_16x16x32_bf16 v[168:171], a[92:95], v[80:83], v[168:171]
    v_mfma_f32_16x16x32_bf16 v[172:175], a[124:127], v[80:83], v[172:175]
    s_waitcnt lgkmcnt(2)
    v_mfma_f32_16x16x32_bf16 v[176:179], a[28:31], v[84:87], v[176:179]
    v_mfma_f32_16x16x32_bf16 v[180:183], a[60:63], v[84:87], v[180:183]
    v_mfma_f32_16x16x32_bf16 v[184:187], a[92:95], v[84:87], v[184:187]
    v_mfma_f32_16x16x32_bf16 v[188:191], a[124:127], v[84:87], v[188:191]
    s_waitcnt lgkmcnt(0)
    v_mfma_f32_16x16x32_bf16 v[192:195], a[28:31], v[88:91], v[192:195]
    v_mfma_f32_16x16x32_bf16 v[196:199], a[60:63], v[88:91], v[196:199]
    v_mfma_f32_16x16x32_bf16 v[200:203], a[92:95], v[88:91], v[200:203]
    v_mfma_f32_16x16x32_bf16 v[204:207], a[124:127], v[88:91], v[204:207]
    v_cvt_pk_bf16_f32 v208, v96, v97
    v_cvt_pk_bf16_f32 v209, v98, v99
    v_cvt_pk_bf16_f32 v210, v100, v101
    v_cvt_pk_bf16_f32 v211, v102, v103
    v_cvt_pk_bf16_f32 v212, v104, v105
    v_cvt_pk_bf16_f32 v213, v106, v107
    v_cvt_pk_bf16_f32 v214, v108, v109
    v_cvt_pk_bf16_f32 v215, v110, v111
    s_add_u32 s37, s36, 0
    buffer_store_dwordx4 v[208:211], v3, s[8:11], s37 offen sc1
    buffer_store_dwordx4 v[212:215], v3, s[8:11], s37 offen offset:1024 sc1
    v_cvt_pk_bf16_f32 v216, v112, v113
    v_cvt_pk_bf16_f32 v217, v114, v115
    v_cvt_pk_bf16_f32 v218, v116, v117
    v_cvt_pk_bf16_f32 v219, v118, v119
    v_cvt_pk_bf16_f32 v220, v120, v121
    v_cvt_pk_bf16_f32 v221, v122, v123
    v_cvt_pk_bf16_f32 v222, v124, v125
    v_cvt_pk_bf16_f32 v223, v126, v127
    s_add_u32 s37, s36, 14336
    buffer_store_dwordx4 v[216:219], v3, s[8:11], s37 offen sc1
    buffer_store_dwordx4 v[220:223], v3, s[8:11], s37 offen offset:1024 sc1
    v_cvt_pk_bf16_f32 v224, v128, v129
    v_cvt_pk_bf16_f32 v225, v130, v131
    v_cvt_pk_bf16_f32 v226, v132, v133
    v_cvt_pk_bf16_f32 v227, v134, v135
    v_cvt_pk_bf16_f32 v228, v136, v137
    v_cvt_pk_bf16_f32 v229, v138, v139
    v_cvt_pk_bf16_f32 v230, v140, v141
    v_cvt_pk_bf16_f32 v231, v142, v143
    s_add_u32 s37, s36, 28672
    buffer_store_dwordx4 v[224:227], v3, s[8:11], s37 offen sc1
    buffer_store_dwordx4 v[228:231], v3, s[8:11], s37 offen offset:1024 sc1
    v_cvt_pk_bf16_f32 v232, v144, v145
    v_cvt_pk_bf16_f32 v233, v146, v147
    v_cvt_pk_bf16_f32 v234, v148, v149
    v_cvt_pk_bf16_f32 v235, v150, v151
    v_cvt_pk_bf16_f32 v236, v152, v153
    v_cvt_pk_bf16_f32 v237, v154, v155
    v_cvt_pk_bf16_f32 v238, v156, v157
    v_cvt_pk_bf16_f32 v239, v158, v159
    s_add_u32 s37, s36, 43008
    buffer_store_dwordx4 v[232:235], v3, s[8:11], s37 offen sc1
    buffer_store_dwordx4 v[236:239], v3, s[8:11], s37 offen offset:1024 sc1
    v_cvt_pk_bf16_f32 v208, v160, v161
    v_cvt_pk_bf16_f32 v209, v162, v163
    v_cvt_pk_bf16_f32 v210, v164, v165
    v_cvt_pk_bf16_f32 v211, v166, v167
    v_cvt_pk_bf16_f32 v212, v168, v169
    v_cvt_pk_bf16_f32 v213, v170, v171
    v_cvt_pk_bf16_f32 v214, v172, v173
    v_cvt_pk_bf16_f32 v215, v174, v175
    s_add_u32 s37, s36, 57344
    buffer_store_dwordx4 v[208:211], v3, s[8:11], s37 offen sc1
    buffer_store_dwordx4 v[212:215], v3, s[8:11], s37 offen offset:1024 sc1
    v_cvt_pk_bf16_f32 v216, v176, v177
    v_cvt_pk_bf16_f32 v217, v178, v179
    v_cvt_pk_bf16_f32 v218, v180, v181
    v_cvt_pk_bf16_f32 v219, v182, v183
    v_cvt_pk_bf16_f32 v220, v184, v185
    v_cvt_pk_bf16_f32 v221, v186, v187
    v_cvt_pk_bf16_f32 v222, v188, v189
    v_cvt_pk_bf16_f32 v223, v190, v191
    s_add_u32 s37, s36, 71680
    buffer_store_dwordx4 v[216:219], v3, s[8:11], s37 offen sc1
    buffer_store_dwordx4 v[220:223], v3, s[8:11], s37 offen offset:1024 sc1
    v_cvt_pk_bf16_f32 v224, v192, v193
    v_cvt_pk_bf16_f32 v225, v194, v195
    v_cvt_pk_bf16_f32 v226, v196, v197
    v_cvt_pk_bf16_f32 v227, v198, v199
    v_cvt_pk_bf16_f32 v228, v200, v201
    v_cvt_pk_bf16_f32 v229, v202, v203
    v_cvt_pk_bf16_f32 v230, v204, v205
    v_cvt_pk_bf16_f32 v231, v206, v207
    s_add_u32 s37, s36, 86016
    buffer_store_dwordx4 v[224:227], v3, s[8:11], s37 offen sc1
    buffer_store_dwordx4 v[228:231], v3, s[8:11], s37 offen offset:1024 sc1
    s_branch P_done
P_ln:
    s_cmp_eq_u32 s2, 0
    s_cbranch_scc0 P_ln2
    v_lshlrev_b32 v3, 4, v0
    v_mov_b32 v16, -1
    v_mov_b32 v17, -1
    v_mov_b32 v18, -1
    v_mov_b32 v19, -1
    v_mov_b32 v20, 0
    v_mov_b32 v21, 0
    v_mov_b32 v22, 0
    v_mov_b32 v23, 0
    s_lshl_b32 s33, s3, 10
    s_add_u32 s32, s33, 0
    buffer_store_dwordx4 v[20:23], v3, s[8:11], s32 offen sc1
    s_add_u32 s32, s33, 4096
    buffer_store_dwordx4 v[20:23], v3, s[8:11], s32 offen sc1
    s_add_u32 s32, s33, 8192
    buffer_store_dwordx4 v[20:23], v3, s[8:11], s32 offen sc1
    s_add_u32 s32, s33, 12288
    buffer_store_dwordx4 v[20:23], v3, s[8:11], s32 offen sc1
    s_add_u32 s32, s33, 16384
    buffer_store_dwordx4 v[20:23], v3, s[8:11], s32 offen sc1
    s_add_u32 s32, s33, 20480
    buffer_store_dwordx4 v[20:23], v3, s[8:11], s32 offen sc1
    s_add_u32 s32, s33, 24576
    buffer_store_dwordx4 v[20:23], v3, s[8:11], s32 offen sc1
    s_add_u32 s32, s33, 28672
    buffer_store_dwordx4 v[20:23], v3, s[8:11], s32 offen sc1
    s_add_u32 s32, s33, 32768
    buffer_store_dwordx4 v[20:23], v3, s[8:11], s32 offen sc1
    s_add_u32 s32, s33, 36864
    buffer_store_dwordx4 v[20:23], v3, s[8:11], s32 offen sc1
    s_add_u32 s32, s33, 40960
    buffer_store_dwordx4 v[20:23], v3, s[8:11], s32 offen sc1
    s_add_u32 s32, s33, 45056
    buffer_store_dwordx4 v[20:23], v3, s[8:11], s32 offen sc1
    s_add_u32 s32, s33, 49152
    buffer_store_dwordx4 v[20:23], v3, s[8:11], s32 offen sc1
    s_add_u32 s32, s33, 53248
    buffer_store_dwordx4 v[20:23], v3, s[8:11], s32 offen sc1
    s_add_u32 s32, s33, 57344
    buffer_store_dwordx4 v[20:23], v3, s[8:11], s32 offen sc1
    s_add_u32 s32, s33, 61440
    buffer_store_dwordx4 v[20:23], v3, s[8:11], s32 offen sc1
    s_add_u32 s32, s33, 65536
    buffer_store_dwordx4 v[20:23], v3, s[8:11], s32 offen sc1
    s_add_u32 s32, s33, 69632
    buffer_store_dwordx4 v[20:23], v3, s[8:11], s32 offen sc1
    s_waitcnt vmcnt(0)
    s_barrier
    s_cmp_eq_u32 s3, 0
    s_cbranch_scc0 P_ln2
    v_mov_b32 v6, 0
    v_mov_b32 v7, 1
    s_mov_b64 exec, 1
    buffer_store_dword v7, v6, s[92:95], 0 offen offset:16 sc1
    s_mov_b64 exec, -1
P_ln2:
    s_lshl_b32 s30, s29, 2
    s_add_u32 s30, s30, s3
    s_lshr_b32 s78, s30, 4
    s_lshl_b32 s78, s78, 4
    s_add_u32 s78, s78, 512
    v_and_b32 v6, 15, v0
    v_lshrrev_b32 v7, 4, v0
    s_lshl_b32 s32, s30, 4
    v_add_u32 v1, s32, v6
    v_mul_u32_u24 v1, 896, v1
    v_lshl_add_u32 v1, v7, 3, v1
    v_lshlrev_b32 v3, 4, v0
    buffer_load_dwordx2 v[8:9], v1, s[20:23], 0 offen offset:0
    buffer_load_dwordx2 v[10:11], v1, s[20:23], 0 offen offset:32
    buffer_load_dwordx2 v[12:13], v1, s[20:23], 0 offen offset:64
    buffer_load_dwordx2 v[14:15], v1, s[20:23], 0 offen offset:96
    buffer_load_dwordx2 v[16:17], v1, s[20:23], 0 offen offset:128
    buffer_load_dwordx2 v[18:19], v1, s[20:23], 0 offen offset:160
    buffer_load_dwordx2 v[20:21], v1, s[20:23], 0 offen offset:192
    buffer_load_dwordx2 v[22:23], v1, s[20:23], 0 offen offset:224
    buffer_load_dwordx2 v[24:25], v1, s[20:23], 0 offen offset:256
    buffer_load_dwordx2 v[26:27], v1, s[20:23], 0 offen offset:288
    buffer_load_dwordx2 v[28:29], v1, s[20:23], 0 offen offset:320
    buffer_load_dwordx2 v[30:31], v1, s[20:23], 0 offen offset:352
    buffer_load_dwordx2 v[32:33], v1, s[20:23], 0 offen offset:384
    buffer_load_dwordx2 v[34:35], v1, s[20:23], 0 offen offset:416
    buffer_load_dwordx2 v[36:37], v1, s[20:23], 0 offen offset:448
    buffer_load_dwordx2 v[38:39], v1, s[20:23], 0 offen offset:480
    buffer_load_dwordx2 v[40:41], v1, s[20:23], 0 offen offset:512
    buffer_load_dwordx2 v[42:43], v1, s[20:23], 0 offen offset:544
    buffer_load_dwordx2 v[44:45], v1, s[20:23], 0 offen offset:576
    buffer_load_dwordx2 v[46:47], v1, s[20:23], 0 offen offset:608
    buffer_load_dwordx2 v[48:49], v1, s[20:23], 0 offen offset:640
    buffer_load_dwordx2 v[50:51], v1, s[20:23], 0 offen offset:672
    buffer_load_dwordx2 v[52:53], v1, s[20:23], 0 offen offset:704
    buffer_load_dwordx2 v[54:55], v1, s[20:23], 0 offen offset:736
    buffer_load_dwordx2 v[56:57], v1, s[20:23], 0 offen offset:768
    buffer_load_dwordx2 v[58:59], v1, s[20:23], 0 offen offset:800
    buffer_load_dwordx2 v[60:61], v1, s[20:23], 0 offen offset:832
    buffer_load_dwordx2 v[62:63], v1, s[20:23], 0 offen offset:864
    v_mov_b32 v200, -1
    v_mov_b32 v201, -1
    v_mov_b32 v202, -1
    v_mov_b32 v203, -1
    s_lshr_b32 s32, s30, 1
    s_and_b32 s33, s30, 1
    s_lshl_b32 s34, s32, 13
    s_lshl_b32 s33, s33, 12
    s_add_u32 s34, s34, s33
    s_add_u32 s34, s34, 23068672
    s_cmp_eq_u32 s32, 0
    s_cbranch_scc1 Lnh_2
    buffer_store_dwordx4 v[200:203], v3, s[8:11], s34 offen sc1
    buffer_store_dwordx4 v[200:203], v3, s[8:11], s34 offen offset:1024 sc1
    buffer_store_dwordx4 v[200:203], v3, s[8:11], s34 offen offset:2048 sc1
    buffer_store_dwordx4 v[200:203], v3, s[8:11], s34 offen offset:3072 sc1
Lnh_2:
    s_mov_b32 s34, 0x3727c5ac
    s_mov_b32 s35, 0x3b124925
    s_waitcnt vmcnt(0)
    v_lshlrev_b32 v72, 16, v8
    v_and_b32 v73, 0xffff0000, v8
    v_lshlrev_b32 v74, 16, v9
    v_and_b32 v75, 0xffff0000, v9
    v_lshlrev_b32 v76, 16, v10
    v_and_b32 v77, 0xffff0000, v10
    v_lshlrev_b32 v78, 16, v11
    v_and_b32 v79, 0xffff0000, v11
    v_lshlrev_b32 v80, 16, v12
    v_and_b32 v81, 0xffff0000, v12
    v_lshlrev_b32 v82, 16, v13
    v_and_b32 v83, 0xffff0000, v13
    v_lshlrev_b32 v84, 16, v14
    v_and_b32 v85, 0xffff0000, v14
    v_lshlrev_b32 v86, 16, v15
    v_and_b32 v87, 0xffff0000, v15
    v_lshlrev_b32 v88, 16, v16
    v_and_b32 v89, 0xffff0000, v16
    v_lshlrev_b32 v90, 16, v17
    v_and_b32 v91, 0xffff0000, v17
    v_lshlrev_b32 v92, 16, v18
    v_and_b32 v93, 0xffff0000, v18
    v_lshlrev_b32 v94, 16, v19
    v_and_b32 v95, 0xffff0000, v19
    v_lshlrev_b32 v96, 16, v20
    v_and_b32 v97, 0xffff0000, v20
    v_lshlrev_b32 v98, 16, v21
    v_and_b32 v99, 0xffff0000, v21
    v_lshlrev_b32 v100, 16, v22
    v_and_b32 v101, 0xffff0000, v22
    v_lshlrev_b32 v102, 16, v23
    v_and_b32 v103, 0xffff0000, v23
    v_lshlrev_b32 v104, 16, v24
    v_and_b32 v105, 0xffff0000, v24
    v_lshlrev_b32 v106, 16, v25
    v_and_b32 v107, 0xffff0000, v25
    v_lshlrev_b32 v108, 16, v26
    v_and_b32 v109, 0xffff0000, v26
    v_lshlrev_b32 v110, 16, v27
    v_and_b32 v111, 0xffff0000, v27
    v_lshlrev_b32 v112, 16, v28
    v_and_b32 v113, 0xffff0000, v28
    v_lshlrev_b32 v114, 16, v29
    v_and_b32 v115, 0xffff0000, v29
    v_lshlrev_b32 v116, 16, v30
    v_and_b32 v117, 0xffff0000, v30
    v_lshlrev_b32 v118, 16, v31
    v_and_b32 v119, 0xffff0000, v31
    v_lshlrev_b32 v120, 16, v32
    v_and_b32 v121, 0xffff0000, v32
    v_lshlrev_b32 v122, 16, v33
    v_and_b32 v123, 0xffff0000, v33
    v_lshlrev_b32 v124, 16, v34
    v_and_b32 v125, 0xffff0000, v34
    v_lshlrev_b32 v126, 16, v35
    v_and_b32 v127, 0xffff0000, v35
    v_lshlrev_b32 v128, 16, v36
    v_and_b32 v129, 0xffff0000, v36
    v_lshlrev_b32 v130, 16, v37
    v_and_b32 v131, 0xffff0000, v37
    v_lshlrev_b32 v132, 16, v38
    v_and_b32 v133, 0xffff0000, v38
    v_lshlrev_b32 v134, 16, v39
    v_and_b32 v135, 0xffff0000, v39
    v_lshlrev_b32 v136, 16, v40
    v_and_b32 v137, 0xffff0000, v40
    v_lshlrev_b32 v138, 16, v41
    v_and_b32 v139, 0xffff0000, v41
    v_lshlrev_b32 v140, 16, v42
    v_and_b32 v141, 0xffff0000, v42
    v_lshlrev_b32 v142, 16, v43
    v_and_b32 v143, 0xffff0000, v43
    v_lshlrev_b32 v144, 16, v44
    v_and_b32 v145, 0xffff0000, v44
    v_lshlrev_b32 v146, 16, v45
    v_and_b32 v147, 0xffff0000, v45
    v_lshlrev_b32 v148, 16, v46
    v_and_b32 v149, 0xffff0000, v46
    v_lshlrev_b32 v150, 16, v47
    v_and_b32 v151, 0xffff0000, v47
    v_lshlrev_b32 v152, 16, v48
    v_and_b32 v153, 0xffff0000, v48
    v_lshlrev_b32 v154, 16, v49
    v_and_b32 v155, 0xffff0000, v49
    v_lshlrev_b32 v156, 16, v50
    v_and_b32 v157, 0xffff0000, v50
    v_lshlrev_b32 v158, 16, v51
    v_and_b32 v159, 0xffff0000, v51
    v_lshlrev_b32 v160, 16, v52
    v_and_b32 v161, 0xffff0000, v52
    v_lshlrev_b32 v162, 16, v53
    v_and_b32 v163, 0xffff0000, v53
    v_lshlrev_b32 v164, 16, v54
    v_and_b32 v165, 0xffff0000, v54
    v_lshlrev_b32 v166, 16, v55
    v_and_b32 v167, 0xffff0000, v55
    v_lshlrev_b32 v168, 16, v56
    v_and_b32 v169, 0xffff0000, v56
    v_lshlrev_b32 v170, 16, v57
    v_and_b32 v171, 0xffff0000, v57
    v_lshlrev_b32 v172, 16, v58
    v_and_b32 v173, 0xffff0000, v58
    v_lshlrev_b32 v174, 16, v59
    v_and_b32 v175, 0xffff0000, v59
    v_lshlrev_b32 v176, 16, v60
    v_and_b32 v177, 0xffff0000, v60
    v_lshlrev_b32 v178, 16, v61
    v_and_b32 v179, 0xffff0000, v61
    v_lshlrev_b32 v180, 16, v62
    v_and_b32 v181, 0xffff0000, v62
    v_lshlrev_b32 v182, 16, v63
    v_and_b32 v183, 0xffff0000, v63
    v_add_f32 v184, v72, v76
    v_add_f32 v188, v73, v77
    v_add_f32 v189, v74, v78
    v_add_f32 v187, v75, v79
    v_add_f32 v184, v184, v80
    v_add_f32 v188, v188, v81
    v_add_f32 v189, v189, v82
    v_add_f32 v187, v187, v83
    v_add_f32 v184, v184, v84
    v_add_f32 v188, v188, v85
    v_add_f32 v189, v189, v86
    v_add_f32 v187, v187, v87
    v_add_f32 v184, v184, v88
    v_add_f32 v188, v188, v89
    v_add_f32 v189, v189, v90
    v_add_f32 v187, v187, v91
    v_add_f32 v184, v184, v92
    v_add_f32 v188, v188, v93
    v_add_f32 v189, v189, v94
    v_add_f32 v187, v187, v95
    v_add_f32 v184, v184, v96
    v_add_f32 v188, v188, v97
    v_add_f32 v189, v189, v98
    v_add_f32 v187, v187, v99
    v_add_f32 v184, v184, v100
    v_add_f32 v188, v188, v101
    v_add_f32 v189, v189, v102
    v_add_f32 v187, v187, v103
    v_add_f32 v184, v184, v104
    v_add_f32 v188, v188, v105
    v_add_f32 v189, v189, v106
    v_add_f32 v187, v187, v107
    v_add_f32 v184, v184, v108
    v_add_f32 v188, v188, v109
    v_add_f32 v189, v189, v110
    v_add_f32 v187, v187, v111
    v_add_f32 v184, v184, v112
    v_add_f32 v188, v188, v113
    v_add_f32 v189, v189, v114
    v_add_f32 v187, v187, v115
    v_add_f32 v184, v184, v116
    v_add_f32 v188, v188, v117
    v_add_f32 v189, v189, v118
    v_add_f32 v187, v187, v119
    v_add_f32 v184, v184, v120
    v_add_f32 v188, v188, v121
    v_add_f32 v189, v189, v122
    v_add_f32 v187, v187, v123
    v_add_f32 v184, v184, v124
    v_add_f32 v188, v188, v125
    v_add_f32 v189, v189, v126
    v_add_f32 v187, v187, v127
    v_add_f32 v184, v184, v128
    v_add_f32 v188, v188, v129
    v_add_f32 v189, v189, v130
    v_add_f32 v187, v187, v131
    v_add_f32 v184, v184, v132
    v_add_f32 v188, v188, v133
    v_add_f32 v189, v189, v134
    v_add_f32 v187, v187, v135
    v_add_f32 v184, v184, v136
    v_add_f32 v188, v188, v137
    v_add_f32 v189, v189, v138
    v_add_f32 v187, v187, v139
    v_add_f32 v184, v184, v140
    v_add_f32 v188, v188, v141
    v_add_f32 v189, v189, v142
    v_add_f32 v187, v187, v143
    v_add_f32 v184, v184, v144
    v_add_f32 v188, v188, v145
    v_add_f32 v189, v189, v146
    v_add_f32 v187, v187, v147
    v_add_f32 v184, v184, v148
    v_add_f32 v188, v188, v149
    v_add_f32 v189, v189, v150
    v_add_f32 v187, v187, v151
    v_add_f32 v184, v184, v152
    v_add_f32 v188, v188, v153
    v_add_f32 v189, v189, v154
    v_add_f32 v187, v187, v155
    v_add_f32 v184, v184, v156
    v_add_f32 v188, v188, v157
    v_add_f32 v189, v189, v158
    v_add_f32 v187, v187, v159
    v_add_f32 v184, v184, v160
    v_add_f32 v188, v188, v161
    v_add_f32 v189, v189, v162
    v_add_f32 v187, v187, v163
    v_add_f32 v184, v184, v164
    v_add_f32 v188, v188, v165
    v_add_f32 v189, v189, v166
    v_add_f32 v187, v187, v167
    v_add_f32 v184, v184, v168
    v_add_f32 v188, v188, v169
    v_add_f32 v189, v189, v170
    v_add_f32 v187, v187, v171
    v_add_f32 v184, v184, v172
    v_add_f32 v188, v188, v173
    v_add_f32 v189, v189, v174
    v_add_f32 v187, v187, v175
    v_add_f32 v184, v184, v176
    v_add_f32 v188, v188, v177
    v_add_f32 v189, v189, v178
    v_add_f32 v187, v187, v179
    v_add_f32 v184, v184, v180
    v_add_f32 v188, v188, v181
    v_add_f32 v189, v189, v182
    v_add_f32 v187, v187, v183
    v_add_f32 v184, v184, v188
    v_add_f32 v189, v189, v187
    v_add_f32 v184, v184, v189
    v_mov_b32 v185, v184
    s_nop 1
    v_permlane16_swap_b32 v184, v185
    v_add_f32 v184, v184, v185
    v_mov_b32 v185, v184
    s_nop 1
    v_permlane32_swap_b32 v184, v185
    v_add_f32 v184, v184, v185
    v_mul_f32 v186, s35, v184
    v_sub_f32 v72, v72, v186
    v_sub_f32 v73, v73, v186
    v_sub_f32 v74, v74, v186
    v_sub_f32 v75, v75, v186
    v_sub_f32 v76, v76, v186
    v_sub_f32 v77, v77, v186
    v_sub_f32 v78, v78, v186
    v_sub_f32 v79, v79, v186
    v_sub_f32 v80, v80, v186
    v_sub_f32 v81, v81, v186
    v_sub_f32 v82, v82, v186
    v_sub_f32 v83, v83, v186
    v_sub_f32 v84, v84, v186
    v_sub_f32 v85, v85, v186
    v_sub_f32 v86, v86, v186
    v_sub_f32 v87, v87, v186
    v_sub_f32 v88, v88, v186
    v_sub_f32 v89, v89, v186
    v_sub_f32 v90, v90, v186
    v_sub_f32 v91, v91, v186
    v_sub_f32 v92, v92, v186
    v_sub_f32 v93, v93, v186
    v_sub_f32 v94, v94, v186
    v_sub_f32 v95, v95, v186
    v_sub_f32 v96, v96, v186
    v_sub_f32 v97, v97, v186
    v_sub_f32 v98, v98, v186
    v_sub_f32 v99, v99, v186
    v_sub_f32 v100, v100, v186
    v_sub_f32 v101, v101, v186
    v_sub_f32 v102, v102, v186
    v_sub_f32 v103, v103, v186
    v_sub_f32 v104, v104, v186
    v_sub_f32 v105, v105, v186
    v_sub_f32 v106, v106, v186
    v_sub_f32 v107, v107, v186
    v_sub_f32 v108, v108, v186
    v_sub_f32 v109, v109, v186
    v_sub_f32 v110, v110, v186
    v_sub_f32 v111, v111, v186
    v_sub_f32 v112, v112, v186
    v_sub_f32 v113, v113, v186
    v_sub_f32 v114, v114, v186
    v_sub_f32 v115, v115, v186
    v_sub_f32 v116, v116, v186
    v_sub_f32 v117, v117, v186
    v_sub_f32 v118, v118, v186
    v_sub_f32 v119, v119, v186
    v_sub_f32 v120, v120, v186
    v_sub_f32 v121, v121, v186
    v_sub_f32 v122, v122, v186
    v_sub_f32 v123, v123, v186
    v_sub_f32 v124, v124, v186
    v_sub_f32 v125, v125, v186
    v_sub_f32 v126, v126, v186
    v_sub_f32 v127, v127, v186
    v_sub_f32 v128, v128, v186
    v_sub_f32 v129, v129, v186
    v_sub_f32 v130, v130, v186
    v_sub_f32 v131, v131, v186
    v_sub_f32 v132, v132, v186
    v_sub_f32 v133, v133, v186
    v_sub_f32 v134, v134, v186
    v_sub_f32 v135, v135, v186
    v_sub_f32 v136, v136, v186
    v_sub_f32 v137, v137, v186
    v_sub_f32 v138, v138, v186
    v_sub_f32 v139, v139, v186
    v_sub_f32 v140, v140, v186
    v_sub_f32 v141, v141, v186
    v_sub_f32 v142, v142, v186
    v_sub_f32 v143, v143, v186
    v_sub_f32 v144, v144, v186
    v_sub_f32 v145, v145, v186
    v_sub_f32 v146, v146, v186
    v_sub_f32 v147, v147, v186
    v_sub_f32 v148, v148, v186
    v_sub_f32 v149, v149, v186
    v_sub_f32 v150, v150, v186
    v_sub_f32 v151, v151, v186
    v_sub_f32 v152, v152, v186
    v_sub_f32 v153, v153, v186
    v_sub_f32 v154, v154, v186
    v_sub_f32 v155, v155, v186
    v_sub_f32 v156, v156, v186
    v_sub_f32 v157, v157, v186
    v_sub_f32 v158, v158, v186
    v_sub_f32 v159, v159, v186
    v_sub_f32 v160, v160, v186
    v_sub_f32 v161, v161, v186
    v_sub_f32 v162, v162, v186
    v_sub_f32 v163, v163, v186
    v_sub_f32 v164, v164, v186
    v_sub_f32 v165, v165, v186
    v_sub_f32 v166, v166, v186
    v_sub_f32 v167, v167, v186
    v_sub_f32 v168, v168, v186
    v_sub_f32 v169, v169, v186
    v_sub_f32 v170, v170, v186
    v_sub_f32 v171, v171, v186
    v_sub_f32 v172, v172, v186
    v_sub_f32 v173, v173, v186
    v_sub_f32 v174, v174, v186
    v_sub_f32 v175, v175, v186
    v_sub_f32 v176, v176, v186
    v_sub_f32 v177, v177, v186
    v_sub_f32 v178, v178, v186
    v_sub_f32 v179, v179, v186
    v_sub_f32 v180, v180, v186
    v_sub_f32 v181, v181, v186
    v_sub_f32 v182, v182, v186
    v_sub_f32 v183, v183, v186
    v_mul_f32 v184, v72, v72
    v_mul_f32 v188, v73, v73
    v_mul_f32 v189, v74, v74
    v_mul_f32 v187, v75, v75
    v_fmac_f32 v184, v76, v76
    v_fmac_f32 v188, v77, v77
    v_fmac_f32 v189, v78, v78
    v_fmac_f32 v187, v79, v79
    v_fmac_f32 v184, v80, v80
    v_fmac_f32 v188, v81, v81
    v_fmac_f32 v189, v82, v82
    v_fmac_f32 v187, v83, v83
    v_fmac_f32 v184, v84, v84
    v_fmac_f32 v188, v85, v85
    v_fmac_f32 v189, v86, v86
    v_fmac_f32 v187, v87, v87
    v_fmac_f32 v184, v88, v88
    v_fmac_f32 v188, v89, v89
    v_fmac_f32 v189, v90, v90
    v_fmac_f32 v187, v91, v91
    v_fmac_f32 v184, v92, v92
    v_fmac_f32 v188, v93, v93
    v_fmac_f32 v189, v94, v94
    v_fmac_f32 v187, v95, v95
    v_fmac_f32 v184, v96, v96
    v_fmac_f32 v188, v97, v97
    v_fmac_f32 v189, v98, v98
    v_fmac_f32 v187, v99, v99
    v_fmac_f32 v184, v100, v100
    v_fmac_f32 v188, v101, v101
    v_fmac_f32 v189, v102, v102
    v_fmac_f32 v187, v103, v103
    v_fmac_f32 v184, v104, v104
    v_fmac_f32 v188, v105, v105
    v_fmac_f32 v189, v106, v106
    v_fmac_f32 v187, v107, v107
    v_fmac_f32 v184, v108, v108
    v_fmac_f32 v188, v109, v109
    v_fmac_f32 v189, v110, v110
    v_fmac_f32 v187, v111, v111
    v_fmac_f32 v184, v112, v112
    v_fmac_f32 v188, v113, v113
    v_fmac_f32 v189, v114, v114
    v_fmac_f32 v187, v115, v115
    v_fmac_f32 v184, v116, v116
    v_fmac_f32 v188, v117, v117
    v_fmac_f32 v189, v118, v118
    v_fmac_f32 v187, v119, v119
    v_fmac_f32 v184, v120, v120
    v_fmac_f32 v188, v121, v121
    v_fmac_f32 v189, v122, v122
    v_fmac_f32 v187, v123, v123
    v_fmac_f32 v184, v124, v124
    v_fmac_f32 v188, v125, v125
    v_fmac_f32 v189, v126, v126
    v_fmac_f32 v187, v127, v127
    v_fmac_f32 v184, v128, v128
    v_fmac_f32 v188, v129, v129
    v_fmac_f32 v189, v130, v130
    v_fmac_f32 v187, v131, v131
    v_fmac_f32 v184, v132, v132
    v_fmac_f32 v188, v133, v133
    v_fmac_f32 v189, v134, v134
    v_fmac_f32 v187, v135, v135
    v_fmac_f32 v184, v136, v136
    v_fmac_f32 v188, v137, v137
    v_fmac_f32 v189, v138, v138
    v_fmac_f32 v187, v139, v139
    v_fmac_f32 v184, v140, v140
    v_fmac_f32 v188, v141, v141
    v_fmac_f32 v189, v142, v142
    v_fmac_f32 v187, v143, v143
    v_fmac_f32 v184, v144, v144
    v_fmac_f32 v188, v145, v145
    v_fmac_f32 v189, v146, v146
    v_fmac_f32 v187, v147, v147
    v_fmac_f32 v184, v148, v148
    v_fmac_f32 v188, v149, v149
    v_fmac_f32 v189, v150, v150
    v_fmac_f32 v187, v151, v151
    v_fmac_f32 v184, v152, v152
    v_fmac_f32 v188, v153, v153
    v_fmac_f32 v189, v154, v154
    v_fmac_f32 v187, v155, v155
    v_fmac_f32 v184, v156, v156
    v_fmac_f32 v188, v157, v157
    v_fmac_f32 v189, v158, v158
    v_fmac_f32 v187, v159, v159
    v_fmac_f32 v184, v160, v160
    v_fmac_f32 v188, v161, v161
    v_fmac_f32 v189, v162, v162
    v_fmac_f32 v187, v163, v163
    v_fmac_f32 v184, v164, v164
    v_fmac_f32 v188, v165, v165
    v_fmac_f32 v189, v166, v166
    v_fmac_f32 v187, v167, v167
    v_fmac_f32 v184, v168, v168
    v_fmac_f32 v188, v169, v169
    v_fmac_f32 v189, v170, v170
    v_fmac_f32 v187, v171, v171
    v_fmac_f32 v184, v172, v172
    v_fmac_f32 v188, v173, v173
    v_fmac_f32 v189, v174, v174
    v_fmac_f32 v187, v175, v175
    v_fmac_f32 v184, v176, v176
    v_fmac_f32 v188, v177, v177
    v_fmac_f32 v189, v178, v178
    v_fmac_f32 v187, v179, v179
    v_fmac_f32 v184, v180, v180
    v_fmac_f32 v188, v181, v181
    v_fmac_f32 v189, v182, v182
    v_fmac_f32 v187, v183, v183
    v_add_f32 v184, v184, v188
    v_add_f32 v189, v189, v187
    v_add_f32 v184, v184, v189
    v_mov_b32 v185, v184
    s_nop 1
    v_permlane16_swap_b32 v184, v185
    v_add_f32 v184, v184, v185
    v_mov_b32 v185, v184
    s_nop 1
    v_permlane32_swap_b32 v184, v185
    v_add_f32 v184, v184, v185
    v_mov_b32 v185, s34
    v_fmac_f32 v185, s35, v184
    v_rsq_f32 v185, v185
    s_nop 0
    v_mul_f32 v72, v72, v185
    v_mul_f32 v73, v73, v185
    v_mul_f32 v74, v74, v185
    v_mul_f32 v75, v75, v185
    v_mul_f32 v76, v76, v185
    v_mul_f32 v77, v77, v185
    v_mul_f32 v78, v78, v185
    v_mul_f32 v79, v79, v185
    v_mul_f32 v80, v80, v185
    v_mul_f32 v81, v81, v185
    v_mul_f32 v82, v82, v185
    v_mul_f32 v83, v83, v185
    v_mul_f32 v84, v84, v185
    v_mul_f32 v85, v85, v185
    v_mul_f32 v86, v86, v185
    v_mul_f32 v87, v87, v185
    v_mul_f32 v88, v88, v185
    v_mul_f32 v89, v89, v185
    v_mul_f32 v90, v90, v185
    v_mul_f32 v91, v91, v185
    v_mul_f32 v92, v92, v185
    v_mul_f32 v93, v93, v185
    v_mul_f32 v94, v94, v185
    v_mul_f32 v95, v95, v185
    v_mul_f32 v96, v96, v185
    v_mul_f32 v97, v97, v185
    v_mul_f32 v98, v98, v185
    v_mul_f32 v99, v99, v185
    v_mul_f32 v100, v100, v185
    v_mul_f32 v101, v101, v185
    v_mul_f32 v102, v102, v185
    v_mul_f32 v103, v103, v185
    v_mul_f32 v104, v104, v185
    v_mul_f32 v105, v105, v185
    v_mul_f32 v106, v106, v185
    v_mul_f32 v107, v107, v185
    v_mul_f32 v108, v108, v185
    v_mul_f32 v109, v109, v185
    v_mul_f32 v110, v110, v185
    v_mul_f32 v111, v111, v185
    v_mul_f32 v112, v112, v185
    v_mul_f32 v113, v113, v185
    v_mul_f32 v114, v114, v185
    v_mul_f32 v115, v115, v185
    v_mul_f32 v116, v116, v185
    v_mul_f32 v117, v117, v185
    v_mul_f32 v118, v118, v185
    v_mul_f32 v119, v119, v185
    v_mul_f32 v120, v120, v185
    v_mul_f32 v121, v121, v185
    v_mul_f32 v122, v122, v185
    v_mul_f32 v123, v123, v185
    v_mul_f32 v124, v124, v185
    v_mul_f32 v125, v125, v185
    v_mul_f32 v126, v126, v185
    v_mul_f32 v127, v127, v185
    v_mul_f32 v128, v128, v185
    v_mul_f32 v129, v129, v185
    v_mul_f32 v130, v130, v185
    v_mul_f32 v131, v131, v185
    v_mul_f32 v132, v132, v185
    v_mul_f32 v133, v133, v185
    v_mul_f32 v134, v134, v185
    v_mul_f32 v135, v135, v185
    v_mul_f32 v136, v136, v185
    v_mul_f32 v137, v137, v185
    v_mul_f32 v138, v138, v185
    v_mul_f32 v139, v139, v185
    v_mul_f32 v140, v140, v185
    v_mul_f32 v141, v141, v185
    v_mul_f32 v142, v142, v185
    v_mul_f32 v143, v143, v185
    v_mul_f32 v144, v144, v185
    v_mul_f32 v145, v145, v185
    v_mul_f32 v146, v146, v185
    v_mul_f32 v147, v147, v185
    v_mul_f32 v148, v148, v185
    v_mul_f32 v149, v149, v185
    v_mul_f32 v150, v150, v185
    v_mul_f32 v151, v151, v185
    v_mul_f32 v152, v152, v185
    v_mul_f32 v153, v153, v185
    v_mul_f32 v154, v154, v185
    v_mul_f32 v155, v155, v185
    v_mul_f32 v156, v156, v185
    v_mul_f32 v157, v157, v185
    v_mul_f32 v158, v158, v185
    v_mul_f32 v159, v159, v185
    v_mul_f32 v160, v160, v185
    v_mul_f32 v161, v161, v185
    v_mul_f32 v162, v162, v185
    v_mul_f32 v163, v163, v185
    v_mul_f32 v164, v164, v185
    v_mul_f32 v165, v165, v185
    v_mul_f32 v166, v166, v185
    v_mul_f32 v167, v167, v185
    v_mul_f32 v168, v168, v185
    v_mul_f32 v169, v169, v185
    v_mul_f32 v170, v170, v185
    v_mul_f32 v171, v171, v185
    v_mul_f32 v172, v172, v185
    v_mul_f32 v173, v173, v185
    v_mul_f32 v174, v174, v185
    v_mul_f32 v175, v175, v185
    v_mul_f32 v176, v176, v185
    v_mul_f32 v177, v177, v185
    v_mul_f32 v178, v178, v185
    v_mul_f32 v179, v179, v185
    v_mul_f32 v180, v180, v185
    v_mul_f32 v181, v181, v185
    v_mul_f32 v182, v182, v185
    v_mul_f32 v183, v183, v185
    v_cvt_pk_bf16_f32 v8, v72, v73
    v_cvt_pk_bf16_f32 v9, v74, v75
    v_cvt_pk_bf16_f32 v10, v76, v77
    v_cvt_pk_bf16_f32 v11, v78, v79
    v_cvt_pk_bf16_f32 v12, v80, v81
    v_cvt_pk_bf16_f32 v13, v82, v83
    v_cvt_pk_bf16_f32 v14, v84, v85
    v_cvt_pk_bf16_f32 v15, v86, v87
    v_cvt_pk_bf16_f32 v16, v88, v89
    v_cvt_pk_bf16_f32 v17, v90, v91
    v_cvt_pk_bf16_f32 v18, v92, v93
    v_cvt_pk_bf16_f32 v19, v94, v95
    v_cvt_pk_bf16_f32 v20, v96, v97
    v_cvt_pk_bf16_f32 v21, v98, v99
    v_cvt_pk_bf16_f32 v22, v100, v101
    v_cvt_pk_bf16_f32 v23, v102, v103
    v_cvt_pk_bf16_f32 v24, v104, v105
    v_cvt_pk_bf16_f32 v25, v106, v107
    v_cvt_pk_bf16_f32 v26, v108, v109
    v_cvt_pk_bf16_f32 v27, v110, v111
    v_cvt_pk_bf16_f32 v28, v112, v113
    v_cvt_pk_bf16_f32 v29, v114, v115
    v_cvt_pk_bf16_f32 v30, v116, v117
    v_cvt_pk_bf16_f32 v31, v118, v119
    v_cvt_pk_bf16_f32 v32, v120, v121
    v_cvt_pk_bf16_f32 v33, v122, v123
    v_cvt_pk_bf16_f32 v34, v124, v125
    v_cvt_pk_bf16_f32 v35, v126, v127
    v_cvt_pk_bf16_f32 v36, v128, v129
    v_cvt_pk_bf16_f32 v37, v130, v131
    v_cvt_pk_bf16_f32 v38, v132, v133
    v_cvt_pk_bf16_f32 v39, v134, v135
    v_cvt_pk_bf16_f32 v40, v136, v137
    v_cvt_pk_bf16_f32 v41, v138, v139
    v_cvt_pk_bf16_f32 v42, v140, v141
    v_cvt_pk_bf16_f32 v43, v142, v143
    v_cvt_pk_bf16_f32 v44, v144, v145
    v_cvt_pk_bf16_f32 v45, v146, v147
    v_cvt_pk_bf16_f32 v46, v148, v149
    v_cvt_pk_bf16_f32 v47, v150, v151
    v_cvt_pk_bf16_f32 v48, v152, v153
    v_cvt_pk_bf16_f32 v49, v154, v155
    v_cvt_pk_bf16_f32 v50, v156, v157
    v_cvt_pk_bf16_f32 v51, v158, v159
    v_cvt_pk_bf16_f32 v52, v160, v161
    v_cvt_pk_bf16_f32 v53, v162, v163
    v_cvt_pk_bf16_f32 v54, v164, v165
    v_cvt_pk_bf16_f32 v55, v166, v167
    v_cvt_pk_bf16_f32 v56, v168, v169
    v_cvt_pk_bf16_f32 v57, v170, v171
    v_cvt_pk_bf16_f32 v58, v172, v173
    v_cvt_pk_bf16_f32 v59, v174, v175
    v_cvt_pk_bf16_f32 v60, v176, v177
    v_cvt_pk_bf16_f32 v61, v178, v179
    v_cvt_pk_bf16_f32 v62, v180, v181
    v_cvt_pk_bf16_f32 v63, v182, v183
    v_lshlrev_b32 v204, 5, v0
    v_mov_b32 v205, 16
    v_cmp_lt_u32 vcc, 7, v0
    s_nop 1
    v_cndmask_b32 v204, v204, v205, vcc
    buffer_load_dword a251, v204, s[92:95], 0 offen sc1
    s_mul_i32 s32, s30, 14336
    s_add_u32 s32, s32, 1048576
    buffer_store_dwordx4 v[8:11], v3, s[8:11], s32 offen offset:0 sc1
    buffer_store_dwordx4 v[12:15], v3, s[8:11], s32 offen offset:1024 sc1
    buffer_store_dwordx4 v[16:19], v3, s[8:11], s32 offen offset:2048 sc1
    buffer_store_dwordx4 v[20:23], v3, s[8:11], s32 offen offset:3072 sc1
    s_add_u32 s32, s32, 4096
    buffer_store_dwordx4 v[24:27], v3, s[8:11], s32 offen offset:0 sc1
    buffer_store_dwordx4 v[28:31], v3, s[8:11], s32 offen offset:1024 sc1
    buffer_store_dwordx4 v[32:35], v3, s[8:11], s32 offen offset:2048 sc1
    buffer_store_dwordx4 v[36:39], v3, s[8:11], s32 offen offset:3072 sc1
    s_add_u32 s32, s32, 4096
    buffer_store_dwordx4 v[40:43], v3, s[8:11], s32 offen offset:0 sc1
    buffer_store_dwordx4 v[44:47], v3, s[8:11], s32 offen offset:1024 sc1
    buffer_store_dwordx4 v[48:51], v3, s[8:11], s32 offen offset:2048 sc1
    buffer_store_dwordx4 v[52:55], v3, s[8:11], s32 offen offset:3072 sc1
    s_add_u32 s32, s32, 4096
    buffer_store_dwordx4 v[56:59], v3, s[8:11], s32 offen offset:0 sc1
    buffer_store_dwordx4 v[60:63], v3, s[8:11], s32 offen offset:1024 sc1
    s_cmp_eq_u32 s2, 8
    s_cbranch_scc0 P_done
    v_lshlrev_b32 v3, 4, v0
    v_mov_b32 v16, -1
    v_mov_b32 v17, -1
    v_mov_b32 v18, -1
    v_mov_b32 v19, -1
    s_lshl_b32 s33, s3, 10
    s_add_u32 s32, s33, 20979712
    buffer_store_dwordx4 v[16:19], v3, s[8:11], s32 offen sc1
    s_add_u32 s32, s33, 20983808
    buffer_store_dwordx4 v[16:19], v3, s[8:11], s32 offen sc1
    s_add_u32 s32, s33, 20987904
    buffer_store_dwordx4 v[16:19], v3, s[8:11], s32 offen sc1
    s_add_u32 s32, s33, 20992000
    buffer_store_dwordx4 v[16:19], v3, s[8:11], s32 offen sc1
    s_add_u32 s32, s33, 20996096
    buffer_store_dwordx4 v[16:19], v3, s[8:11], s32 offen sc1
    s_add_u32 s32, s33, 21000192
    buffer_store_dwordx4 v[16:19], v3, s[8:11], s32 offen sc1
    s_add_u32 s32, s33, 22020096
    buffer_store_dwordx4 v[16:19], v3, s[8:11], s32 offen sc1
    s_add_u32 s32, s33, 22024192
    buffer_store_dwordx4 v[16:19], v3, s[8:11], s32 offen sc1
    s_add_u32 s32, s33, 22028288
    buffer_store_dwordx4 v[16:19], v3, s[8:11], s32 offen sc1
    s_add_u32 s32, s33, 22032384
    buffer_store_dwordx4 v[16:19], v3, s[8:11], s32 offen sc1
    s_add_u32 s32, s33, 22036480
    buffer_store_dwordx4 v[16:19], v3, s[8:11], s32 offen sc1
    s_add_u32 s32, s33, 22040576
    buffer_store_dwordx4 v[16:19], v3, s[8:11], s32 offen sc1
    s_add_u32 s32, s33, 22044672
    buffer_store_dwordx4 v[16:19], v3, s[8:11], s32 offen sc1
    s_add_u32 s32, s33, 22048768
    buffer_store_dwordx4 v[16:19], v3, s[8:11], s32 offen sc1
    s_add_u32 s32, s33, 22052864
    buffer_store_dwordx4 v[16:19], v3, s[8:11], s32 offen sc1
    s_add_u32 s32, s33, 22056960
    buffer_store_dwordx4 v[16:19], v3, s[8:11], s32 offen sc1
    s_add_u32 s32, s33, 22061056
    buffer_store_dwordx4 v[16:19], v3, s[8:11], s32 offen sc1
    s_add_u32 s32, s33, 22065152
    buffer_store_dwordx4 v[16:19], v3, s[8:11], s32 offen sc1
    s_add_u32 s32, s33, 22069248
    buffer_store_dwordx4 v[16:19], v3, s[8:11], s32 offen sc1
    s_add_u32 s32, s33, 22073344
    buffer_store_dwordx4 v[16:19], v3, s[8:11], s32 offen sc1
    s_add_u32 s32, s33, 22077440
    buffer_store_dwordx4 v[16:19], v3, s[8:11], s32 offen sc1
    s_add_u32 s32, s33, 22081536
    buffer_store_dwordx4 v[16:19], v3, s[8:11], s32 offen sc1
    v_lshrrev_b32 v6, 4, v0
    v_and_b32 v7, 7, v0
    v_bfe_u32 v8, v0, 3, 1
    v_mul_u32_u24 v9, 896, v7
    v_lshrrev_b32 v10, 1, v6
    v_lshl_add_u32 v9, v10, 6, v9
    v_and_b32 v10, 1, v6
    v_lshl_add_u32 v9, v10, 4, v9
    v_lshl_add_u32 v9, v8, 2, v9
    s_add_u32 s34, s3, 0
    s_cmp_ge_u32 s34, 7
    s_cbranch_scc1 Lin_3
    s_lshl_b32 s35, s34, 7
    s_add_u32 s36, s35, 0
    buffer_load_dword v24, v9, s[56:59], s36 offen
    s_add_u32 s36, s35, 32
    buffer_load_dword v25, v9, s[56:59], s36 offen
    s_add_u32 s36, s35, 8
    buffer_load_dword v26, v9, s[56:59], s36 offen
    s_add_u32 s36, s35, 40
    buffer_load_dword v27, v9, s[56:59], s36 offen
    s_waitcnt vmcnt(0)
    s_lshl_b32 s35, s34, 10
    s_add_u32 s36, s35, 20971520
    buffer_store_dwordx4 v[24:27], v3, s[8:11], s36 offen sc1
    s_add_u32 s36, s35, 23068672
    buffer_store_dwordx4 v[24:27], v3, s[8:11], s36 offen sc1
    s_nop 1
Lin_3:
    s_add_u32 s34, s3, 4
    s_cmp_ge_u32 s34, 7
    s_cbranch_scc1 Lin_4
    s_lshl_b32 s35, s34, 7
    s_add_u32 s36, s35, 0
    buffer_load_dword v24, v9, s[56:59], s36 offen
    s_add_u32 s36, s35, 32
    buffer_load_dword v25, v9, s[56:59], s36 offen
    s_add_u32 s36, s35, 8
    buffer_load_dword v26, v9, s[56:59], s36 offen
    s_add_u32 s36, s35, 40
    buffer_load_dword v27, v9, s[56:59], s36 offen
    s_waitcnt vmcnt(0)
    s_lshl_b32 s35, s34, 10
    s_add_u32 s36, s35, 20971520
    buffer_store_dwordx4 v[24:27], v3, s[8:11], s36 offen sc1
    s_add_u32 s36, s35, 23068672
    buffer_store_dwordx4 v[24:27], v3, s[8:11], s36 offen sc1
    s_nop 1
Lin_4:
    s_waitcnt vmcnt(0)
P_done:
    s_cmp_eq_u32 s3, 0
    s_cbranch_scc0 P_sig
    v_mov_b32 v6, 0
    s_waitcnt vmcnt(0)
    v_accvgpr_read_b32 v7, a251
    s_nop 1
    v_readlane_b32 s29, v7, 8
    s_nop 3
    s_cmp_lg_u32 s29, 0
    s_cbranch_scc1 P_sig
P_iw:
    buffer_load_dword v7, v6, s[92:95], 0 offen offset:16 sc1
    s_waitcnt vmcnt(0)
    v_readfirstlane_b32 s29, v7
    s_cmp_lg_u32 s29, 0
    s_cbranch_scc1 P_sig
    s_sleep 2
    s_sub_u32 s76, s76, 1
    s_cbranch_scc0 P_iw
    s_branch L_exit
P_sig:
    s_waitcnt vmcnt(0)
    s_barrier
    s_cmp_eq_u32 s3, 0
    s_cbranch_scc0 Lsg_5
    v_mov_b32 v6, 0
    v_mov_b32 v7, 1
    s_mov_b64 exec, 1
    buffer_atomic_add v7, v6, s[8:11], s78 offen sc1
    s_mov_b64 exec, -1
Lsg_5:
    s_mov_b32 s28, s79
    s_cmp_eq_u32 s3, 0
    s_cbranch_scc0 E_wait
    s_waitcnt vmcnt(0)
    v_accvgpr_read_b32 v7, a250
    s_nop 1
    v_readfirstlane_b32 s30, v7
    v_and_b32 v6, 7, v0
    v_lshlrev_b32 v6, 5, v6
    v_accvgpr_read_b32 v7, a251
    s_branch E_sum
E_poll:
    buffer_load_dword v7, v6, s[92:95], 0 offen sc1
    s_waitcnt vmcnt(0)
E_sum:
    s_mov_b32 s31, 0
    s_mov_b32 s32, 0
    s_mov_b32 s33, 1
    v_readlane_b32 s34, v7, 0
    s_nop 3
    s_add_u32 s31, s31, s34
    s_cmp_lg_u32 s34, 32
    s_cselect_b32 s33, 0, s33
    s_cmp_gt_u32 s28, 0
    s_cselect_b32 s34, s34, 0
    s_add_u32 s32, s32, s34
    v_readlane_b32 s34, v7, 1
    s_nop 3
    s_add_u32 s31, s31, s34
    s_cmp_lg_u32 s34, 32
    s_cselect_b32 s33, 0, s33
    s_cmp_gt_u32 s28, 1
    s_cselect_b32 s34, s34, 0
    s_add_u32 s32, s32, s34
    v_readlane_b32 s34, v7, 2
    s_nop 3
    s_add_u32 s31, s31, s34
    s_cmp_lg_u32 s34, 32
    s_cselect_b32 s33, 0, s33
    s_cmp_gt_u32 s28, 2
    s_cselect_b32 s34, s34, 0
    s_add_u32 s32, s32, s34
    v_readlane_b32 s34, v7, 3
    s_nop 3
    s_add_u32 s31, s31, s34
    s_cmp_lg_u32 s34, 32
    s_cselect_b32 s33, 0, s33
    s_cmp_gt_u32 s28, 3
    s_cselect_b32 s34, s34, 0
    s_add_u32 s32, s32, s34
    v_readlane_b32 s34, v7, 4
    s_nop 3
    s_add_u32 s31, s31, s34
    s_cmp_lg_u32 s34, 32
    s_cselect_b32 s33, 0, s33
    s_cmp_gt_u32 s28, 4
    s_cselect_b32 s34, s34, 0
    s_add_u32 s32, s32, s34
    v_readlane_b32 s34, v7, 5
    s_nop 3
    s_add_u32 s31, s31, s34
    s_cmp_lg_u32 s34, 32
    s_cselect_b32 s33, 0, s33
    s_cmp_gt_u32 s28, 5
    s_cselect_b32 s34, s34, 0
    s_add_u32 s32, s32, s34
    v_readlane_b32 s34, v7, 6
    s_nop 3
    s_add_u32 s31, s31, s34
    s_cmp_lg_u32 s34, 32
    s_cselect_b32 s33, 0, s33
    s_cmp_gt_u32 s28, 6
    s_cselect_b32 s34, s34, 0
    s_add_u32 s32, s32, s34
    v_readlane_b32 s34, v7, 7
    s_nop 3
    s_add_u32 s31, s31, s34
    s_cmp_lg_u32 s34, 32
    s_cselect_b32 s33, 0, s33
    s_cmp_gt_u32 s28, 7
    s_cselect_b32 s34, s34, 0
    s_add_u32 s32, s32, s34
    s_cmp_ge_u32 s31, 256
    s_cbranch_scc1 E_done
    s_sleep 2
    s_sub_u32 s76, s76, 1
    s_cbranch_scc0 E_poll
    s_branch L_exit
E_done:
    v_mov_b32 v6, 0
    v_mov_b32 v8, s30
    v_mov_b32 v9, s32
    v_mov_b32 v10, s33
    v_mov_b32 v11, s33
    ds_write_b128 v6, v[8:11]
    s_waitcnt lgkmcnt(0)
E_wait:
    s_barrier
    v_mov_b32 v6, 0
    ds_read_b128 v[8:11], v6
    s_waitcnt lgkmcnt(0)
    v_readfirstlane_b32 s30, v8
    v_readfirstlane_b32 s32, v9
    v_readfirstlane_b32 s33, v10
    s_nop 3
    s_barrier
    s_cmp_eq_u32 s33, 1
    s_cbranch_scc0 E_fallback
    s_cmp_eq_u32 s28, 0
    s_cbranch_scc0 E_wk
    s_mov_b32 s13, s30
    s_mov_b32 s35, 0
    s_branch E_chain
E_wk:
    s_sub_u32 s34, s28, 1
    s_and_b32 s74, s30, 7
    s_lshr_b32 s75, s30, 3
    s_lshl_b32 s35, s34, 2
    s_add_u32 s75, s75, s35
    s_lshl_b32 s72, s34, 5
    s_add_u32 s72, s72, s30
    s_branch E_worker
E_fallback:
    s_add_u32 s30, s30, s32
    s_cmp_ge_u32 s30, 32
    s_cbranch_scc1 E_fw
    s_mov_b32 s13, s30
    s_mov_b32 s35, 1
    s_branch E_chain
E_fw:
    s_sub_u32 s72, s30, 32
    s_and_b32 s74, s72, 7
    s_lshr_b32 s75, s72, 3
    s_branch E_worker
E_chain:
    s_mov_b32 s12, s3
    s_mov_b32 s57, s35
    s_mov_b32 s32, 1500000
    s_mov_b32 s14, 0
    s_mov_b32 s33, 20971520
    s_mov_b32 s34, 22020096
    s_lshl_b32 s35, s12, 10
    s_add_u32 s36, s35, 4096
    s_cmp_eq_u32 s12, 3
    s_cselect_b32 s36, s35, s36
    s_mov_b32 s39, 0x3db8aa3b
    s_cmp_ge_u32 s13, 30
    s_cbranch_scc1 L_roleX
    s_cmp_eq_u32 s57, 1
    s_cbranch_scc1 E_slow
    s_cmp_lt_u32 s13, 16
    s_cbranch_scc0 L_roleB
    v_lshlrev_b32 v1, 4, v0
    v_and_b32 v20, 15, v0
    v_mov_b32 v2, 0x4444
    v_mov_b32 v21, 0xeeee
    v_cmp_lt_u32 vcc, 7, v20
    s_nop 1
    v_cndmask_b32 v2, v2, v21, vcc
    s_mul_i32 s16, s13, 401408
    s_mul_i32 s17, s12, 100352
    s_add_u32 s16, s16, s17
    s_add_u32 s16, s16, 5242880
    s_mul_i32 s18, s12, 14336
    s_add_u32 s18, s18, 14336
    v_add_u32 v14, s18, v1
    s_add_u32 s19, s12, 0
    s_mul_hi_u32 s20, s19, 613566757
    s_mul_i32 s20, s20, 7
    s_sub_u32 s19, s19, s20
    s_lshl_b32 s46, s19, 10
    s_add_u32 s19, s12, 4
    s_mul_hi_u32 s20, s19, 613566757
    s_mul_i32 s20, s20, 7
    s_sub_u32 s19, s19, s20
    s_lshl_b32 s47, s19, 10
    s_add_u32 s19, s12, 8
    s_mul_hi_u32 s20, s19, 613566757
    s_mul_i32 s20, s20, 7
    s_sub_u32 s19, s19, s20
    s_lshl_b32 s48, s19, 10
    s_add_u32 s19, s12, 12
    s_mul_hi_u32 s20, s19, 613566757
    s_mul_i32 s20, s20, 7
    s_sub_u32 s19, s19, s20
    s_lshl_b32 s49, s19, 10
    s_add_u32 s19, s12, 16
    s_mul_hi_u32 s20, s19, 613566757
    s_mul_i32 s20, s20, 7
    s_sub_u32 s19, s19, s20
    s_lshl_b32 s50, s19, 10
    s_add_u32 s19, s12, 20
    s_mul_hi_u32 s20, s19, 613566757
    s_mul_i32 s20, s20, 7
    s_sub_u32 s19, s19, s20
    s_lshl_b32 s51, s19, 10
    s_add_u32 s19, s12, 24
    s_mul_hi_u32 s20, s19, 613566757
    s_mul_i32 s20, s20, 7
    s_sub_u32 s19, s19, s20
    s_lshl_b32 s52, s19, 10
    s_mov_b32 s35, s46
    s_mov_b32 s36, s47
    s_lshl_b32 s22, s13, 2
    s_add_u32 s22, s22, s12
    s_lshl_b32 s22, s22, 8
    s_add_u32 s22, s22, 40960
    v_lshlrev_b32 v20, 2, v0
    s_mov_b64 s[62:63], 0
Lwt_6:
    s_lshr_b64 s[20:21], s[62:63], 0
    s_and_b32 s20, s20, 0x7f
    s_cmp_eq_u32 s20, 0x7f
    s_cbranch_scc1 Lwt_6_d
    buffer_load_dword v21, v20, s[8:11], s22 offen sc1
    s_waitcnt vmcnt(0)
    v_cmp_ne_u32 vcc, 0, v21
    s_mov_b64 s[62:63], vcc
    s_sub_u32 s32, s32, 1
    s_cbranch_scc0 Lwt_6
    s_branch L_exit
Lwt_6_d:
    s_lshl_b32 s17, s52, 1
    s_add_u32 s17, s17, s16
    s_add_u32 s17, s17, 0
    s_add_u32 m0, s18, 0
    s_nop 0
    buffer_load_dwordx4 v1, s[8:11], s17 offen sc1 lds
    buffer_load_dwordx4 v1, s[8:11], s17 offen offset:1024 sc1 lds
    s_lshl_b32 s17, s46, 1
    s_add_u32 s17, s17, s16
    s_add_u32 s17, s17, 0
    buffer_load_dwordx4 a[0:3], v1, s[8:11], s17 offen offset:0 sc1
    buffer_load_dwordx4 a[4:7], v1, s[8:11], s17 offen offset:1024 sc1
    s_lshl_b32 s17, s47, 1
    s_add_u32 s17, s17, s16
    s_add_u32 s17, s17, 0
    buffer_load_dwordx4 a[8:11], v1, s[8:11], s17 offen offset:0 sc1
    buffer_load_dwordx4 a[12:15], v1, s[8:11], s17 offen offset:1024 sc1
    s_lshl_b32 s17, s48, 1
    s_add_u32 s17, s17, s16
    s_add_u32 s17, s17, 0
    buffer_load_dwordx4 a[16:19], v1, s[8:11], s17 offen offset:0 sc1
    buffer_load_dwordx4 a[20:23], v1, s[8:11], s17 offen offset:1024 sc1
    s_lshl_b32 s17, s49, 1
    s_add_u32 s17, s17, s16
    s_add_u32 s17, s17, 0
    buffer_load_dwordx4 a[24:27], v1, s[8:11], s17 offen offset:0 sc1
    buffer_load_dwordx4 a[28:31], v1, s[8:11], s17 offen offset:1024 sc1
    s_lshl_b32 s17, s50, 1
    s_add_u32 s17, s17, s16
    s_add_u32 s17, s17, 0
    buffer_load_dwordx4 a[32:35], v1, s[8:11], s17 offen offset:0 sc1
    buffer_load_dwordx4 a[36:39], v1, s[8:11], s17 offen offset:1024 sc1
    s_lshl_b32 s17, s51, 1
    s_add_u32 s17, s17, s16
    s_add_u32 s17, s17, 0
    buffer_load_dwordx4 a[40:43], v1, s[8:11], s17 offen offset:0 sc1
    buffer_load_dwordx4 a[44:47], v1, s[8:11], s17 offen offset:1024 sc1
Lwt_7:
    s_lshr_b64 s[20:21], s[62:63], 8
    s_and_b32 s20, s20, 0x7f
    s_cmp_eq_u32 s20, 0x7f
    s_cbranch_scc1 Lwt_7_d
    buffer_load_dword v21, v20, s[8:11], s22 offen sc1
    s_waitcnt vmcnt(0)
    v_cmp_ne_u32 vcc, 0, v21
    s_mov_b64 s[62:63], vcc
    s_sub_u32 s32, s32, 1
    s_cbranch_scc0 Lwt_7
    s_branch L_exit
Lwt_7_d:
    s_lshl_b32 s17, s52, 1
    s_add_u32 s17, s17, s16
    s_add_u32 s17, s17, 14336
    s_add_u32 m0, s18, 2048
    s_nop 0
    buffer_load_dwordx4 v1, s[8:11], s17 offen sc1 lds
    buffer_load_dwordx4 v1, s[8:11], s17 offen offset:1024 sc1 lds
    s_lshl_b32 s17, s46, 1
    s_add_u32 s17, s17, s16
    s_add_u32 s17, s17, 14336
    buffer_load_dwordx4 a[48:51], v1, s[8:11], s17 offen offset:0 sc1
    buffer_load_dwordx4 a[52:55], v1, s[8:11], s17 offen offset:1024 sc1
    s_lshl_b32 s17, s47, 1
    s_add_u32 s17, s17, s16
    s_add_u32 s17, s17, 14336
    buffer_load_dwordx4 a[56:59], v1, s[8:11], s17 offen offset:0 sc1
    buffer_load_dwordx4 a[60:63], v1, s[8:11], s17 offen offset:1024 sc1
    s_lshl_b32 s17, s48, 1
    s_add_u32 s17, s17, s16
    s_add_u32 s17, s17, 14336
    buffer_load_dwordx4 a[64:67], v1, s[8:11], s17 offen offset:0 sc1
    buffer_load_dwordx4 a[68:71], v1, s[8:11], s17 offen offset:1024 sc1
    s_lshl_b32 s17, s49, 1
    s_add_u32 s17, s17, s16
    s_add_u32 s17, s17, 14336
    buffer_load_dwordx4 a[72:75], v1, s[8:11], s17 offen offset:0 sc1
    buffer_load_dwordx4 a[76:79], v1, s[8:11], s17 offen offset:1024 sc1
    s_lshl_b32 s17, s50, 1
    s_add_u32 s17, s17, s16
    s_add_u32 s17, s17, 14336
    buffer_load_dwordx4 a[80:83], v1, s[8:11], s17 offen offset:0 sc1
    buffer_load_dwordx4 a[84:87], v1, s[8:11], s17 offen offset:1024 sc1
    s_lshl_b32 s17, s51, 1
    s_add_u32 s17, s17, s16
    s_add_u32 s17, s17, 14336
    buffer_load_dwordx4 a[88:91], v1, s[8:11], s17 offen offset:0 sc1
    buffer_load_dwordx4 a[92:95], v1, s[8:11], s17 offen offset:1024 sc1
Lwt_8:
    s_lshr_b64 s[20:21], s[62:63], 16
    s_and_b32 s20, s20, 0x7f
    s_cmp_eq_u32 s20, 0x7f
    s_cbranch_scc1 Lwt_8_d
    buffer_load_dword v21, v20, s[8:11], s22 offen sc1
    s_waitcnt vmcnt(0)
    v_cmp_ne_u32 vcc, 0, v21
    s_mov_b64 s[62:63], vcc
    s_sub_u32 s32, s32, 1
    s_cbranch_scc0 Lwt_8
    s_branch L_exit
Lwt_8_d:
    s_lshl_b32 s17, s52, 1
    s_add_u32 s17, s17, s16
    s_add_u32 s17, s17, 28672
    s_add_u32 m0, s18, 4096
    s_nop 0
    buffer_load_dwordx4 v1, s[8:11], s17 offen sc1 lds
    buffer_load_dwordx4 v1, s[8:11], s17 offen offset:1024 sc1 lds
    s_lshl_b32 s17, s46, 1
    s_add_u32 s17, s17, s16
    s_add_u32 s17, s17, 28672
    buffer_load_dwordx4 a[96:99], v1, s[8:11], s17 offen offset:0 sc1
    buffer_load_dwordx4 a[100:103], v1, s[8:11], s17 offen offset:1024 sc1
    s_lshl_b32 s17, s47, 1
    s_add_u32 s17, s17, s16
    s_add_u32 s17, s17, 28672
    buffer_load_dwordx4 a[104:107], v1, s[8:11], s17 offen offset:0 sc1
    buffer_load_dwordx4 a[108:111], v1, s[8:11], s17 offen offset:1024 sc1
    s_lshl_b32 s17, s48, 1
    s_add_u32 s17, s17, s16
    s_add_u32 s17, s17, 28672
    buffer_load_dwordx4 a[112:115], v1, s[8:11], s17 offen offset:0 sc1
    buffer_load_dwordx4 a[116:119], v1, s[8:11], s17 offen offset:1024 sc1
    s_lshl_b32 s17, s49, 1
    s_add_u32 s17, s17, s16
    s_add_u32 s17, s17, 28672
    buffer_load_dwordx4 a[120:123], v1, s[8:11], s17 offen offset:0 sc1
    buffer_load_dwordx4 a[124:127], v1, s[8:11], s17 offen offset:1024 sc1
    s_lshl_b32 s17, s50, 1
    s_add_u32 s17, s17, s16
    s_add_u32 s17, s17, 28672
    buffer_load_dwordx4 a[128:131], v1, s[8:11], s17 offen offset:0 sc1
    buffer_load_dwordx4 a[132:135], v1, s[8:11], s17 offen offset:1024 sc1
    s_lshl_b32 s17, s51, 1
    s_add_u32 s17, s17, s16
    s_add_u32 s17, s17, 28672
    buffer_load_dwordx4 a[136:139], v1, s[8:11], s17 offen offset:0 sc1
    buffer_load_dwordx4 a[140:143], v1, s[8:11], s17 offen offset:1024 sc1
Lwt_9:
    s_lshr_b64 s[20:21], s[62:63], 24
    s_and_b32 s20, s20, 0x7f
    s_cmp_eq_u32 s20, 0x7f
    s_cbranch_scc1 Lwt_9_d
    buffer_load_dword v21, v20, s[8:11], s22 offen sc1
    s_waitcnt vmcnt(0)
    v_cmp_ne_u32 vcc, 0, v21
    s_mov_b64 s[62:63], vcc
    s_sub_u32 s32, s32, 1
    s_cbranch_scc0 Lwt_9
    s_branch L_exit
Lwt_9_d:
    s_lshl_b32 s17, s52, 1
    s_add_u32 s17, s17, s16
    s_add_u32 s17, s17, 43008
    s_add_u32 m0, s18, 6144
    s_nop 0
    buffer_load_dwordx4 v1, s[8:11], s17 offen sc1 lds
    buffer_load_dwordx4 v1, s[8:11], s17 offen offset:1024 sc1 lds
    s_lshl_b32 s17, s46, 1
    s_add_u32 s17, s17, s16
    s_add_u32 s17, s17, 43008
    buffer_load_dwordx4 a[144:147], v1, s[8:11], s17 offen offset:0 sc1
    buffer_load_dwordx4 a[148:151], v1, s[8:11], s17 offen offset:1024 sc1
    s_lshl_b32 s17, s47, 1
    s_add_u32 s17, s17, s16
    s_add_u32 s17, s17, 43008
    buffer_load_dwordx4 a[152:155], v1, s[8:11], s17 offen offset:0 sc1
    buffer_load_dwordx4 a[156:159], v1, s[8:11], s17 offen offset:1024 sc1
    s_lshl_b32 s17, s48, 1
    s_add_u32 s17, s17, s16
    s_add_u32 s17, s17, 43008
    buffer_load_dwordx4 a[160:163], v1, s[8:11], s17 offen offset:0 sc1
    buffer_load_dwordx4 a[164:167], v1, s[8:11], s17 offen offset:1024 sc1
    s_lshl_b32 s17, s49, 1
    s_add_u32 s17, s17, s16
    s_add_u32 s17, s17, 43008
    buffer_load_dwordx4 a[168:171], v1, s[8:11], s17 offen offset:0 sc1
    buffer_load_dwordx4 a[172:175], v1, s[8:11], s17 offen offset:1024 sc1
    s_lshl_b32 s17, s50, 1
    s_add_u32 s17, s17, s16
    s_add_u32 s17, s17, 43008
    buffer_load_dwordx4 a[176:179], v1, s[8:11], s17 offen offset:0 sc1
    buffer_load_dwordx4 a[180:183], v1, s[8:11], s17 offen offset:1024 sc1
    s_lshl_b32 s17, s51, 1
    s_add_u32 s17, s17, s16
    s_add_u32 s17, s17, 43008
    buffer_load_dwordx4 a[184:187], v1, s[8:11], s17 offen offset:0 sc1
    buffer_load_dwordx4 a[188:191], v1, s[8:11], s17 offen offset:1024 sc1
Lwt_10:
    s_lshr_b64 s[20:21], s[62:63], 32
    s_and_b32 s20, s20, 0x7f
    s_cmp_eq_u32 s20, 0x7f
    s_cbranch_scc1 Lwt_10_d
    buffer_load_dword v21, v20, s[8:11], s22 offen sc1
    s_waitcnt vmcnt(0)
    v_cmp_ne_u32 vcc, 0, v21
    s_mov_b64 s[62:63], vcc
    s_sub_u32 s32, s32, 1
    s_cbranch_scc0 Lwt_10
    s_branch L_exit
Lwt_10_d:
    s_lshl_b32 s17, s52, 1
    s_add_u32 s17, s17, s16
    s_add_u32 s17, s17, 57344
    s_add_u32 m0, s18, 8192
    s_nop 0
    buffer_load_dwordx4 v1, s[8:11], s17 offen sc1 lds
    buffer_load_dwordx4 v1, s[8:11], s17 offen offset:1024 sc1 lds
    s_lshl_b32 s17, s46, 1
    s_add_u32 s17, s17, s16
    s_add_u32 s17, s17, 57344
    buffer_load_dwordx4 a[192:195], v1, s[8:11], s17 offen offset:0 sc1
    buffer_load_dwordx4 a[196:199], v1, s[8:11], s17 offen offset:1024 sc1
    s_lshl_b32 s17, s47, 1
    s_add_u32 s17, s17, s16
    s_add_u32 s17, s17, 57344
    buffer_load_dwordx4 a[200:203], v1, s[8:11], s17 offen offset:0 sc1
    buffer_load_dwordx4 a[204:207], v1, s[8:11], s17 offen offset:1024 sc1
    s_lshl_b32 s17, s48, 1
    s_add_u32 s17, s17, s16
    s_add_u32 s17, s17, 57344
    buffer_load_dwordx4 a[208:211], v1, s[8:11], s17 offen offset:0 sc1
    buffer_load_dwordx4 a[212:215], v1, s[8:11], s17 offen offset:1024 sc1
    s_lshl_b32 s17, s49, 1
    s_add_u32 s17, s17, s16
    s_add_u32 s17, s17, 57344
    buffer_load_dwordx4 a[216:219], v1, s[8:11], s17 offen offset:0 sc1
    buffer_load_dwordx4 a[220:223], v1, s[8:11], s17 offen offset:1024 sc1
    s_lshl_b32 s17, s50, 1
    s_add_u32 s17, s17, s16
    s_add_u32 s17, s17, 57344
    buffer_load_dwordx4 a[224:227], v1, s[8:11], s17 offen offset:0 sc1
    buffer_load_dwordx4 a[228:231], v1, s[8:11], s17 offen offset:1024 sc1
    s_lshl_b32 s17, s51, 1
    s_add_u32 s17, s17, s16
    s_add_u32 s17, s17, 57344
    buffer_load_dwordx4 a[232:235], v1, s[8:11], s17 offen offset:0 sc1
    buffer_load_dwordx4 a[236:239], v1, s[8:11], s17 offen offset:1024 sc1
Lwt_11:
    s_lshr_b64 s[20:21], s[62:63], 40
    s_and_b32 s20, s20, 0x7f
    s_cmp_eq_u32 s20, 0x7f
    s_cbranch_scc1 Lwt_11_d
    buffer_load_dword v21, v20, s[8:11], s22 offen sc1
    s_waitcnt vmcnt(0)
    v_cmp_ne_u32 vcc, 0, v21
    s_mov_b64 s[62:63], vcc
    s_sub_u32 s32, s32, 1
    s_cbranch_scc0 Lwt_11
    s_branch L_exit
Lwt_11_d:
    s_lshl_b32 s17, s52, 1
    s_add_u32 s17, s17, s16
    s_add_u32 s17, s17, 71680
    s_add_u32 m0, s18, 10240
    s_nop 0
    buffer_load_dwordx4 v1, s[8:11], s17 offen sc1 lds
    buffer_load_dwordx4 v1, s[8:11], s17 offen offset:1024 sc1 lds
    s_lshl_b32 s17, s46, 1
    s_add_u32 s17, s17, s16
    s_add_u32 s17, s17, 71680
    buffer_load_dwordx4 a[240:243], v1, s[8:11], s17 offen offset:0 sc1
    buffer_load_dwordx4 a[244:247], v1, s[8:11], s17 offen offset:1024 sc1
    s_lshl_b32 s17, s47, 1
    s_add_u32 s17, s17, s16
    s_add_u32 s17, s17, 71680
    buffer_load_dwordx4 a[248:251], v1, s[8:11], s17 offen offset:0 sc1
    buffer_load_dwordx4 a[252:255], v1, s[8:11], s17 offen offset:1024 sc1
    s_lshl_b32 s17, s48, 1
    s_add_u32 s17, s17, s16
    s_add_u32 s17, s17, 71680
    buffer_load_dwordx4 v[176:179], v1, s[8:11], s17 offen offset:0 sc1
    buffer_load_dwordx4 v[180:183], v1, s[8:11], s17 offen offset:1024 sc1
    s_lshl_b32 s17, s49, 1
    s_add_u32 s17, s17, s16
    s_add_u32 s17, s17, 71680
    buffer_load_dwordx4 v[184:187], v1, s[8:11], s17 offen offset:0 sc1
    buffer_load_dwordx4 v[188:191], v1, s[8:11], s17 offen offset:1024 sc1
    s_lshl_b32 s17, s50, 1
    s_add_u32 s17, s17, s16
    s_add_u32 s17, s17, 71680
    buffer_load_dwordx4 v[192:195], v1, s[8:11], s17 offen offset:0 sc1
    buffer_load_dwordx4 v[196:199], v1, s[8:11], s17 offen offset:1024 sc1
    s_lshl_b32 s17, s51, 1
    s_add_u32 s17, s17, s16
    s_add_u32 s17, s17, 71680
    buffer_load_dwordx4 v[200:203], v1, s[8:11], s17 offen offset:0 sc1
    buffer_load_dwordx4 v[204:207], v1, s[8:11], s17 offen offset:1024 sc1
Lwt_12:
    s_lshr_b64 s[20:21], s[62:63], 48
    s_and_b32 s20, s20, 0x7f
    s_cmp_eq_u32 s20, 0x7f
    s_cbranch_scc1 Lwt_12_d
    buffer_load_dword v21, v20, s[8:11], s22 offen sc1
    s_waitcnt vmcnt(0)
    v_cmp_ne_u32 vcc, 0, v21
    s_mov_b64 s[62:63], vcc
    s_sub_u32 s32, s32, 1
    s_cbranch_scc0 Lwt_12
    s_branch L_exit
Lwt_12_d:
    s_lshl_b32 s17, s52, 1
    s_add_u32 s17, s17, s16
    s_add_u32 s17, s17, 86016
    s_add_u32 m0, s18, 12288
    s_nop 0
    buffer_load_dwordx4 v1, s[8:11], s17 offen sc1 lds
    buffer_load_dwordx4 v1, s[8:11], s17 offen offset:1024 sc1 lds
    s_lshl_b32 s17, s46, 1
    s_add_u32 s17, s17, s16
    s_add_u32 s17, s17, 86016
    buffer_load_dwordx4 v[208:211], v1, s[8:11], s17 offen offset:0 sc1
    buffer_load_dwordx4 v[212:215], v1, s[8:11], s17 offen offset:1024 sc1
    s_lshl_b32 s17, s47, 1
    s_add_u32 s17, s17, s16
    s_add_u32 s17, s17, 86016
    buffer_load_dwordx4 v[216:219], v1, s[8:11], s17 offen offset:0 sc1
    buffer_load_dwordx4 v[220:223], v1, s[8:11], s17 offen offset:1024 sc1
    s_lshl_b32 s17, s48, 1
    s_add_u32 s17, s17, s16
    s_add_u32 s17, s17, 86016
    buffer_load_dwordx4 v[224:227], v1, s[8:11], s17 offen offset:0 sc1
    buffer_load_dwordx4 v[228:231], v1, s[8:11], s17 offen offset:1024 sc1
    s_lshl_b32 s17, s49, 1
    s_add_u32 s17, s17, s16
    s_add_u32 s17, s17, 86016
    buffer_load_dwordx4 v[232:235], v1, s[8:11], s17 offen offset:0 sc1
    buffer_load_dwordx4 v[236:239], v1, s[8:11], s17 offen offset:1024 sc1
    s_lshl_b32 s17, s50, 1
    s_add_u32 s17, s17, s16
    s_add_u32 s17, s17, 86016
    buffer_load_dwordx4 v[240:243], v1, s[8:11], s17 offen offset:0 sc1
    buffer_load_dwordx4 v[244:247], v1, s[8:11], s17 offen offset:1024 sc1
    s_lshl_b32 s17, s51, 1
    s_add_u32 s17, s17, s16
    s_add_u32 s17, s17, 86016
    buffer_load_dwordx4 v[248:251], v1, s[8:11], s17 offen offset:0 sc1
    buffer_load_dwordx4 v[252:255], v1, s[8:11], s17 offen offset:1024 sc1
    v_and_b32 v20, 15, v0
    v_lshrrev_b32 v21, 4, v0
    v_lshlrev_b32 v23, 3, v20
    v_lshrrev_b32 v24, 1, v21
    v_lshlrev_b32 v24, 6, v24
    v_xor_b32 v23, v23, v24
    v_lshl_add_u32 v23, v21, 7, v23
    s_lshl_b32 s16, s12, 12
    s_add_u32 s16, s16, 71680
    s_and_b32 s17, s12, 1
    s_lshl_b32 s17, s17, 9
    s_add_u32 s17, s17, s16
    v_add_u32 v3, s17, v23
    v_and_b32 v24, 3, v20
    v_lshrrev_b32 v25, 2, v20
    v_lshl_add_u32 v25, v21, 2, v25
    v_lshlrev_b32 v25, 3, v25
    v_lshrrev_b32 v26, 1, v24
    v_lshlrev_b32 v26, 6, v26
    v_xor_b32 v25, v25, v26
    v_lshl_add_u32 v23, v24, 7, v25
    v_add_u32 v4, s16, v23
    v_mov_b32 v24, 0
    v_mov_b32 v25, 0
    v_mov_b32 v26, 0
    v_mov_b32 v27, 0
    v_add_u32 v23, s16, v1
    ds_write_b128 v23, v[24:27]
    ds_write_b128 v23, v[24:27] offset:1024
    ds_write_b128 v23, v[24:27] offset:2048
    ds_write_b128 v23, v[24:27] offset:3072
    s_mul_i32 s18, s12, 7
    s_lshr_b32 s18, s18, 1
    v_lshrrev_b32 v23, 1, v21
    v_lshlrev_b32 v23, 8, v23
    v_and_b32 v24, 7, v20
    v_lshl_add_u32 v23, v24, 4, v23
    v_and_b32 v24, 1, v21
    v_lshl_add_u32 v23, v24, 3, v23
    s_add_u32 s19, s18, 0
    s_lshr_b32 s20, s19, 1
    s_lshl_b32 s20, s20, 1
    s_mul_hi_u32 s21, s20, 613566757
    s_mul_i32 s21, s21, 7
    s_sub_u32 s20, s20, s21
    s_lshl_b32 s20, s20, 10
    s_and_b32 s19, s19, 1
    s_lshl_b32 s19, s19, 9
    s_add_u32 s20, s20, s19
    v_add_u32 v5, s20, v23
    s_add_u32 s19, s18, 1
    s_lshr_b32 s20, s19, 1
    s_lshl_b32 s20, s20, 1
    s_mul_hi_u32 s21, s20, 613566757
    s_mul_i32 s21, s21, 7
    s_sub_u32 s20, s20, s21
    s_lshl_b32 s20, s20, 10
    s_and_b32 s19, s19, 1
    s_lshl_b32 s19, s19, 9
    s_add_u32 s20, s20, s19
    v_add_u32 v6, s20, v23
    s_add_u32 s19, s18, 2
    s_lshr_b32 s20, s19, 1
    s_lshl_b32 s20, s20, 1
    s_mul_hi_u32 s21, s20, 613566757
    s_mul_i32 s21, s21, 7
    s_sub_u32 s20, s20, s21
    s_lshl_b32 s20, s20, 10
    s_and_b32 s19, s19, 1
    s_lshl_b32 s19, s19, 9
    s_add_u32 s20, s20, s19
    v_add_u32 v9, s20, v23
    s_add_u32 s19, s18, 3
    s_lshr_b32 s20, s19, 1
    s_lshl_b32 s20, s20, 1
    s_mul_hi_u32 s21, s20, 613566757
    s_mul_i32 s21, s21, 7
    s_sub_u32 s20, s20, s21
    s_lshl_b32 s20, s20, 10
    s_and_b32 s19, s19, 1
    s_lshl_b32 s19, s19, 9
    s_add_u32 s20, s20, s19
    v_add_u32 v10, s20, v23
    s_lshl_b32 s19, s18, 10
    s_add_u32 s37, s19, 1048576
    s_add_u32 s54, s19, 24117248
    s_mul_i32 s19, s12, 1728
    s_add_u32 s19, s19, 88064
    v_mul_u32_u24 v23, 144, v21
    v_lshl_add_u32 v23, v20, 4, v23
    v_add_u32 v7, s19, v23
    v_add_u32 v24, 6784, v7
    v_cmp_lt_u32 vcc, 7, v20
    s_nop 1
    v_cndmask_b32 v7, v7, v24, vcc
    s_lshl_b32 s19, s12, 11
    v_add_u32 v13, s19, v1
    s_add_u32 s19, s19, 1024
    s_cmp_eq_u32 s12, 3
    s_cselect_b32 s19, 0, s19
    v_add_u32 v15, s19, v1
    v_lshrrev_b32 v20, 5, v0
    s_lshl_b32 s16, s12, 1
    v_add_u32 v20, s16, v20
    v_and_b32 v21, 31, v0
    v_lshrrev_b32 v22, 3, v21
    v_min_u32 v22, 2, v22
    v_lshrrev_b32 v23, 1, v21
    v_and_b32 v23, 3, v23
    v_and_b32 v24, 1, v21
    v_mul_u32_u24 v25, 576, v22
    v_mul_u32_u24 v26, 144, v23
    v_add_u32 v25, v25, v26
    v_lshl_add_u32 v25, v20, 4, v25
    v_lshl_add_u32 v25, v24, 3, v25
    v_add_u32 v8, 88064, v25
    v_mov_b32 v26, 88192
    v_cmp_lt_u32 vcc, 19, v21
    s_nop 1
    v_cndmask_b32 v8, v8, v26, vcc
    v_mov_b32 v26, 0xf049f2ca
    v_mov_b32 v27, 0xf049f2ca
    s_mul_i32 s19, s12, 1728
    s_add_u32 s19, s19, 88192
    v_mov_b32 v22, s19
    ds_write_b64 v22, v[26:27]
    v_lshrrev_b32 v25, 2, v21
    v_and_b32 v25, 1, v25
    v_lshlrev_b32 v25, 4, v25
    v_lshl_add_u32 v25, v24, 3, v25
    v_add_u32 v25, v25, v20
    v_lshlrev_b32 v25, 4, v25
    v_lshrrev_b32 v26, 3, v21
    v_and_b32 v26, 1, v26
    v_lshrrev_b32 v27, 1, v21
    v_and_b32 v27, 1, v27
    v_lshl_add_u32 v26, v27, 1, v26
    v_lshl_add_u32 v25, v26, 2, v25
    s_lshl_b32 s16, s13, 9
    v_add_u32 v25, s16, v25
    s_lshr_b32 s16, s13, 2
    s_lshl_b32 s16, s16, 9
    s_add_u32 s16, s16, 8192
    s_bfe_u32 s17, s13, 0x10001
    s_lshl_b32 s17, s17, 8
    s_add_u32 s16, s16, s17
    s_and_b32 s17, s13, 1
    s_lshl_b32 s17, s17, 2
    s_add_u32 s16, s16, s17
    v_lshlrev_b32 v26, 3, v24
    v_add_u32 v26, v26, v20
    v_lshlrev_b32 v26, 4, v26
    v_lshl_add_u32 v26, v27, 3, v26
    v_add_u32 v26, s16, v26
    v_cmp_lt_u32 vcc, 15, v21
    s_nop 1
    v_cndmask_b32 v25, v25, v26, vcc
    v_mov_b32 v26, 0x80000000
    v_cmp_lt_u32 vcc, 19, v21
    s_nop 1
    v_cndmask_b32 v12, v25, v26, vcc
    v_cmp_gt_u32 s[44:45], 20, v21
    s_mov_b32 s56, 1115684864
    s_mov_b32 s60, 0x00ff00ff
    s_mov_b32 s61, 0x00ff00ff
    s_lshl_b32 s58, s12, 2
    v_min_u32 v20, 7, v0
    v_mul_u32_u24 v20, 16, v20
    s_mov_b32 s16, 512
Lcw_13:
    buffer_load_dword v21, v20, s[8:11], s16 offen sc1
    s_waitcnt vmcnt(0)
    v_cmp_gt_u32 vcc, 4, v21
    s_cbranch_vccz Lcw_13_d
    s_sleep 2
    s_sub_u32 s32, s32, 1
    s_cbranch_scc0 Lcw_13
    s_branch L_exit
Lcw_13_d:
    s_add_u32 s16, s37, 14336
    buffer_load_dwordx4 v[100:103], v1, s[8:11], s37 offen offset:0 sc1
    buffer_load_dwordx4 v[108:111], v1, s[8:11], s37 offen offset:1024 sc1
    buffer_load_dwordx4 v[116:119], v1, s[8:11], s37 offen offset:2048 sc1
    buffer_load_dwordx4 v[124:127], v1, s[8:11], s37 offen offset:3072 sc1
    buffer_load_dwordx4 v[104:107], v1, s[8:11], s16 offen offset:0 sc1
    buffer_load_dwordx4 v[112:115], v1, s[8:11], s16 offen offset:1024 sc1
    buffer_load_dwordx4 v[120:123], v1, s[8:11], s16 offen offset:2048 sc1
    buffer_load_dwordx4 v[128:131], v1, s[8:11], s16 offen offset:3072 sc1
    s_add_u32 s37, s37, 28672
    s_waitcnt vmcnt(0) lgkmcnt(0)
    s_barrier
    v_mov_b64 v[44:45], 0
    v_mov_b64 v[46:47], 0
    v_mov_b64 v[48:49], 0
    v_mov_b64 v[50:51], 0
    v_mov_b64 v[52:53], 0
    v_mov_b64 v[54:55], 0
    v_mov_b64 v[56:57], 0
    v_mov_b64 v[58:59], 0
    v_mov_b64 v[60:61], 0
    v_mov_b64 v[62:63], 0
    v_mov_b64 v[64:65], 0
    v_mov_b64 v[66:67], 0
    v_mov_b64 v[68:69], 0
    v_mov_b64 v[70:71], 0
    s_branch LAfirst_15
    .p2align 6
LAtop_14:
    s_sleep 10
LAfirst_15:
    s_add_u32 s16, s33, s35
    s_add_u32 s17, s33, s36
Lpl_16:
    buffer_load_dwordx4 v[160:163], v1, s[8:11], s16 offen sc1
    buffer_load_dwordx4 v[164:167], v1, s[8:11], s17 offen sc1
    s_sub_u32 s32, s32, 1
    s_cbranch_scc1 L_exit
    s_waitcnt vmcnt(0)
    v_max3_u32 v72, v160, v161, v162
    v_max3_u32 v73, v163, v164, v165
    v_max3_u32 v72, v72, v166, v167
    v_max_u32 v72, v72, v73
    v_cmp_eq_u32 vcc, -1, v72
    s_cbranch_vccnz Lpl_16
    ds_write_b128 v13, v[160:163]
    v_smfmac_f32_16x16x64_bf16 v[44:47], v[160:163], a[0:7], v2
    ds_write_b128 v15, v[164:167]
    v_smfmac_f32_16x16x64_bf16 v[48:51], v[160:163], a[48:55], v2
    ds_write_b128 v13, v[160:163] offset:7168
    v_smfmac_f32_16x16x64_bf16 v[52:55], v[160:163], a[96:103], v2
    ds_write_b128 v15, v[164:167] offset:7168
    v_smfmac_f32_16x16x64_bf16 v[56:59], v[160:163], a[144:151], v2
    ds_read_b128 v[84:87], v14 offset:0
    v_smfmac_f32_16x16x64_bf16 v[60:63], v[160:163], a[192:199], v2
    ds_read_b128 v[88:91], v14 offset:1024
    v_smfmac_f32_16x16x64_bf16 v[64:67], v[160:163], a[240:247], v2
    v_smfmac_f32_16x16x64_bf16 v[68:71], v[160:163], v[208:215], v2
    v_smfmac_f32_16x16x64_bf16 v[44:47], v[164:167], a[8:15], v2
    s_waitcnt lgkmcnt(0)
    s_barrier
    v_smfmac_f32_16x16x64_bf16 v[48:51], v[164:167], a[56:63], v2
    ds_read_b128 v[24:27], v13 offset:2048
    v_smfmac_f32_16x16x64_bf16 v[52:55], v[164:167], a[104:111], v2
    ds_read_b128 v[28:31], v13 offset:3072
    v_smfmac_f32_16x16x64_bf16 v[56:59], v[164:167], a[152:159], v2
    ds_read_b128 v[32:35], v13 offset:4096
    v_smfmac_f32_16x16x64_bf16 v[60:63], v[164:167], a[200:207], v2
    ds_read_b128 v[36:39], v13 offset:5120
    v_smfmac_f32_16x16x64_bf16 v[64:67], v[164:167], a[248:255], v2
    ds_read_b128 v[40:43], v13 offset:6144
    v_smfmac_f32_16x16x64_bf16 v[68:71], v[164:167], v[216:223], v2
    s_waitcnt lgkmcnt(4)
    v_smfmac_f32_16x16x64_bf16 v[44:47], v[24:27], a[16:23], v2
    ds_read_b128 v[92:95], v14 offset:2048
    s_waitcnt lgkmcnt(4)
    v_smfmac_f32_16x16x64_bf16 v[44:47], v[28:31], a[24:31], v2
    ds_read_b128 v[96:99], v14 offset:3072
    s_waitcnt lgkmcnt(4)
    v_smfmac_f32_16x16x64_bf16 v[44:47], v[32:35], a[32:39], v2
    ds_read2_b32 v[132:133], v5 offset0:0 offset1:32
    s_waitcnt lgkmcnt(4)
    v_smfmac_f32_16x16x64_bf16 v[44:47], v[36:39], a[40:47], v2
    ds_read2_b32 v[134:135], v5 offset0:1 offset1:33
    s_waitcnt lgkmcnt(4)
    v_smfmac_f32_16x16x64_bf16 v[44:47], v[40:43], v[84:91], v2
    ds_read_b128 v[84:87], v14 offset:4096
    v_smfmac_f32_16x16x64_bf16 v[48:51], v[24:27], a[64:71], v2
    ds_read_b128 v[88:91], v14 offset:5120
    v_smfmac_f32_16x16x64_bf16 v[48:51], v[28:31], a[72:79], v2
    v_cvt_pk_bf16_f32 v72, v44, v45
    v_smfmac_f32_16x16x64_bf16 v[48:51], v[32:35], a[80:87], v2
    v_cvt_pk_bf16_f32 v73, v46, v47
    v_smfmac_f32_16x16x64_bf16 v[48:51], v[36:39], a[88:95], v2
    ds_write_b64 v3, v[72:73] offset:0
    s_waitcnt lgkmcnt(5)
    v_smfmac_f32_16x16x64_bf16 v[48:51], v[40:43], v[92:99], v2
    ds_read_b128 v[92:95], v14 offset:6144
    v_smfmac_f32_16x16x64_bf16 v[52:55], v[24:27], a[112:119], v2
    ds_read_b128 v[96:99], v14 offset:7168
    v_smfmac_f32_16x16x64_bf16 v[52:55], v[28:31], a[120:127], v2
    v_cvt_pk_bf16_f32 v74, v48, v49
    v_smfmac_f32_16x16x64_bf16 v[52:55], v[32:35], a[128:135], v2
    v_cvt_pk_bf16_f32 v75, v50, v51
    v_smfmac_f32_16x16x64_bf16 v[52:55], v[36:39], a[136:143], v2
    ds_write_b64 v3, v[74:75] offset:512
    s_waitcnt lgkmcnt(4)
    v_smfmac_f32_16x16x64_bf16 v[52:55], v[40:43], v[84:91], v2
    ds_read_b64_tr_b16 v[76:77], v4 offset:0
    v_smfmac_f32_16x16x64_bf16 v[56:59], v[24:27], a[160:167], v2
    ds_read_b64_tr_b16 v[78:79], v4 offset:512
    v_smfmac_f32_16x16x64_bf16 v[56:59], v[28:31], a[168:175], v2
    v_cvt_pk_bf16_f32 v72, v52, v53
    v_smfmac_f32_16x16x64_bf16 v[56:59], v[32:35], a[176:183], v2
    v_cvt_pk_bf16_f32 v73, v54, v55
    v_smfmac_f32_16x16x64_bf16 v[56:59], v[36:39], a[184:191], v2
    ds_write_b64 v3, v[72:73] offset:1024
    s_waitcnt lgkmcnt(4)
    v_smfmac_f32_16x16x64_bf16 v[56:59], v[40:43], v[92:99], v2
    ds_read_b128 v[84:87], v14 offset:8192
    v_smfmac_f32_16x16x64_bf16 v[60:63], v[24:27], a[208:215], v2
    ds_read_b128 v[88:91], v14 offset:9216
    v_smfmac_f32_16x16x64_bf16 v[60:63], v[28:31], a[216:223], v2
    v_cvt_pk_bf16_f32 v74, v56, v57
    s_waitcnt lgkmcnt(3)
    v_mfma_f32_16x16x32_bf16 v[148:151], v[100:103], v[76:79], 0
    v_cvt_pk_bf16_f32 v75, v58, v59
    ds_write_b64 v3, v[74:75] offset:1536
    v_mfma_f32_16x16x32_bf16 v[152:155], v[104:107], v[76:79], 0
    ds_read_b128 v[92:95], v14 offset:10240
    ds_read_b64_tr_b16 v[80:81], v4 offset:1024
    v_mfma_f32_16x16x32_bf16 v[156:159], v[132:135], v[76:79], 0
    ds_read_b128 v[96:99], v14 offset:11264
    ds_read_b64_tr_b16 v[82:83], v4 offset:1536
    v_smfmac_f32_16x16x64_bf16 v[60:63], v[32:35], a[224:231], v2
    ds_read2_b32 v[136:137], v6 offset0:0 offset1:32
    v_smfmac_f32_16x16x64_bf16 v[60:63], v[36:39], a[232:239], v2
    ds_read2_b32 v[138:139], v6 offset0:1 offset1:33
    s_waitcnt lgkmcnt(7)
    v_smfmac_f32_16x16x64_bf16 v[60:63], v[40:43], v[84:91], v2
    ds_read_b128 v[84:87], v14 offset:12288
    v_smfmac_f32_16x16x64_bf16 v[64:67], v[24:27], v[176:183], v2
    ds_read_b128 v[88:91], v14 offset:13312
    v_smfmac_f32_16x16x64_bf16 v[64:67], v[28:31], v[184:191], v2
    v_cvt_pk_bf16_f32 v72, v60, v61
    v_smfmac_f32_16x16x64_bf16 v[64:67], v[32:35], v[192:199], v2
    v_cvt_pk_bf16_f32 v73, v62, v63
    v_smfmac_f32_16x16x64_bf16 v[64:67], v[36:39], v[200:207], v2
    ds_write_b64 v3, v[72:73] offset:2048
    s_waitcnt lgkmcnt(6)
    v_smfmac_f32_16x16x64_bf16 v[64:67], v[40:43], v[92:99], v2
    ds_read2_b32 v[140:141], v9 offset0:0 offset1:32
    v_smfmac_f32_16x16x64_bf16 v[68:71], v[24:27], v[224:231], v2
    ds_read2_b32 v[142:143], v9 offset0:1 offset1:33
    v_smfmac_f32_16x16x64_bf16 v[68:71], v[28:31], v[232:239], v2
    v_cvt_pk_bf16_f32 v74, v64, v65
    s_waitcnt lgkmcnt(7)
    v_mfma_f32_16x16x32_bf16 v[148:151], v[108:111], v[80:83], v[148:151]
    ds_read2_b32 v[144:145], v10 offset0:0 offset1:32
    ds_read2_b32 v[146:147], v10 offset0:1 offset1:33
    v_mfma_f32_16x16x32_bf16 v[152:155], v[112:115], v[80:83], v[152:155]
    v_cvt_pk_bf16_f32 v75, v66, v67
    ds_write_b64 v3, v[74:75] offset:2560
    v_mfma_f32_16x16x32_bf16 v[156:159], v[136:139], v[80:83], v[156:159]
    v_smfmac_f32_16x16x64_bf16 v[68:71], v[32:35], v[240:247], v2
    v_smfmac_f32_16x16x64_bf16 v[68:71], v[36:39], v[248:255], v2
    s_waitcnt lgkmcnt(6)
    v_smfmac_f32_16x16x64_bf16 v[68:71], v[40:43], v[84:91], v2
    ds_read_b64_tr_b16 v[76:77], v4 offset:2048
    ds_read_b64_tr_b16 v[78:79], v4 offset:2560
    s_nop 5
    v_cvt_pk_bf16_f32 v72, v68, v69
    v_cvt_pk_bf16_f32 v73, v70, v71
    ds_write_b64 v3, v[72:73] offset:3072
    ds_read_b64_tr_b16 v[80:81], v4 offset:3072
    ds_read_b64_tr_b16 v[82:83], v4 offset:3584
    s_waitcnt lgkmcnt(3)
    v_mfma_f32_16x16x32_bf16 v[148:151], v[116:119], v[76:79], v[148:151]
    v_mfma_f32_16x16x32_bf16 v[152:155], v[120:123], v[76:79], v[152:155]
    v_mfma_f32_16x16x32_bf16 v[156:159], v[140:143], v[76:79], v[156:159]
    s_waitcnt lgkmcnt(0)
    v_mfma_f32_16x16x32_bf16 v[148:151], v[124:127], v[80:83], v[148:151]
    v_mfma_f32_16x16x32_bf16 v[152:155], v[128:131], v[80:83], v[152:155]
    v_mfma_f32_16x16x32_bf16 v[156:159], v[144:147], v[80:83], v[156:159]
    v_add_f32 v148, v148, v148 row_ror:8
    v_add_f32 v149, v149, v149 row_ror:8
    v_add_f32 v150, v150, v150 row_ror:8
    v_add_f32 v151, v151, v151 row_ror:8
    ds_write_b128 v7, v[148:151] offset:0
    v_add_f32 v152, v152, v152 row_ror:8
    v_add_f32 v153, v153, v153 row_ror:8
    v_add_f32 v154, v154, v154 row_ror:8
    v_add_f32 v155, v155, v155 row_ror:8
    ds_write_b128 v7, v[152:155] offset:576
    v_add_f32 v156, v156, v156 row_ror:8
    v_add_f32 v157, v157, v157 row_ror:8
    v_add_f32 v158, v158, v158 row_ror:8
    v_add_f32 v159, v159, v159 row_ror:8
    ds_write_b128 v7, v[156:159] offset:1152
    s_waitcnt vmcnt(0) lgkmcnt(0)
    s_barrier
    ds_read_b64 v[160:161], v8 offset:0
    ds_read_b64 v[162:163], v8 offset:1728
    ds_read_b64 v[164:165], v8 offset:3456
    ds_read_b64 v[166:167], v8 offset:5184
    s_waitcnt lgkmcnt(2)
    v_pk_add_f32 v[160:161], v[160:161], v[162:163]
    s_waitcnt lgkmcnt(0)
    v_pk_add_f32 v[164:165], v[164:165], v[166:167]
    v_pk_add_f32 v[160:161], v[160:161], v[164:165]
    v_max_f32 v162, |v160|, |v161|
    v_cmp_nle_f32 vcc, v162, s56
    s_and_b64 vcc, vcc, s[44:45]
    s_cbranch_vccnz Lslow_18
Lfast_19:
    v_exp_f32 v160, v160
    v_exp_f32 v161, v161
    s_nop 0
    v_add_f32 v163, v160, v161
    s_nop 1
    v_add_f32 v163, v163, v163 row_ror:8
    s_nop 1
    v_add_f32 v163, v163, v163 row_ror:4
    s_nop 1
    v_add_f32 v163, v163, v163 row_ror:2
    s_nop 1
    v_add_f32 v163, v163, v163 row_ror:1
    v_mov_b32 v164, v163
    s_nop 1
    v_permlane16_swap_b32 v163, v164
    v_add_f32 v163, v163, v164
    v_rcp_f32 v163, v163
    s_nop 0
    v_mul_f32 v160, v160, v163
    v_mul_f32 v161, v161, v163
    v_cvt_pk_bf16_f32 v160, v160, v161
    buffer_store_dword v160, v12, s[8:11], s34 offen
    s_add_u32 s16, s14, 2
    s_and_b32 s16, s16, 3
    s_lshl_b32 s16, s16, 14
    s_add_u32 s16, s16, 22020096
    v_mov_b32 v72, -1
    buffer_store_dword v72, v12, s[8:11], s16 offen
    s_add_u32 s16, s37, 14336
    buffer_load_dwordx4 v[100:103], v1, s[8:11], s37 offen offset:0 sc1
    buffer_load_dwordx4 v[108:111], v1, s[8:11], s37 offen offset:1024 sc1
    buffer_load_dwordx4 v[116:119], v1, s[8:11], s37 offen offset:2048 sc1
    buffer_load_dwordx4 v[124:127], v1, s[8:11], s37 offen offset:3072 sc1
    buffer_load_dwordx4 v[104:107], v1, s[8:11], s16 offen offset:0 sc1
    buffer_load_dwordx4 v[112:115], v1, s[8:11], s16 offen offset:1024 sc1
    buffer_load_dwordx4 v[120:123], v1, s[8:11], s16 offen offset:2048 sc1
    buffer_load_dwordx4 v[128:131], v1, s[8:11], s16 offen offset:3072 sc1
    s_add_u32 s37, s37, 28672
    v_mov_b64 v[44:45], 0
    v_mov_b64 v[46:47], 0
    v_mov_b64 v[48:49], 0
    v_mov_b64 v[50:51], 0
    v_mov_b64 v[52:53], 0
    v_mov_b64 v[54:55], 0
    v_mov_b64 v[56:57], 0
    v_mov_b64 v[58:59], 0
    v_mov_b64 v[60:61], 0
    v_mov_b64 v[62:63], 0
    v_mov_b64 v[64:65], 0
    v_mov_b64 v[66:67], 0
    v_mov_b64 v[68:69], 0
    v_mov_b64 v[70:71], 0
    s_add_u32 s14, s14, 1
    s_and_b32 s16, s14, 3
    s_lshl_b32 s17, s16, 13
    s_add_u32 s33, s17, 20971520
    s_lshl_b32 s17, s16, 14
    s_add_u32 s34, s17, 22020096
    s_cmp_lt_u32 s14, 63
    s_cbranch_scc1 LAtop_14
    s_branch L_exit
Lslow_18:
    v_max_f32 v163, v160, v161
    s_nop 1
    v_max_f32 v163, v163, v163 row_ror:8
    s_nop 1
    v_max_f32 v163, v163, v163 row_ror:4
    s_nop 1
    v_max_f32 v163, v163, v163 row_ror:2
    s_nop 1
    v_max_f32 v163, v163, v163 row_ror:1
    v_mov_b32 v164, v163
    s_nop 1
    v_permlane16_swap_b32 v163, v164
    v_max_f32 v163, v163, v164
    v_sub_f32 v160, v160, v163
    v_sub_f32 v161, v161, v163
    s_branch Lfast_19
L_roleB:
    s_sub_u32 s13, s13, 16
    s_lshl_b32 s19, s12, 2
    v_min_u32 v20, 3, v0
    v_mul_u32_u24 v20, 16, v20
    s_mul_i32 s16, s19, 16
    s_add_u32 s16, s16, 256
Lcw_20:
    buffer_load_dword v21, v20, s[8:11], s16 offen sc1
    s_waitcnt vmcnt(0)
    v_cmp_gt_u32 vcc, 7, v21
    s_cbranch_vccz Lcw_20_d
    s_sleep 2
    s_sub_u32 s32, s32, 1
    s_cbranch_scc0 Lcw_20
    s_branch L_exit
Lcw_20_d:
    v_lshlrev_b32 v1, 4, v0
    v_and_b32 v20, 15, v0
    v_mov_b32 v2, 0x4444
    v_mov_b32 v21, 0xeeee
    v_cmp_lt_u32 vcc, 7, v20
    s_nop 1
    v_cndmask_b32 v2, v2, v21, vcc
    s_lshl_b32 s16, s12, 2
    s_mul_i32 s16, s16, 28
    s_lshl_b32 s17, s13, 1
    s_add_u32 s16, s16, s17
    s_mul_i32 s16, s16, 14336
    s_add_u32 s16, s16, 12582912
    s_lshl_b32 s18, s12, 15
    s_add_u32 s18, s18, 8192
    v_add_u32 v5, s18, v1
    s_add_u32 s17, s16, 10240
    s_add_u32 m0, s18, 0
    s_nop 0
    buffer_load_dwordx4 v1, s[8:11], s17 offen offset:0 sc1 lds
    buffer_load_dwordx4 v1, s[8:11], s17 offen offset:1024 sc1 lds
    buffer_load_dwordx4 v1, s[8:11], s17 offen offset:2048 sc1 lds
    buffer_load_dwordx4 v1, s[8:11], s17 offen offset:3072 sc1 lds
    s_add_u32 s17, s16, 24576
    s_add_u32 m0, s18, 4096
    s_nop 0
    buffer_load_dwordx4 v1, s[8:11], s17 offen offset:0 sc1 lds
    buffer_load_dwordx4 v1, s[8:11], s17 offen offset:1024 sc1 lds
    buffer_load_dwordx4 v1, s[8:11], s17 offen offset:2048 sc1 lds
    buffer_load_dwordx4 v1, s[8:11], s17 offen offset:3072 sc1 lds
    s_add_u32 s17, s16, 411648
    s_add_u32 m0, s18, 8192
    s_nop 0
    buffer_load_dwordx4 v1, s[8:11], s17 offen offset:0 sc1 lds
    buffer_load_dwordx4 v1, s[8:11], s17 offen offset:1024 sc1 lds
    buffer_load_dwordx4 v1, s[8:11], s17 offen offset:2048 sc1 lds
    buffer_load_dwordx4 v1, s[8:11], s17 offen offset:3072 sc1 lds
    s_add_u32 s17, s16, 425984
    s_add_u32 m0, s18, 12288
    s_nop 0
    buffer_load_dwordx4 v1, s[8:11], s17 offen offset:0 sc1 lds
    buffer_load_dwordx4 v1, s[8:11], s17 offen offset:1024 sc1 lds
    buffer_load_dwordx4 v1, s[8:11], s17 offen offset:2048 sc1 lds
    buffer_load_dwordx4 v1, s[8:11], s17 offen offset:3072 sc1 lds
    s_add_u32 s17, s16, 813056
    s_add_u32 m0, s18, 16384
    s_nop 0
    buffer_load_dwordx4 v1, s[8:11], s17 offen offset:0 sc1 lds
    buffer_load_dwordx4 v1, s[8:11], s17 offen offset:1024 sc1 lds
    buffer_load_dwordx4 v1, s[8:11], s17 offen offset:2048 sc1 lds
    buffer_load_dwordx4 v1, s[8:11], s17 offen offset:3072 sc1 lds
    s_add_u32 s17, s16, 827392
    s_add_u32 m0, s18, 20480
    s_nop 0
    buffer_load_dwordx4 v1, s[8:11], s17 offen offset:0 sc1 lds
    buffer_load_dwordx4 v1, s[8:11], s17 offen offset:1024 sc1 lds
    buffer_load_dwordx4 v1, s[8:11], s17 offen offset:2048 sc1 lds
    buffer_load_dwordx4 v1, s[8:11], s17 offen offset:3072 sc1 lds
    s_add_u32 s17, s16, 1214464
    s_add_u32 m0, s18, 24576
    s_nop 0
    buffer_load_dwordx4 v1, s[8:11], s17 offen offset:0 sc1 lds
    buffer_load_dwordx4 v1, s[8:11], s17 offen offset:1024 sc1 lds
    buffer_load_dwordx4 v1, s[8:11], s17 offen offset:2048 sc1 lds
    buffer_load_dwordx4 v1, s[8:11], s17 offen offset:3072 sc1 lds
    s_add_u32 s17, s16, 1228800
    s_add_u32 m0, s18, 28672
    s_nop 0
    buffer_load_dwordx4 v1, s[8:11], s17 offen offset:0 sc1 lds
    buffer_load_dwordx4 v1, s[8:11], s17 offen offset:1024 sc1 lds
    buffer_load_dwordx4 v1, s[8:11], s17 offen offset:2048 sc1 lds
    buffer_load_dwordx4 v1, s[8:11], s17 offen offset:3072 sc1 lds
    s_add_u32 s17, s16, 0
    buffer_load_dwordx4 a[0:3], v1, s[8:11], s17 offen offset:0 sc1
    buffer_load_dwordx4 a[4:7], v1, s[8:11], s17 offen offset:1024 sc1
    s_add_u32 s17, s16, 2048
    buffer_load_dwordx4 a[8:11], v1, s[8:11], s17 offen offset:0 sc1
    buffer_load_dwordx4 a[12:15], v1, s[8:11], s17 offen offset:1024 sc1
    s_add_u32 s17, s16, 4096
    buffer_load_dwordx4 a[16:19], v1, s[8:11], s17 offen offset:0 sc1
    buffer_load_dwordx4 a[20:23], v1, s[8:11], s17 offen offset:1024 sc1
    s_add_u32 s17, s16, 6144
    buffer_load_dwordx4 a[24:27], v1, s[8:11], s17 offen offset:0 sc1
    buffer_load_dwordx4 a[28:31], v1, s[8:11], s17 offen offset:1024 sc1
    s_add_u32 s17, s16, 8192
    buffer_load_dwordx4 a[32:35], v1, s[8:11], s17 offen offset:0 sc1
    buffer_load_dwordx4 a[36:39], v1, s[8:11], s17 offen offset:1024 sc1
    s_add_u32 s17, s16, 14336
    buffer_load_dwordx4 a[40:43], v1, s[8:11], s17 offen offset:0 sc1
    buffer_load_dwordx4 a[44:47], v1, s[8:11], s17 offen offset:1024 sc1
    s_add_u32 s17, s16, 16384
    buffer_load_dwordx4 a[48:51], v1, s[8:11], s17 offen offset:0 sc1
    buffer_load_dwordx4 a[52:55], v1, s[8:11], s17 offen offset:1024 sc1
    s_add_u32 s17, s16, 18432
    buffer_load_dwordx4 a[56:59], v1, s[8:11], s17 offen offset:0 sc1
    buffer_load_dwordx4 a[60:63], v1, s[8:11], s17 offen offset:1024 sc1
    s_add_u32 s17, s16, 20480
    buffer_load_dwordx4 a[64:67], v1, s[8:11], s17 offen offset:0 sc1
    buffer_load_dwordx4 a[68:71], v1, s[8:11], s17 offen offset:1024 sc1
    s_add_u32 s17, s16, 22528
    buffer_load_dwordx4 a[72:75], v1, s[8:11], s17 offen offset:0 sc1
    buffer_load_dwordx4 a[76:79], v1, s[8:11], s17 offen offset:1024 sc1
    s_add_u32 s17, s16, 401408
    buffer_load_dwordx4 a[80:83], v1, s[8:11], s17 offen offset:0 sc1
    buffer_load_dwordx4 a[84:87], v1, s[8:11], s17 offen offset:1024 sc1
    s_add_u32 s17, s16, 403456
    buffer_load_dwordx4 a[88:91], v1, s[8:11], s17 offen offset:0 sc1
    buffer_load_dwordx4 a[92:95], v1, s[8:11], s17 offen offset:1024 sc1
    s_add_u32 s17, s16, 405504
    buffer_load_dwordx4 a[96:99], v1, s[8:11], s17 offen offset:0 sc1
    buffer_load_dwordx4 a[100:103], v1, s[8:11], s17 offen offset:1024 sc1
    s_add_u32 s17, s16, 407552
    buffer_load_dwordx4 a[104:107], v1, s[8:11], s17 offen offset:0 sc1
    buffer_load_dwordx4 a[108:111], v1, s[8:11], s17 offen offset:1024 sc1
    s_add_u32 s17, s16, 409600
    buffer_load_dwordx4 a[112:115], v1, s[8:11], s17 offen offset:0 sc1
    buffer_load_dwordx4 a[116:119], v1, s[8:11], s17 offen offset:1024 sc1
    s_add_u32 s17, s16, 415744
    buffer_load_dwordx4 a[120:123], v1, s[8:11], s17 offen offset:0 sc1
    buffer_load_dwordx4 a[124:127], v1, s[8:11], s17 offen offset:1024 sc1
    s_add_u32 s17, s16, 417792
    buffer_load_dwordx4 a[128:131], v1, s[8:11], s17 offen offset:0 sc1
    buffer_load_dwordx4 a[132:135], v1, s[8:11], s17 offen offset:1024 sc1
    s_add_u32 s17, s16, 419840
    buffer_load_dwordx4 a[136:139], v1, s[8:11], s17 offen offset:0 sc1
    buffer_load_dwordx4 a[140:143], v1, s[8:11], s17 offen offset:1024 sc1
    s_add_u32 s17, s16, 421888
    buffer_load_dwordx4 a[144:147], v1, s[8:11], s17 offen offset:0 sc1
    buffer_load_dwordx4 a[148:151], v1, s[8:11], s17 offen offset:1024 sc1
    s_add_u32 s17, s16, 423936
    buffer_load_dwordx4 a[152:155], v1, s[8:11], s17 offen offset:0 sc1
    buffer_load_dwordx4 a[156:159], v1, s[8:11], s17 offen offset:1024 sc1
    s_add_u32 s17, s16, 802816
    buffer_load_dwordx4 a[160:163], v1, s[8:11], s17 offen offset:0 sc1
    buffer_load_dwordx4 a[164:167], v1, s[8:11], s17 offen offset:1024 sc1
    s_add_u32 s17, s16, 804864
    buffer_load_dwordx4 a[168:171], v1, s[8:11], s17 offen offset:0 sc1
    buffer_load_dwordx4 a[172:175], v1, s[8:11], s17 offen offset:1024 sc1
    s_add_u32 s17, s16, 806912
    buffer_load_dwordx4 a[176:179], v1, s[8:11], s17 offen offset:0 sc1
    buffer_load_dwordx4 a[180:183], v1, s[8:11], s17 offen offset:1024 sc1
    s_add_u32 s17, s16, 808960
    buffer_load_dwordx4 a[184:187], v1, s[8:11], s17 offen offset:0 sc1
    buffer_load_dwordx4 a[188:191], v1, s[8:11], s17 offen offset:1024 sc1
    s_add_u32 s17, s16, 811008
    buffer_load_dwordx4 a[192:195], v1, s[8:11], s17 offen offset:0 sc1
    buffer_load_dwordx4 a[196:199], v1, s[8:11], s17 offen offset:1024 sc1
    s_add_u32 s17, s16, 817152
    buffer_load_dwordx4 a[200:203], v1, s[8:11], s17 offen offset:0 sc1
    buffer_load_dwordx4 a[204:207], v1, s[8:11], s17 offen offset:1024 sc1
    s_add_u32 s17, s16, 819200
    buffer_load_dwordx4 a[208:211], v1, s[8:11], s17 offen offset:0 sc1
    buffer_load_dwordx4 a[212:215], v1, s[8:11], s17 offen offset:1024 sc1
    s_add_u32 s17, s16, 821248
    buffer_load_dwordx4 a[216:219], v1, s[8:11], s17 offen offset:0 sc1
    buffer_load_dwordx4 a[220:223], v1, s[8:11], s17 offen offset:1024 sc1
    s_add_u32 s17, s16, 823296
    buffer_load_dwordx4 a[224:227], v1, s[8:11], s17 offen offset:0 sc1
    buffer_load_dwordx4 a[228:231], v1, s[8:11], s17 offen offset:1024 sc1
    s_add_u32 s17, s16, 825344
    buffer_load_dwordx4 a[232:235], v1, s[8:11], s17 offen offset:0 sc1
    buffer_load_dwordx4 a[236:239], v1, s[8:11], s17 offen offset:1024 sc1
    s_add_u32 s17, s16, 1204224
    buffer_load_dwordx4 a[240:243], v1, s[8:11], s17 offen offset:0 sc1
    buffer_load_dwordx4 a[244:247], v1, s[8:11], s17 offen offset:1024 sc1
    s_add_u32 s17, s16, 1206272
    buffer_load_dwordx4 a[248:251], v1, s[8:11], s17 offen offset:0 sc1
    buffer_load_dwordx4 a[252:255], v1, s[8:11], s17 offen offset:1024 sc1
    s_add_u32 s17, s16, 1208320
    buffer_load_dwordx4 v[192:195], v1, s[8:11], s17 offen offset:0 sc1
    buffer_load_dwordx4 v[196:199], v1, s[8:11], s17 offen offset:1024 sc1
    s_add_u32 s17, s16, 1210368
    buffer_load_dwordx4 v[200:203], v1, s[8:11], s17 offen offset:0 sc1
    buffer_load_dwordx4 v[204:207], v1, s[8:11], s17 offen offset:1024 sc1
    s_add_u32 s17, s16, 1212416
    buffer_load_dwordx4 v[208:211], v1, s[8:11], s17 offen offset:0 sc1
    buffer_load_dwordx4 v[212:215], v1, s[8:11], s17 offen offset:1024 sc1
    s_add_u32 s17, s16, 1218560
    buffer_load_dwordx4 v[216:219], v1, s[8:11], s17 offen offset:0 sc1
    buffer_load_dwordx4 v[220:223], v1, s[8:11], s17 offen offset:1024 sc1
    s_add_u32 s17, s16, 1220608
    buffer_load_dwordx4 v[224:227], v1, s[8:11], s17 offen offset:0 sc1
    buffer_load_dwordx4 v[228:231], v1, s[8:11], s17 offen offset:1024 sc1
    s_add_u32 s17, s16, 1222656
    buffer_load_dwordx4 v[232:235], v1, s[8:11], s17 offen offset:0 sc1
    buffer_load_dwordx4 v[236:239], v1, s[8:11], s17 offen offset:1024 sc1
    s_add_u32 s17, s16, 1224704
    buffer_load_dwordx4 v[240:243], v1, s[8:11], s17 offen offset:0 sc1
    buffer_load_dwordx4 v[244:247], v1, s[8:11], s17 offen offset:1024 sc1
    s_add_u32 s17, s16, 1226752
    buffer_load_dwordx4 v[248:251], v1, s[8:11], s17 offen offset:0 sc1
    buffer_load_dwordx4 v[252:255], v1, s[8:11], s17 offen offset:1024 sc1
    v_and_b32 v20, 15, v0
    v_add_u32 v3, s35, v1
    v_add_u32 v4, s36, v1
    v_lshrrev_b32 v21, 5, v0
    v_lshlrev_b32 v21, 4, v21
    v_add_u32 v21, v21, v20
    v_lshlrev_b32 v6, 4, v21
    v_lshrrev_b32 v21, 5, v0
    v_lshlrev_b32 v21, 9, v21
    v_and_b32 v22, 7, v0
    v_lshl_add_u32 v21, v22, 6, v21
    v_bfe_u32 v22, v0, 4, 1
    v_lshl_add_u32 v21, v22, 5, v21
    v_bfe_u32 v22, v0, 3, 1
    v_lshl_add_u32 v21, v22, 4, v21
    v_mov_b32 v13, v1
    s_mul_i32 s16, s12, 1184
    s_add_u32 s16, s16, 139264
    v_lshrrev_b32 v21, 4, v0
    v_mul_u32_u24 v21, 272, v21
    v_lshl_add_u32 v21, v20, 4, v21
    v_add_u32 v7, s16, v21
    v_and_b32 v21, 31, v0
    v_lshrrev_b32 v22, 2, v21
    v_and_b32 v23, 3, v21
    v_and_b32 v24, 1, v23
    v_lshrrev_b32 v25, 1, v23
    s_lshr_b32 s16, s12, 1
    s_lshl_b32 s16, s16, 3
    s_and_b32 s17, s12, 1
    s_lshl_b32 s17, s17, 1
    s_add_u32 s16, s16, s17
    v_lshlrev_b32 v25, 2, v25
    v_add_u32 v25, s16, v25
    v_lshrrev_b32 v26, 2, v22
    v_mul_u32_u24 v26, 272, v26
    v_lshl_add_u32 v26, v25, 4, v26
    v_mul_u32_u24 v24, 544, v24
    v_add_u32 v26, v26, v24
    v_and_b32 v27, 3, v22
    v_lshl_add_u32 v26, v27, 2, v26
    v_add_u32 v8, 139264, v26
    v_add_u32 v9, 1184, v8
    v_add_u32 v10, 1184, v9
    v_add_u32 v11, 1184, v10
    s_lshl_b32 s16, s13, 9
    s_lshl_b32 s17, s12, 7
    s_add_u32 s16, s16, s17
    v_lshlrev_b32 v26, 2, v21
    v_add_u32 v26, s16, v26
    v_mov_b32 v27, 0x80000000
    v_cmp_lt_u32 vcc, 31, v0
    s_nop 1
    v_cndmask_b32 v12, v26, v27, vcc
    s_lshl_b32 s16, s12, 2
    s_mul_i32 s16, s16, 28
    s_lshl_b32 s17, s13, 1
    s_add_u32 s16, s16, s17
    s_lshl_b32 s16, s16, 10
    s_add_u32 s38, s16, 35651584
    s_lshl_b32 s16, s12, 1
    s_mul_i32 s16, s16, 28
    s_add_u32 s16, s16, s17
    s_lshl_b32 s16, s16, 10
    s_add_u32 s55, s16, 100663296
    s_lshl_b32 s16, s13, 2
    s_add_u32 s16, s16, s12
    s_lshl_b32 s58, s16, 2
    s_waitcnt vmcnt(0) lgkmcnt(0)
    s_barrier
    v_min_u32 v20, 7, v0
    v_mul_u32_u24 v20, 16, v20
    s_mov_b32 s16, 512
Lcw_21:
    buffer_load_dword v21, v20, s[8:11], s16 offen sc1
    s_waitcnt vmcnt(0)
    v_cmp_gt_u32 vcc, 4, v21
    s_cbranch_vccz Lcw_21_d
    s_sleep 2
    s_sub_u32 s32, s32, 1
    s_cbranch_scc0 Lcw_21
    s_branch L_exit
Lcw_21_d:
    s_cmp_ge_u32 s14, 64
    s_cbranch_scc1 Lwu_22_d
    s_lshr_b32 s21, s14, 3
    s_lshl_b32 s21, s21, 10
    s_add_u32 s21, s21, 57344
    v_min_u32 v20, 55, v0
    v_lshlrev_b32 v20, 4, v20
Lwu_22:
    buffer_load_dwordx4 v[22:25], v20, s[8:11], s21 offen sc1
    s_waitcnt vmcnt(0)
    v_min_u32 v22, v22, v23
    v_min3_u32 v22, v22, v24, v25
    v_cmp_eq_u32 vcc, 0, v22
    s_cbranch_vccz Lwu_22_d
    s_sleep 2
    s_sub_u32 s32, s32, 1
    s_cbranch_scc0 Lwu_22
    s_branch L_exit
Lwu_22_d:
    v_mov_b64 v[44:45], 0
    v_mov_b64 v[46:47], 0
    v_mov_b64 v[48:49], 0
    v_mov_b64 v[50:51], 0
    v_mov_b64 v[52:53], 0
    v_mov_b64 v[54:55], 0
    v_mov_b64 v[56:57], 0
    v_mov_b64 v[58:59], 0
    v_mov_b64 v[60:61], 0
    v_mov_b64 v[62:63], 0
    v_mov_b64 v[64:65], 0
    v_mov_b64 v[66:67], 0
    v_mov_b64 v[68:69], 0
    v_mov_b64 v[70:71], 0
    v_mov_b64 v[72:73], 0
    v_mov_b64 v[74:75], 0
    v_mov_b64 v[168:169], 0
    v_mov_b64 v[170:171], 0
    v_mov_b64 v[172:173], 0
    v_mov_b64 v[174:175], 0
    s_branch LBfirst_24
    .p2align 6
LBtop_23:
    s_sleep 1
LBfirst_24:
    s_add_u32 s16, s33, s35
    s_add_u32 s17, s33, s36
Lpl_25:
    buffer_load_dwordx4 v[156:159], v1, s[8:11], s16 offen sc1
    buffer_load_dwordx4 v[160:163], v1, s[8:11], s17 offen sc1
    s_sub_u32 s32, s32, 1
    s_cbranch_scc1 L_exit
    s_waitcnt vmcnt(0)
    v_max3_u32 v188, v156, v157, v158
    v_max3_u32 v189, v159, v160, v161
    v_max3_u32 v188, v188, v162, v163
    v_max_u32 v188, v188, v189
    v_cmp_eq_u32 vcc, -1, v188
    s_cbranch_vccnz Lpl_25
    ds_write_b128 v3, v[156:159]
    ds_write_b128 v4, v[160:163]
    s_add_u32 s16, s38, 0
    buffer_load_dwordx4 v[124:127], v1, s[8:11], s16 offen offset:0 sc1
    buffer_load_dwordx4 v[132:135], v1, s[8:11], s16 offen offset:1024 sc1
    s_add_u32 s16, s38, 28672
    buffer_load_dwordx4 v[128:131], v1, s[8:11], s16 offen offset:0 sc1
    buffer_load_dwordx4 v[136:139], v1, s[8:11], s16 offen offset:1024 sc1
    s_add_u32 s16, s38, 57344
    buffer_load_dwordx4 v[140:143], v1, s[8:11], s16 offen offset:0 sc1
    buffer_load_dwordx4 v[148:151], v1, s[8:11], s16 offen offset:1024 sc1
    s_add_u32 s16, s38, 86016
    buffer_load_dwordx4 v[144:147], v1, s[8:11], s16 offen offset:0 sc1
    buffer_load_dwordx4 v[152:155], v1, s[8:11], s16 offen offset:1024 sc1
    s_add_u32 s38, s38, 458752
    s_waitcnt lgkmcnt(0)
    s_barrier
    ds_read_b128 v[16:19], v1 offset:0
    ds_read_b128 v[20:23], v1 offset:1024
    ds_read_b128 v[24:27], v1 offset:2048
    ds_read_b128 v[28:31], v1 offset:3072
    ds_read_b128 v[32:35], v1 offset:4096
    ds_read_b128 v[36:39], v1 offset:5120
    ds_read_b128 v[40:43], v1 offset:6144
    ds_read_b128 v[92:95], v5 offset:0
    ds_read_b128 v[96:99], v5 offset:1024
    ds_read_b128 v[100:103], v5 offset:2048
    ds_read_b128 v[104:107], v5 offset:3072
    s_add_u32 s16, s14, 2
    s_and_b32 s16, s16, 3
    s_lshl_b32 s16, s16, 13
    s_add_u32 s16, s16, 20971520
    v_mov_b32 v188, -1
    buffer_store_dword v188, v12, s[8:11], s16 offen
    s_waitcnt lgkmcnt(10)
    v_smfmac_f32_16x16x64_bf16 v[44:47], v[16:19], a[0:7], v2
    ds_read_b128 v[108:111], v5 offset:4096
    s_waitcnt lgkmcnt(10)
    v_smfmac_f32_16x16x64_bf16 v[44:47], v[20:23], a[8:15], v2
    ds_read_b128 v[112:115], v5 offset:5120
    s_waitcnt lgkmcnt(10)
    v_smfmac_f32_16x16x64_bf16 v[44:47], v[24:27], a[16:23], v2
    ds_read_b128 v[116:119], v5 offset:6144
    s_waitcnt lgkmcnt(10)
    v_smfmac_f32_16x16x64_bf16 v[44:47], v[28:31], a[24:31], v2
    ds_read_b128 v[120:123], v5 offset:7168
    s_waitcnt lgkmcnt(10)
    v_smfmac_f32_16x16x64_bf16 v[44:47], v[32:35], a[32:39], v2
    s_waitcnt lgkmcnt(9)
    s_waitcnt lgkmcnt(4)
    v_smfmac_f32_16x16x64_bf16 v[44:47], v[36:39], v[92:99], v2
    s_waitcnt lgkmcnt(8)
    v_smfmac_f32_16x16x64_bf16 v[44:47], v[40:43], v[100:107], v2
    v_smfmac_f32_16x16x64_bf16 v[48:51], v[16:19], a[40:47], v2
    ds_read_b128 v[92:95], v5 offset:8192
    v_smfmac_f32_16x16x64_bf16 v[48:51], v[20:23], a[48:55], v2
    ds_read_b128 v[96:99], v5 offset:9216
    v_smfmac_f32_16x16x64_bf16 v[48:51], v[24:27], a[56:63], v2
    ds_read_b128 v[100:103], v5 offset:10240
    v_smfmac_f32_16x16x64_bf16 v[48:51], v[28:31], a[64:71], v2
    ds_read_b128 v[104:107], v5 offset:11264
    v_smfmac_f32_16x16x64_bf16 v[48:51], v[32:35], a[72:79], v2
    v_cvt_pk_bf16_f32 v76, v44, v45
    s_waitcnt lgkmcnt(4)
    v_smfmac_f32_16x16x64_bf16 v[48:51], v[36:39], v[108:115], v2
    v_cvt_pk_bf16_f32 v77, v46, v47
    v_smfmac_f32_16x16x64_bf16 v[48:51], v[40:43], v[116:123], v2
    v_smfmac_f32_16x16x64_bf16 v[52:55], v[16:19], a[80:87], v2
    ds_read_b128 v[108:111], v5 offset:12288
    v_smfmac_f32_16x16x64_bf16 v[52:55], v[20:23], a[88:95], v2
    ds_read_b128 v[112:115], v5 offset:13312
    v_smfmac_f32_16x16x64_bf16 v[52:55], v[24:27], a[96:103], v2
    ds_read_b128 v[116:119], v5 offset:14336
    v_smfmac_f32_16x16x64_bf16 v[52:55], v[28:31], a[104:111], v2
    ds_read_b128 v[120:123], v5 offset:15360
    v_smfmac_f32_16x16x64_bf16 v[52:55], v[32:35], a[112:119], v2
    v_cvt_pk_bf16_f32 v84, v48, v49
    s_waitcnt lgkmcnt(4)
    v_smfmac_f32_16x16x64_bf16 v[52:55], v[36:39], v[92:99], v2
    v_cvt_pk_bf16_f32 v85, v50, v51
    v_smfmac_f32_16x16x64_bf16 v[52:55], v[40:43], v[100:107], v2
    v_smfmac_f32_16x16x64_bf16 v[56:59], v[16:19], a[120:127], v2
    ds_read_b128 v[92:95], v5 offset:16384
    v_smfmac_f32_16x16x64_bf16 v[56:59], v[20:23], a[128:135], v2
    ds_read_b128 v[96:99], v5 offset:17408
    v_smfmac_f32_16x16x64_bf16 v[56:59], v[24:27], a[136:143], v2
    ds_read_b128 v[100:103], v5 offset:18432
    v_smfmac_f32_16x16x64_bf16 v[56:59], v[28:31], a[144:151], v2
    ds_read_b128 v[104:107], v5 offset:19456
    v_smfmac_f32_16x16x64_bf16 v[56:59], v[32:35], a[152:159], v2
    v_cvt_pk_bf16_f32 v78, v52, v53
    s_waitcnt lgkmcnt(4)
    v_smfmac_f32_16x16x64_bf16 v[56:59], v[36:39], v[108:115], v2
    v_cvt_pk_bf16_f32 v79, v54, v55
    v_smfmac_f32_16x16x64_bf16 v[56:59], v[40:43], v[116:123], v2
    v_smfmac_f32_16x16x64_bf16 v[60:63], v[16:19], a[160:167], v2
    ds_read_b128 v[108:111], v5 offset:20480
    v_smfmac_f32_16x16x64_bf16 v[60:63], v[20:23], a[168:175], v2
    ds_read_b128 v[112:115], v5 offset:21504
    v_smfmac_f32_16x16x64_bf16 v[60:63], v[24:27], a[176:183], v2
    ds_read_b128 v[116:119], v5 offset:22528
    v_smfmac_f32_16x16x64_bf16 v[60:63], v[28:31], a[184:191], v2
    ds_read_b128 v[120:123], v5 offset:23552
    v_smfmac_f32_16x16x64_bf16 v[60:63], v[32:35], a[192:199], v2
    v_cvt_pk_bf16_f32 v86, v56, v57
    s_waitcnt lgkmcnt(4)
    v_smfmac_f32_16x16x64_bf16 v[60:63], v[36:39], v[92:99], v2
    v_cvt_pk_bf16_f32 v87, v58, v59
    v_smfmac_f32_16x16x64_bf16 v[60:63], v[40:43], v[100:107], v2
    v_smfmac_f32_16x16x64_bf16 v[64:67], v[16:19], a[200:207], v2
    ds_read_b128 v[92:95], v5 offset:24576
    v_smfmac_f32_16x16x64_bf16 v[64:67], v[20:23], a[208:215], v2
    ds_read_b128 v[96:99], v5 offset:25600
    v_smfmac_f32_16x16x64_bf16 v[64:67], v[24:27], a[216:223], v2
    ds_read_b128 v[100:103], v5 offset:26624
    v_smfmac_f32_16x16x64_bf16 v[64:67], v[28:31], a[224:231], v2
    ds_read_b128 v[104:107], v5 offset:27648
    v_smfmac_f32_16x16x64_bf16 v[64:67], v[32:35], a[232:239], v2
    v_cvt_pk_bf16_f32 v80, v60, v61
    s_waitcnt lgkmcnt(4)
    v_smfmac_f32_16x16x64_bf16 v[64:67], v[36:39], v[108:115], v2
    v_cvt_pk_bf16_f32 v81, v62, v63
    v_smfmac_f32_16x16x64_bf16 v[64:67], v[40:43], v[116:123], v2
    v_smfmac_f32_16x16x64_bf16 v[68:71], v[16:19], a[240:247], v2
    ds_read_b128 v[108:111], v5 offset:28672
    v_smfmac_f32_16x16x64_bf16 v[68:71], v[20:23], a[248:255], v2
    ds_read_b128 v[112:115], v5 offset:29696
    v_smfmac_f32_16x16x64_bf16 v[68:71], v[24:27], v[192:199], v2
    ds_read_b128 v[116:119], v5 offset:30720
    v_smfmac_f32_16x16x64_bf16 v[68:71], v[28:31], v[200:207], v2
    ds_read_b128 v[120:123], v5 offset:31744
    v_smfmac_f32_16x16x64_bf16 v[68:71], v[32:35], v[208:215], v2
    v_cvt_pk_bf16_f32 v88, v64, v65
    s_waitcnt lgkmcnt(4)
    v_smfmac_f32_16x16x64_bf16 v[68:71], v[36:39], v[92:99], v2
    v_cvt_pk_bf16_f32 v89, v66, v67
    v_smfmac_f32_16x16x64_bf16 v[68:71], v[40:43], v[100:107], v2
    v_smfmac_f32_16x16x64_bf16 v[72:75], v[16:19], v[216:223], v2
    v_smfmac_f32_16x16x64_bf16 v[72:75], v[20:23], v[224:231], v2
    v_smfmac_f32_16x16x64_bf16 v[72:75], v[24:27], v[232:239], v2
    v_smfmac_f32_16x16x64_bf16 v[72:75], v[28:31], v[240:247], v2
    v_smfmac_f32_16x16x64_bf16 v[72:75], v[32:35], v[248:255], v2
    v_cvt_pk_bf16_f32 v82, v68, v69
    s_waitcnt lgkmcnt(0)
    v_smfmac_f32_16x16x64_bf16 v[72:75], v[36:39], v[108:115], v2
    v_cvt_pk_bf16_f32 v83, v70, v71
    v_smfmac_f32_16x16x64_bf16 v[72:75], v[40:43], v[116:123], v2
    s_nop 7
    v_cvt_pk_bf16_f32 v90, v72, v73
    v_cvt_pk_bf16_f32 v91, v74, v75
    s_lshl_b32 s16, s12, 11
    s_add_u32 s16, s16, s34
    s_lshl_b32 s17, s12, 9
    s_add_u32 s17, s17, s34
    s_add_u32 s17, s17, 8192
    s_add_u32 s18, s14, 1
    s_lshl_b32 s19, s18, 13
    s_and_b32 s18, s18, 3
    s_lshl_b32 s18, s18, 13
    s_add_u32 s18, s18, 20971520
    buffer_load_dwordx4 v[164:167], v6, s[8:11], s17 offen sc1
    buffer_load_dwordx4 v[156:159], v13, s[8:11], s16 offen sc1
    buffer_load_dwordx4 v[160:163], v13, s[8:11], s16 offen offset:1024 sc1
Lq_27:
    buffer_load_dwordx4 v[184:187], v6, s[8:11], s17 offen sc1
    buffer_load_dwordx4 v[176:179], v13, s[8:11], s16 offen sc1
    buffer_load_dwordx4 v[180:183], v13, s[8:11], s16 offen offset:1024 sc1
    s_waitcnt vmcnt(3)
    v_max3_u32 v188, v156, v157, v158
    v_max3_u32 v189, v159, v160, v161
    v_max3_u32 v188, v188, v162, v163
    v_max3_u32 v189, v189, v164, v165
    v_max3_u32 v188, v188, v166, v167
    v_max_u32 v188, v188, v189
    v_cmp_eq_u32 vcc, -1, v188
    s_cbranch_vccnz Lqa_28
    v_smfmac_f32_16x16x64_bf16 v[168:171], v[164:167], v[76:83], v2
    v_smfmac_f32_16x16x64_bf16 v[172:175], v[164:167], v[84:91], v2
    v_smfmac_f32_16x16x64_bf16 v[168:171], v[156:159], v[124:131], v2
    v_smfmac_f32_16x16x64_bf16 v[172:175], v[156:159], v[132:139], v2
    v_smfmac_f32_16x16x64_bf16 v[168:171], v[160:163], v[140:147], v2
    v_smfmac_f32_16x16x64_bf16 v[172:175], v[160:163], v[148:155], v2
    s_nop 7
    v_permlane32_swap_b32 v168, v172
    v_permlane32_swap_b32 v169, v173
    v_permlane32_swap_b32 v170, v174
    v_permlane32_swap_b32 v171, v175
    v_add_f32 v168, v168, v172
    v_add_f32 v169, v169, v173
    v_add_f32 v170, v170, v174
    v_add_f32 v171, v171, v175
    ds_write_b128 v7, v[168:171]
    s_waitcnt lgkmcnt(0)
    s_barrier
    ds_read2_b32 v[44:45], v8 offset0:0 offset1:4
    ds_read2_b32 v[46:47], v9 offset0:0 offset1:4
    ds_read2_b32 v[48:49], v10 offset0:0 offset1:4
    ds_read2_b32 v[50:51], v11 offset0:0 offset1:4
    s_waitcnt lgkmcnt(2)
    v_pk_add_f32 v[44:45], v[44:45], v[46:47]
    s_waitcnt lgkmcnt(0)
    v_pk_add_f32 v[48:49], v[48:49], v[50:51]
    v_pk_add_f32 v[44:45], v[44:45], v[48:49]
    v_cvt_pk_bf16_f32 v44, v44, v45
    buffer_store_dword v44, v12, s[8:11], s18 offen
    s_branch Lqj_30
Lqa_28:
    buffer_load_dwordx4 v[164:167], v6, s[8:11], s17 offen sc1
    buffer_load_dwordx4 v[156:159], v13, s[8:11], s16 offen sc1
    buffer_load_dwordx4 v[160:163], v13, s[8:11], s16 offen offset:1024 sc1
    s_sub_u32 s32, s32, 1
    s_cbranch_scc1 L_exit
    s_waitcnt vmcnt(3)
    v_max3_u32 v188, v176, v177, v178
    v_max3_u32 v189, v179, v180, v181
    v_max3_u32 v188, v188, v182, v183
    v_max3_u32 v189, v189, v184, v185
    v_max3_u32 v188, v188, v186, v187
    v_max_u32 v188, v188, v189
    v_cmp_eq_u32 vcc, -1, v188
    s_cbranch_vccnz Lq_27
    v_smfmac_f32_16x16x64_bf16 v[168:171], v[184:187], v[76:83], v2
    v_smfmac_f32_16x16x64_bf16 v[172:175], v[184:187], v[84:91], v2
    v_smfmac_f32_16x16x64_bf16 v[168:171], v[176:179], v[124:131], v2
    v_smfmac_f32_16x16x64_bf16 v[172:175], v[176:179], v[132:139], v2
    v_smfmac_f32_16x16x64_bf16 v[168:171], v[180:183], v[140:147], v2
    v_smfmac_f32_16x16x64_bf16 v[172:175], v[180:183], v[148:155], v2
    s_nop 7
    v_permlane32_swap_b32 v168, v172
    v_permlane32_swap_b32 v169, v173
    v_permlane32_swap_b32 v170, v174
    v_permlane32_swap_b32 v171, v175
    v_add_f32 v168, v168, v172
    v_add_f32 v169, v169, v173
    v_add_f32 v170, v170, v174
    v_add_f32 v171, v171, v175
    ds_write_b128 v7, v[168:171]
    s_waitcnt lgkmcnt(0)
    s_barrier
    ds_read2_b32 v[44:45], v8 offset0:0 offset1:4
    ds_read2_b32 v[46:47], v9 offset0:0 offset1:4
    ds_read2_b32 v[48:49], v10 offset0:0 offset1:4
    ds_read2_b32 v[50:51], v11 offset0:0 offset1:4
    s_waitcnt lgkmcnt(2)
    v_pk_add_f32 v[44:45], v[44:45], v[46:47]
    s_waitcnt lgkmcnt(0)
    v_pk_add_f32 v[48:49], v[48:49], v[50:51]
    v_pk_add_f32 v[44:45], v[44:45], v[48:49]
    v_cvt_pk_bf16_f32 v44, v44, v45
    buffer_store_dword v44, v12, s[8:11], s18 offen
Lqj_30:
    s_mov_b32 s17, s19
    s_add_u32 s17, s17, 23068672
    buffer_store_dword v44, v12, s[8:11], s17 offen
    s_nop 1
    v_mov_b64 v[44:45], 0
    v_mov_b64 v[46:47], 0
    v_mov_b64 v[48:49], 0
    v_mov_b64 v[50:51], 0
    v_mov_b64 v[52:53], 0
    v_mov_b64 v[54:55], 0
    v_mov_b64 v[56:57], 0
    v_mov_b64 v[58:59], 0
    v_mov_b64 v[60:61], 0
    v_mov_b64 v[62:63], 0
    v_mov_b64 v[64:65], 0
    v_mov_b64 v[66:67], 0
    v_mov_b64 v[68:69], 0
    v_mov_b64 v[70:71], 0
    v_mov_b64 v[72:73], 0
    v_mov_b64 v[74:75], 0
    v_mov_b64 v[168:169], 0
    v_mov_b64 v[170:171], 0
    v_mov_b64 v[172:173], 0
    v_mov_b64 v[174:175], 0
    s_add_u32 s20, s14, 1
    s_and_b32 s21, s20, 7
    s_cmp_eq_u32 s21, 0
    s_cbranch_scc0 Lng_31
    s_cmp_ge_u32 s20, 64
    s_cbranch_scc1 Lwu_32_d
    s_lshr_b32 s21, s20, 3
    s_lshl_b32 s21, s21, 10
    s_add_u32 s21, s21, 57344
    v_min_u32 v16, 55, v0
    v_lshlrev_b32 v16, 4, v16
Lwu_32:
    buffer_load_dwordx4 v[18:21], v16, s[8:11], s21 offen sc1
    s_waitcnt vmcnt(0)
    v_min_u32 v18, v18, v19
    v_min3_u32 v18, v18, v20, v21
    v_cmp_eq_u32 vcc, 0, v18
    s_cbranch_vccz Lwu_32_d
    s_sleep 2
    s_sub_u32 s32, s32, 1
    s_cbranch_scc0 Lwu_32
    s_branch L_exit
Lwu_32_d:
Lng_31:
    s_add_u32 s14, s14, 1
    s_and_b32 s16, s14, 3
    s_lshl_b32 s17, s16, 13
    s_add_u32 s33, s17, 20971520
    s_lshl_b32 s17, s16, 14
    s_add_u32 s34, s17, 22020096
    s_cmp_lt_u32 s14, 63
    s_cbranch_scc1 LBtop_23
    s_branch L_exit
E_slow:
    s_cmp_lt_u32 s13, 16
    s_cbranch_scc0 L_roleBs
    v_lshlrev_b32 v1, 4, v0
    v_and_b32 v20, 15, v0
    v_mov_b32 v2, 0x4444
    v_mov_b32 v21, 0xeeee
    v_cmp_lt_u32 vcc, 7, v20
    s_nop 1
    v_cndmask_b32 v2, v2, v21, vcc
    s_mul_i32 s16, s13, 401408
    s_mul_i32 s17, s12, 100352
    s_add_u32 s16, s16, s17
    s_add_u32 s16, s16, 5242880
    s_mul_i32 s18, s12, 14336
    s_add_u32 s18, s18, 14336
    v_add_u32 v14, s18, v1
    s_add_u32 s19, s12, 0
    s_mul_hi_u32 s20, s19, 613566757
    s_mul_i32 s20, s20, 7
    s_sub_u32 s19, s19, s20
    s_lshl_b32 s46, s19, 10
    s_add_u32 s19, s12, 4
    s_mul_hi_u32 s20, s19, 613566757
    s_mul_i32 s20, s20, 7
    s_sub_u32 s19, s19, s20
    s_lshl_b32 s47, s19, 10
    s_add_u32 s19, s12, 8
    s_mul_hi_u32 s20, s19, 613566757
    s_mul_i32 s20, s20, 7
    s_sub_u32 s19, s19, s20
    s_lshl_b32 s48, s19, 10
    s_add_u32 s19, s12, 12
    s_mul_hi_u32 s20, s19, 613566757
    s_mul_i32 s20, s20, 7
    s_sub_u32 s19, s19, s20
    s_lshl_b32 s49, s19, 10
    s_add_u32 s19, s12, 16
    s_mul_hi_u32 s20, s19, 613566757
    s_mul_i32 s20, s20, 7
    s_sub_u32 s19, s19, s20
    s_lshl_b32 s50, s19, 10
    s_add_u32 s19, s12, 20
    s_mul_hi_u32 s20, s19, 613566757
    s_mul_i32 s20, s20, 7
    s_sub_u32 s19, s19, s20
    s_lshl_b32 s51, s19, 10
    s_add_u32 s19, s12, 24
    s_mul_hi_u32 s20, s19, 613566757
    s_mul_i32 s20, s20, 7
    s_sub_u32 s19, s19, s20
    s_lshl_b32 s52, s19, 10
    s_mov_b32 s35, s46
    s_mov_b32 s36, s47
    s_lshl_b32 s22, s13, 2
    s_add_u32 s22, s22, s12
    s_lshl_b32 s22, s22, 8
    s_add_u32 s22, s22, 40960
    v_lshlrev_b32 v20, 2, v0
    s_mov_b64 s[62:63], 0
Lwt_33:
    s_lshr_b64 s[20:21], s[62:63], 0
    s_and_b32 s20, s20, 0x7f
    s_cmp_eq_u32 s20, 0x7f
    s_cbranch_scc1 Lwt_33_d
    buffer_load_dword v21, v20, s[8:11], s22 offen sc1
    s_waitcnt vmcnt(0)
    v_cmp_ne_u32 vcc, 0, v21
    s_mov_b64 s[62:63], vcc
    s_sub_u32 s32, s32, 1
    s_cbranch_scc0 Lwt_33
    s_branch L_exit
Lwt_33_d:
    s_lshl_b32 s17, s52, 1
    s_add_u32 s17, s17, s16
    s_add_u32 s17, s17, 0
    s_add_u32 m0, s18, 0
    s_nop 0
    buffer_load_dwordx4 v1, s[8:11], s17 offen sc1 lds
    buffer_load_dwordx4 v1, s[8:11], s17 offen offset:1024 sc1 lds
    s_lshl_b32 s17, s46, 1
    s_add_u32 s17, s17, s16
    s_add_u32 s17, s17, 0
    buffer_load_dwordx4 a[0:3], v1, s[8:11], s17 offen offset:0 sc1
    buffer_load_dwordx4 a[4:7], v1, s[8:11], s17 offen offset:1024 sc1
    s_lshl_b32 s17, s47, 1
    s_add_u32 s17, s17, s16
    s_add_u32 s17, s17, 0
    buffer_load_dwordx4 a[8:11], v1, s[8:11], s17 offen offset:0 sc1
    buffer_load_dwordx4 a[12:15], v1, s[8:11], s17 offen offset:1024 sc1
    s_lshl_b32 s17, s48, 1
    s_add_u32 s17, s17, s16
    s_add_u32 s17, s17, 0
    buffer_load_dwordx4 a[16:19], v1, s[8:11], s17 offen offset:0 sc1
    buffer_load_dwordx4 a[20:23], v1, s[8:11], s17 offen offset:1024 sc1
    s_lshl_b32 s17, s49, 1
    s_add_u32 s17, s17, s16
    s_add_u32 s17, s17, 0
    buffer_load_dwordx4 a[24:27], v1, s[8:11], s17 offen offset:0 sc1
    buffer_load_dwordx4 a[28:31], v1, s[8:11], s17 offen offset:1024 sc1
    s_lshl_b32 s17, s50, 1
    s_add_u32 s17, s17, s16
    s_add_u32 s17, s17, 0
    buffer_load_dwordx4 a[32:35], v1, s[8:11], s17 offen offset:0 sc1
    buffer_load_dwordx4 a[36:39], v1, s[8:11], s17 offen offset:1024 sc1
    s_lshl_b32 s17, s51, 1
    s_add_u32 s17, s17, s16
    s_add_u32 s17, s17, 0
    buffer_load_dwordx4 a[40:43], v1, s[8:11], s17 offen offset:0 sc1
    buffer_load_dwordx4 a[44:47], v1, s[8:11], s17 offen offset:1024 sc1
Lwt_34:
    s_lshr_b64 s[20:21], s[62:63], 8
    s_and_b32 s20, s20, 0x7f
    s_cmp_eq_u32 s20, 0x7f
    s_cbranch_scc1 Lwt_34_d
    buffer_load_dword v21, v20, s[8:11], s22 offen sc1
    s_waitcnt vmcnt(0)
    v_cmp_ne_u32 vcc, 0, v21
    s_mov_b64 s[62:63], vcc
    s_sub_u32 s32, s32, 1
    s_cbranch_scc0 Lwt_34
    s_branch L_exit
Lwt_34_d:
    s_lshl_b32 s17, s52, 1
    s_add_u32 s17, s17, s16
    s_add_u32 s17, s17, 14336
    s_add_u32 m0, s18, 2048
    s_nop 0
    buffer_load_dwordx4 v1, s[8:11], s17 offen sc1 lds
    buffer_load_dwordx4 v1, s[8:11], s17 offen offset:1024 sc1 lds
    s_lshl_b32 s17, s46, 1
    s_add_u32 s17, s17, s16
    s_add_u32 s17, s17, 14336
    buffer_load_dwordx4 a[48:51], v1, s[8:11], s17 offen offset:0 sc1
    buffer_load_dwordx4 a[52:55], v1, s[8:11], s17 offen offset:1024 sc1
    s_lshl_b32 s17, s47, 1
    s_add_u32 s17, s17, s16
    s_add_u32 s17, s17, 14336
    buffer_load_dwordx4 a[56:59], v1, s[8:11], s17 offen offset:0 sc1
    buffer_load_dwordx4 a[60:63], v1, s[8:11], s17 offen offset:1024 sc1
    s_lshl_b32 s17, s48, 1
    s_add_u32 s17, s17, s16
    s_add_u32 s17, s17, 14336
    buffer_load_dwordx4 a[64:67], v1, s[8:11], s17 offen offset:0 sc1
    buffer_load_dwordx4 a[68:71], v1, s[8:11], s17 offen offset:1024 sc1
    s_lshl_b32 s17, s49, 1
    s_add_u32 s17, s17, s16
    s_add_u32 s17, s17, 14336
    buffer_load_dwordx4 a[72:75], v1, s[8:11], s17 offen offset:0 sc1
    buffer_load_dwordx4 a[76:79], v1, s[8:11], s17 offen offset:1024 sc1
    s_lshl_b32 s17, s50, 1
    s_add_u32 s17, s17, s16
    s_add_u32 s17, s17, 14336
    buffer_load_dwordx4 a[80:83], v1, s[8:11], s17 offen offset:0 sc1
    buffer_load_dwordx4 a[84:87], v1, s[8:11], s17 offen offset:1024 sc1
    s_lshl_b32 s17, s51, 1
    s_add_u32 s17, s17, s16
    s_add_u32 s17, s17, 14336
    buffer_load_dwordx4 a[88:91], v1, s[8:11], s17 offen offset:0 sc1
    buffer_load_dwordx4 a[92:95], v1, s[8:11], s17 offen offset:1024 sc1
Lwt_35:
    s_lshr_b64 s[20:21], s[62:63], 16
    s_and_b32 s20, s20, 0x7f
    s_cmp_eq_u32 s20, 0x7f
    s_cbranch_scc1 Lwt_35_d
    buffer_load_dword v21, v20, s[8:11], s22 offen sc1
    s_waitcnt vmcnt(0)
    v_cmp_ne_u32 vcc, 0, v21
    s_mov_b64 s[62:63], vcc
    s_sub_u32 s32, s32, 1
    s_cbranch_scc0 Lwt_35
    s_branch L_exit
Lwt_35_d:
    s_lshl_b32 s17, s52, 1
    s_add_u32 s17, s17, s16
    s_add_u32 s17, s17, 28672
    s_add_u32 m0, s18, 4096
    s_nop 0
    buffer_load_dwordx4 v1, s[8:11], s17 offen sc1 lds
    buffer_load_dwordx4 v1, s[8:11], s17 offen offset:1024 sc1 lds
    s_lshl_b32 s17, s46, 1
    s_add_u32 s17, s17, s16
    s_add_u32 s17, s17, 28672
    buffer_load_dwordx4 a[96:99], v1, s[8:11], s17 offen offset:0 sc1
    buffer_load_dwordx4 a[100:103], v1, s[8:11], s17 offen offset:1024 sc1
    s_lshl_b32 s17, s47, 1
    s_add_u32 s17, s17, s16
    s_add_u32 s17, s17, 28672
    buffer_load_dwordx4 a[104:107], v1, s[8:11], s17 offen offset:0 sc1
    buffer_load_dwordx4 a[108:111], v1, s[8:11], s17 offen offset:1024 sc1
    s_lshl_b32 s17, s48, 1
    s_add_u32 s17, s17, s16
    s_add_u32 s17, s17, 28672
    buffer_load_dwordx4 a[112:115], v1, s[8:11], s17 offen offset:0 sc1
    buffer_load_dwordx4 a[116:119], v1, s[8:11], s17 offen offset:1024 sc1
    s_lshl_b32 s17, s49, 1
    s_add_u32 s17, s17, s16
    s_add_u32 s17, s17, 28672
    buffer_load_dwordx4 a[120:123], v1, s[8:11], s17 offen offset:0 sc1
    buffer_load_dwordx4 a[124:127], v1, s[8:11], s17 offen offset:1024 sc1
    s_lshl_b32 s17, s50, 1
    s_add_u32 s17, s17, s16
    s_add_u32 s17, s17, 28672
    buffer_load_dwordx4 a[128:131], v1, s[8:11], s17 offen offset:0 sc1
    buffer_load_dwordx4 a[132:135], v1, s[8:11], s17 offen offset:1024 sc1
    s_lshl_b32 s17, s51, 1
    s_add_u32 s17, s17, s16
    s_add_u32 s17, s17, 28672
    buffer_load_dwordx4 a[136:139], v1, s[8:11], s17 offen offset:0 sc1
    buffer_load_dwordx4 a[140:143], v1, s[8:11], s17 offen offset:1024 sc1
Lwt_36:
    s_lshr_b64 s[20:21], s[62:63], 24
    s_and_b32 s20, s20, 0x7f
    s_cmp_eq_u32 s20, 0x7f
    s_cbranch_scc1 Lwt_36_d
    buffer_load_dword v21, v20, s[8:11], s22 offen sc1
    s_waitcnt vmcnt(0)
    v_cmp_ne_u32 vcc, 0, v21
    s_mov_b64 s[62:63], vcc
    s_sub_u32 s32, s32, 1
    s_cbranch_scc0 Lwt_36
    s_branch L_exit
Lwt_36_d:
    s_lshl_b32 s17, s52, 1
    s_add_u32 s17, s17, s16
    s_add_u32 s17, s17, 43008
    s_add_u32 m0, s18, 6144
    s_nop 0
    buffer_load_dwordx4 v1, s[8:11], s17 offen sc1 lds
    buffer_load_dwordx4 v1, s[8:11], s17 offen offset:1024 sc1 lds
    s_lshl_b32 s17, s46, 1
    s_add_u32 s17, s17, s16
    s_add_u32 s17, s17, 43008
    buffer_load_dwordx4 a[144:147], v1, s[8:11], s17 offen offset:0 sc1
    buffer_load_dwordx4 a[148:151], v1, s[8:11], s17 offen offset:1024 sc1
    s_lshl_b32 s17, s47, 1
    s_add_u32 s17, s17, s16
    s_add_u32 s17, s17, 43008
    buffer_load_dwordx4 a[152:155], v1, s[8:11], s17 offen offset:0 sc1
    buffer_load_dwordx4 a[156:159], v1, s[8:11], s17 offen offset:1024 sc1
    s_lshl_b32 s17, s48, 1
    s_add_u32 s17, s17, s16
    s_add_u32 s17, s17, 43008
    buffer_load_dwordx4 a[160:163], v1, s[8:11], s17 offen offset:0 sc1
    buffer_load_dwordx4 a[164:167], v1, s[8:11], s17 offen offset:1024 sc1
    s_lshl_b32 s17, s49, 1
    s_add_u32 s17, s17, s16
    s_add_u32 s17, s17, 43008
    buffer_load_dwordx4 a[168:171], v1, s[8:11], s17 offen offset:0 sc1
    buffer_load_dwordx4 a[172:175], v1, s[8:11], s17 offen offset:1024 sc1
    s_lshl_b32 s17, s50, 1
    s_add_u32 s17, s17, s16
    s_add_u32 s17, s17, 43008
    buffer_load_dwordx4 a[176:179], v1, s[8:11], s17 offen offset:0 sc1
    buffer_load_dwordx4 a[180:183], v1, s[8:11], s17 offen offset:1024 sc1
    s_lshl_b32 s17, s51, 1
    s_add_u32 s17, s17, s16
    s_add_u32 s17, s17, 43008
    buffer_load_dwordx4 a[184:187], v1, s[8:11], s17 offen offset:0 sc1
    buffer_load_dwordx4 a[188:191], v1, s[8:11], s17 offen offset:1024 sc1
Lwt_37:
    s_lshr_b64 s[20:21], s[62:63], 32
    s_and_b32 s20, s20, 0x7f
    s_cmp_eq_u32 s20, 0x7f
    s_cbranch_scc1 Lwt_37_d
    buffer_load_dword v21, v20, s[8:11], s22 offen sc1
    s_waitcnt vmcnt(0)
    v_cmp_ne_u32 vcc, 0, v21
    s_mov_b64 s[62:63], vcc
    s_sub_u32 s32, s32, 1
    s_cbranch_scc0 Lwt_37
    s_branch L_exit
Lwt_37_d:
    s_lshl_b32 s17, s52, 1
    s_add_u32 s17, s17, s16
    s_add_u32 s17, s17, 57344
    s_add_u32 m0, s18, 8192
    s_nop 0
    buffer_load_dwordx4 v1, s[8:11], s17 offen sc1 lds
    buffer_load_dwordx4 v1, s[8:11], s17 offen offset:1024 sc1 lds
    s_lshl_b32 s17, s46, 1
    s_add_u32 s17, s17, s16
    s_add_u32 s17, s17, 57344
    buffer_load_dwordx4 a[192:195], v1, s[8:11], s17 offen offset:0 sc1
    buffer_load_dwordx4 a[196:199], v1, s[8:11], s17 offen offset:1024 sc1
    s_lshl_b32 s17, s47, 1
    s_add_u32 s17, s17, s16
    s_add_u32 s17, s17, 57344
    buffer_load_dwordx4 a[200:203], v1, s[8:11], s17 offen offset:0 sc1
    buffer_load_dwordx4 a[204:207], v1, s[8:11], s17 offen offset:1024 sc1
    s_lshl_b32 s17, s48, 1
    s_add_u32 s17, s17, s16
    s_add_u32 s17, s17, 57344
    buffer_load_dwordx4 a[208:211], v1, s[8:11], s17 offen offset:0 sc1
    buffer_load_dwordx4 a[212:215], v1, s[8:11], s17 offen offset:1024 sc1
    s_lshl_b32 s17, s49, 1
    s_add_u32 s17, s17, s16
    s_add_u32 s17, s17, 57344
    buffer_load_dwordx4 a[216:219], v1, s[8:11], s17 offen offset:0 sc1
    buffer_load_dwordx4 a[220:223], v1, s[8:11], s17 offen offset:1024 sc1
    s_lshl_b32 s17, s50, 1
    s_add_u32 s17, s17, s16
    s_add_u32 s17, s17, 57344
    buffer_load_dwordx4 a[224:227], v1, s[8:11], s17 offen offset:0 sc1
    buffer_load_dwordx4 a[228:231], v1, s[8:11], s17 offen offset:1024 sc1
    s_lshl_b32 s17, s51, 1
    s_add_u32 s17, s17, s16
    s_add_u32 s17, s17, 57344
    buffer_load_dwordx4 a[232:235], v1, s[8:11], s17 offen offset:0 sc1
    buffer_load_dwordx4 a[236:239], v1, s[8:11], s17 offen offset:1024 sc1
Lwt_38:
    s_lshr_b64 s[20:21], s[62:63], 40
    s_and_b32 s20, s20, 0x7f
    s_cmp_eq_u32 s20, 0x7f
    s_cbranch_scc1 Lwt_38_d
    buffer_load_dword v21, v20, s[8:11], s22 offen sc1
    s_waitcnt vmcnt(0)
    v_cmp_ne_u32 vcc, 0, v21
    s_mov_b64 s[62:63], vcc
    s_sub_u32 s32, s32, 1
    s_cbranch_scc0 Lwt_38
    s_branch L_exit
Lwt_38_d:
    s_lshl_b32 s17, s52, 1
    s_add_u32 s17, s17, s16
    s_add_u32 s17, s17, 71680
    s_add_u32 m0, s18, 10240
    s_nop 0
    buffer_load_dwordx4 v1, s[8:11], s17 offen sc1 lds
    buffer_load_dwordx4 v1, s[8:11], s17 offen offset:1024 sc1 lds
    s_lshl_b32 s17, s46, 1
    s_add_u32 s17, s17, s16
    s_add_u32 s17, s17, 71680
    buffer_load_dwordx4 a[240:243], v1, s[8:11], s17 offen offset:0 sc1
    buffer_load_dwordx4 a[244:247], v1, s[8:11], s17 offen offset:1024 sc1
    s_lshl_b32 s17, s47, 1
    s_add_u32 s17, s17, s16
    s_add_u32 s17, s17, 71680
    buffer_load_dwordx4 a[248:251], v1, s[8:11], s17 offen offset:0 sc1
    buffer_load_dwordx4 a[252:255], v1, s[8:11], s17 offen offset:1024 sc1
    s_lshl_b32 s17, s48, 1
    s_add_u32 s17, s17, s16
    s_add_u32 s17, s17, 71680
    buffer_load_dwordx4 v[176:179], v1, s[8:11], s17 offen offset:0 sc1
    buffer_load_dwordx4 v[180:183], v1, s[8:11], s17 offen offset:1024 sc1
    s_lshl_b32 s17, s49, 1
    s_add_u32 s17, s17, s16
    s_add_u32 s17, s17, 71680
    buffer_load_dwordx4 v[184:187], v1, s[8:11], s17 offen offset:0 sc1
    buffer_load_dwordx4 v[188:191], v1, s[8:11], s17 offen offset:1024 sc1
    s_lshl_b32 s17, s50, 1
    s_add_u32 s17, s17, s16
    s_add_u32 s17, s17, 71680
    buffer_load_dwordx4 v[192:195], v1, s[8:11], s17 offen offset:0 sc1
    buffer_load_dwordx4 v[196:199], v1, s[8:11], s17 offen offset:1024 sc1
    s_lshl_b32 s17, s51, 1
    s_add_u32 s17, s17, s16
    s_add_u32 s17, s17, 71680
    buffer_load_dwordx4 v[200:203], v1, s[8:11], s17 offen offset:0 sc1
    buffer_load_dwordx4 v[204:207], v1, s[8:11], s17 offen offset:1024 sc1
Lwt_39:
    s_lshr_b64 s[20:21], s[62:63], 48
    s_and_b32 s20, s20, 0x7f
    s_cmp_eq_u32 s20, 0x7f
    s_cbranch_scc1 Lwt_39_d
    buffer_load_dword v21, v20, s[8:11], s22 offen sc1
    s_waitcnt vmcnt(0)
    v_cmp_ne_u32 vcc, 0, v21
    s_mov_b64 s[62:63], vcc
    s_sub_u32 s32, s32, 1
    s_cbranch_scc0 Lwt_39
    s_branch L_exit
Lwt_39_d:
    s_lshl_b32 s17, s52, 1
    s_add_u32 s17, s17, s16
    s_add_u32 s17, s17, 86016
    s_add_u32 m0, s18, 12288
    s_nop 0
    buffer_load_dwordx4 v1, s[8:11], s17 offen sc1 lds
    buffer_load_dwordx4 v1, s[8:11], s17 offen offset:1024 sc1 lds
    s_lshl_b32 s17, s46, 1
    s_add_u32 s17, s17, s16
    s_add_u32 s17, s17, 86016
    buffer_load_dwordx4 v[208:211], v1, s[8:11], s17 offen offset:0 sc1
    buffer_load_dwordx4 v[212:215], v1, s[8:11], s17 offen offset:1024 sc1
    s_lshl_b32 s17, s47, 1
    s_add_u32 s17, s17, s16
    s_add_u32 s17, s17, 86016
    buffer_load_dwordx4 v[216:219], v1, s[8:11], s17 offen offset:0 sc1
    buffer_load_dwordx4 v[220:223], v1, s[8:11], s17 offen offset:1024 sc1
    s_lshl_b32 s17, s48, 1
    s_add_u32 s17, s17, s16
    s_add_u32 s17, s17, 86016
    buffer_load_dwordx4 v[224:227], v1, s[8:11], s17 offen offset:0 sc1
    buffer_load_dwordx4 v[228:231], v1, s[8:11], s17 offen offset:1024 sc1
    s_lshl_b32 s17, s49, 1
    s_add_u32 s17, s17, s16
    s_add_u32 s17, s17, 86016
    buffer_load_dwordx4 v[232:235], v1, s[8:11], s17 offen offset:0 sc1
    buffer_load_dwordx4 v[236:239], v1, s[8:11], s17 offen offset:1024 sc1
    s_lshl_b32 s17, s50, 1
    s_add_u32 s17, s17, s16
    s_add_u32 s17, s17, 86016
    buffer_load_dwordx4 v[240:243], v1, s[8:11], s17 offen offset:0 sc1
    buffer_load_dwordx4 v[244:247], v1, s[8:11], s17 offen offset:1024 sc1
    s_lshl_b32 s17, s51, 1
    s_add_u32 s17, s17, s16
    s_add_u32 s17, s17, 86016
    buffer_load_dwordx4 v[248:251], v1, s[8:11], s17 offen offset:0 sc1
    buffer_load_dwordx4 v[252:255], v1, s[8:11], s17 offen offset:1024 sc1
    v_and_b32 v20, 15, v0
    v_lshrrev_b32 v21, 4, v0
    v_lshlrev_b32 v23, 3, v20
    v_lshrrev_b32 v24, 1, v21
    v_lshlrev_b32 v24, 6, v24
    v_xor_b32 v23, v23, v24
    v_lshl_add_u32 v23, v21, 7, v23
    s_lshl_b32 s16, s12, 12
    s_add_u32 s16, s16, 71680
    s_and_b32 s17, s12, 1
    s_lshl_b32 s17, s17, 9
    s_add_u32 s17, s17, s16
    v_add_u32 v3, s17, v23
    v_and_b32 v24, 3, v20
    v_lshrrev_b32 v25, 2, v20
    v_lshl_add_u32 v25, v21, 2, v25
    v_lshlrev_b32 v25, 3, v25
    v_lshrrev_b32 v26, 1, v24
    v_lshlrev_b32 v26, 6, v26
    v_xor_b32 v25, v25, v26
    v_lshl_add_u32 v23, v24, 7, v25
    v_add_u32 v4, s16, v23
    v_mov_b32 v24, 0
    v_mov_b32 v25, 0
    v_mov_b32 v26, 0
    v_mov_b32 v27, 0
    v_add_u32 v23, s16, v1
    ds_write_b128 v23, v[24:27]
    ds_write_b128 v23, v[24:27] offset:1024
    ds_write_b128 v23, v[24:27] offset:2048
    ds_write_b128 v23, v[24:27] offset:3072
    s_mul_i32 s18, s12, 7
    s_lshr_b32 s18, s18, 1
    v_lshrrev_b32 v23, 1, v21
    v_lshlrev_b32 v23, 8, v23
    v_and_b32 v24, 7, v20
    v_lshl_add_u32 v23, v24, 4, v23
    v_and_b32 v24, 1, v21
    v_lshl_add_u32 v23, v24, 3, v23
    s_add_u32 s19, s18, 0
    s_lshr_b32 s20, s19, 1
    s_lshl_b32 s20, s20, 1
    s_mul_hi_u32 s21, s20, 613566757
    s_mul_i32 s21, s21, 7
    s_sub_u32 s20, s20, s21
    s_lshl_b32 s20, s20, 10
    s_and_b32 s19, s19, 1
    s_lshl_b32 s19, s19, 9
    s_add_u32 s20, s20, s19
    v_add_u32 v5, s20, v23
    s_add_u32 s19, s18, 1
    s_lshr_b32 s20, s19, 1
    s_lshl_b32 s20, s20, 1
    s_mul_hi_u32 s21, s20, 613566757
    s_mul_i32 s21, s21, 7
    s_sub_u32 s20, s20, s21
    s_lshl_b32 s20, s20, 10
    s_and_b32 s19, s19, 1
    s_lshl_b32 s19, s19, 9
    s_add_u32 s20, s20, s19
    v_add_u32 v6, s20, v23
    s_add_u32 s19, s18, 2
    s_lshr_b32 s20, s19, 1
    s_lshl_b32 s20, s20, 1
    s_mul_hi_u32 s21, s20, 613566757
    s_mul_i32 s21, s21, 7
    s_sub_u32 s20, s20, s21
    s_lshl_b32 s20, s20, 10
    s_and_b32 s19, s19, 1
    s_lshl_b32 s19, s19, 9
    s_add_u32 s20, s20, s19
    v_add_u32 v9, s20, v23
    s_add_u32 s19, s18, 3
    s_lshr_b32 s20, s19, 1
    s_lshl_b32 s20, s20, 1
    s_mul_hi_u32 s21, s20, 613566757
    s_mul_i32 s21, s21, 7
    s_sub_u32 s20, s20, s21
    s_lshl_b32 s20, s20, 10
    s_and_b32 s19, s19, 1
    s_lshl_b32 s19, s19, 9
    s_add_u32 s20, s20, s19
    v_add_u32 v10, s20, v23
    s_lshl_b32 s19, s18, 10
    s_add_u32 s37, s19, 1048576
    s_add_u32 s54, s19, 24117248
    s_mul_i32 s19, s12, 1728
    s_add_u32 s19, s19, 88064
    v_mul_u32_u24 v23, 144, v21
    v_lshl_add_u32 v23, v20, 4, v23
    v_add_u32 v7, s19, v23
    v_add_u32 v24, 6784, v7
    v_cmp_lt_u32 vcc, 7, v20
    s_nop 1
    v_cndmask_b32 v7, v7, v24, vcc
    s_lshl_b32 s19, s12, 11
    v_add_u32 v13, s19, v1
    s_add_u32 s19, s19, 1024
    s_cmp_eq_u32 s12, 3
    s_cselect_b32 s19, 0, s19
    v_add_u32 v15, s19, v1
    v_lshrrev_b32 v20, 5, v0
    s_lshl_b32 s16, s12, 1
    v_add_u32 v20, s16, v20
    v_and_b32 v21, 31, v0
    v_lshrrev_b32 v22, 3, v21
    v_min_u32 v22, 2, v22
    v_lshrrev_b32 v23, 1, v21
    v_and_b32 v23, 3, v23
    v_and_b32 v24, 1, v21
    v_mul_u32_u24 v25, 576, v22
    v_mul_u32_u24 v26, 144, v23
    v_add_u32 v25, v25, v26
    v_lshl_add_u32 v25, v20, 4, v25
    v_lshl_add_u32 v25, v24, 3, v25
    v_add_u32 v8, 88064, v25
    v_mov_b32 v26, 88192
    v_cmp_lt_u32 vcc, 19, v21
    s_nop 1
    v_cndmask_b32 v8, v8, v26, vcc
    v_mov_b32 v26, 0xf049f2ca
    v_mov_b32 v27, 0xf049f2ca
    s_mul_i32 s19, s12, 1728
    s_add_u32 s19, s19, 88192
    v_mov_b32 v22, s19
    ds_write_b64 v22, v[26:27]
    v_lshrrev_b32 v25, 2, v21
    v_and_b32 v25, 1, v25
    v_lshlrev_b32 v25, 4, v25
    v_lshl_add_u32 v25, v24, 3, v25
    v_add_u32 v25, v25, v20
    v_lshlrev_b32 v25, 4, v25
    v_lshrrev_b32 v26, 3, v21
    v_and_b32 v26, 1, v26
    v_lshrrev_b32 v27, 1, v21
    v_and_b32 v27, 1, v27
    v_lshl_add_u32 v26, v27, 1, v26
    v_lshl_add_u32 v25, v26, 2, v25
    s_lshl_b32 s16, s13, 9
    v_add_u32 v25, s16, v25
    s_lshr_b32 s16, s13, 2
    s_lshl_b32 s16, s16, 9
    s_add_u32 s16, s16, 8192
    s_bfe_u32 s17, s13, 0x10001
    s_lshl_b32 s17, s17, 8
    s_add_u32 s16, s16, s17
    s_and_b32 s17, s13, 1
    s_lshl_b32 s17, s17, 2
    s_add_u32 s16, s16, s17
    v_lshlrev_b32 v26, 3, v24
    v_add_u32 v26, v26, v20
    v_lshlrev_b32 v26, 4, v26
    v_lshl_add_u32 v26, v27, 3, v26
    v_add_u32 v26, s16, v26
    v_cmp_lt_u32 vcc, 15, v21
    s_nop 1
    v_cndmask_b32 v25, v25, v26, vcc
    v_mov_b32 v26, 0x80000000
    v_cmp_lt_u32 vcc, 19, v21
    s_nop 1
    v_cndmask_b32 v12, v25, v26, vcc
    v_cmp_gt_u32 s[44:45], 20, v21
    s_mov_b32 s56, 1115684864
    s_mov_b32 s60, 0x00ff00ff
    s_mov_b32 s61, 0x00ff00ff
    s_lshl_b32 s58, s12, 2
    v_min_u32 v20, 7, v0
    v_mul_u32_u24 v20, 16, v20
    s_mov_b32 s16, 512
Lcw_40:
    buffer_load_dword v21, v20, s[8:11], s16 offen sc1
    s_waitcnt vmcnt(0)
    v_cmp_gt_u32 vcc, 4, v21
    s_cbranch_vccz Lcw_40_d
    s_sleep 2
    s_sub_u32 s32, s32, 1
    s_cbranch_scc0 Lcw_40
    s_branch L_exit
Lcw_40_d:
    s_add_u32 s16, s37, 14336
    buffer_load_dwordx4 v[100:103], v1, s[8:11], s37 offen offset:0 sc1
    buffer_load_dwordx4 v[108:111], v1, s[8:11], s37 offen offset:1024 sc1
    buffer_load_dwordx4 v[116:119], v1, s[8:11], s37 offen offset:2048 sc1
    buffer_load_dwordx4 v[124:127], v1, s[8:11], s37 offen offset:3072 sc1
    buffer_load_dwordx4 v[104:107], v1, s[8:11], s16 offen offset:0 sc1
    buffer_load_dwordx4 v[112:115], v1, s[8:11], s16 offen offset:1024 sc1
    buffer_load_dwordx4 v[120:123], v1, s[8:11], s16 offen offset:2048 sc1
    buffer_load_dwordx4 v[128:131], v1, s[8:11], s16 offen offset:3072 sc1
    s_add_u32 s37, s37, 28672
    s_waitcnt vmcnt(0) lgkmcnt(0)
    s_barrier
    v_mov_b64 v[44:45], 0
    v_mov_b64 v[46:47], 0
    v_mov_b64 v[48:49], 0
    v_mov_b64 v[50:51], 0
    v_mov_b64 v[52:53], 0
    v_mov_b64 v[54:55], 0
    v_mov_b64 v[56:57], 0
    v_mov_b64 v[58:59], 0
    v_mov_b64 v[60:61], 0
    v_mov_b64 v[62:63], 0
    v_mov_b64 v[64:65], 0
    v_mov_b64 v[66:67], 0
    v_mov_b64 v[68:69], 0
    v_mov_b64 v[70:71], 0
    s_branch LAfirst_42
    .p2align 6
LAtop_41:
    s_sleep 10
LAfirst_42:
    s_add_u32 s16, s33, s35
    s_add_u32 s17, s33, s36
Lpl_43:
    buffer_load_dwordx4 v[160:163], v1, s[8:11], s16 offen sc1
    buffer_load_dwordx4 v[164:167], v1, s[8:11], s17 offen sc1
    s_sub_u32 s32, s32, 1
    s_cbranch_scc1 L_exit
    s_waitcnt vmcnt(0)
    v_max3_u32 v72, v160, v161, v162
    v_max3_u32 v73, v163, v164, v165
    v_max3_u32 v72, v72, v166, v167
    v_max_u32 v72, v72, v73
    v_cmp_eq_u32 vcc, -1, v72
    s_cbranch_vccnz Lpl_43
    ds_write_b128 v13, v[160:163]
    v_smfmac_f32_16x16x64_bf16 v[44:47], v[160:163], a[0:7], v2
    ds_write_b128 v15, v[164:167]
    v_smfmac_f32_16x16x64_bf16 v[48:51], v[160:163], a[48:55], v2
    ds_write_b128 v13, v[160:163] offset:7168
    v_smfmac_f32_16x16x64_bf16 v[52:55], v[160:163], a[96:103], v2
    ds_write_b128 v15, v[164:167] offset:7168
    v_smfmac_f32_16x16x64_bf16 v[56:59], v[160:163], a[144:151], v2
    ds_read_b128 v[84:87], v14 offset:0
    v_smfmac_f32_16x16x64_bf16 v[60:63], v[160:163], a[192:199], v2
    ds_read_b128 v[88:91], v14 offset:1024
    v_smfmac_f32_16x16x64_bf16 v[64:67], v[160:163], a[240:247], v2
    v_smfmac_f32_16x16x64_bf16 v[68:71], v[160:163], v[208:215], v2
    v_smfmac_f32_16x16x64_bf16 v[44:47], v[164:167], a[8:15], v2
    s_waitcnt lgkmcnt(0)
    s_barrier
    v_smfmac_f32_16x16x64_bf16 v[48:51], v[164:167], a[56:63], v2
    ds_read_b128 v[24:27], v13 offset:2048
    v_smfmac_f32_16x16x64_bf16 v[52:55], v[164:167], a[104:111], v2
    ds_read_b128 v[28:31], v13 offset:3072
    v_smfmac_f32_16x16x64_bf16 v[56:59], v[164:167], a[152:159], v2
    ds_read_b128 v[32:35], v13 offset:4096
    v_smfmac_f32_16x16x64_bf16 v[60:63], v[164:167], a[200:207], v2
    ds_read_b128 v[36:39], v13 offset:5120
    v_smfmac_f32_16x16x64_bf16 v[64:67], v[164:167], a[248:255], v2
    ds_read_b128 v[40:43], v13 offset:6144
    v_smfmac_f32_16x16x64_bf16 v[68:71], v[164:167], v[216:223], v2
    s_waitcnt lgkmcnt(4)
    v_smfmac_f32_16x16x64_bf16 v[44:47], v[24:27], a[16:23], v2
    ds_read_b128 v[92:95], v14 offset:2048
    s_waitcnt lgkmcnt(4)
    v_smfmac_f32_16x16x64_bf16 v[44:47], v[28:31], a[24:31], v2
    ds_read_b128 v[96:99], v14 offset:3072
    s_waitcnt lgkmcnt(4)
    v_smfmac_f32_16x16x64_bf16 v[44:47], v[32:35], a[32:39], v2
    ds_read2_b32 v[132:133], v5 offset0:0 offset1:32
    s_waitcnt lgkmcnt(4)
    v_smfmac_f32_16x16x64_bf16 v[44:47], v[36:39], a[40:47], v2
    ds_read2_b32 v[134:135], v5 offset0:1 offset1:33
    s_waitcnt lgkmcnt(4)
    v_smfmac_f32_16x16x64_bf16 v[44:47], v[40:43], v[84:91], v2
    ds_read_b128 v[84:87], v14 offset:4096
    v_smfmac_f32_16x16x64_bf16 v[48:51], v[24:27], a[64:71], v2
    ds_read_b128 v[88:91], v14 offset:5120
    v_smfmac_f32_16x16x64_bf16 v[48:51], v[28:31], a[72:79], v2
    v_cvt_pk_bf16_f32 v72, v44, v45
    v_smfmac_f32_16x16x64_bf16 v[48:51], v[32:35], a[80:87], v2
    v_cvt_pk_bf16_f32 v73, v46, v47
    v_smfmac_f32_16x16x64_bf16 v[48:51], v[36:39], a[88:95], v2
    ds_write_b64 v3, v[72:73] offset:0
    s_waitcnt lgkmcnt(5)
    v_smfmac_f32_16x16x64_bf16 v[48:51], v[40:43], v[92:99], v2
    ds_read_b128 v[92:95], v14 offset:6144
    v_smfmac_f32_16x16x64_bf16 v[52:55], v[24:27], a[112:119], v2
    ds_read_b128 v[96:99], v14 offset:7168
    v_smfmac_f32_16x16x64_bf16 v[52:55], v[28:31], a[120:127], v2
    v_cvt_pk_bf16_f32 v74, v48, v49
    v_smfmac_f32_16x16x64_bf16 v[52:55], v[32:35], a[128:135], v2
    v_cvt_pk_bf16_f32 v75, v50, v51
    v_smfmac_f32_16x16x64_bf16 v[52:55], v[36:39], a[136:143], v2
    ds_write_b64 v3, v[74:75] offset:512
    s_waitcnt lgkmcnt(4)
    v_smfmac_f32_16x16x64_bf16 v[52:55], v[40:43], v[84:91], v2
    ds_read_b64_tr_b16 v[76:77], v4 offset:0
    v_smfmac_f32_16x16x64_bf16 v[56:59], v[24:27], a[160:167], v2
    ds_read_b64_tr_b16 v[78:79], v4 offset:512
    v_smfmac_f32_16x16x64_bf16 v[56:59], v[28:31], a[168:175], v2
    v_cvt_pk_bf16_f32 v72, v52, v53
    v_smfmac_f32_16x16x64_bf16 v[56:59], v[32:35], a[176:183], v2
    v_cvt_pk_bf16_f32 v73, v54, v55
    v_smfmac_f32_16x16x64_bf16 v[56:59], v[36:39], a[184:191], v2
    ds_write_b64 v3, v[72:73] offset:1024
    s_waitcnt lgkmcnt(4)
    v_smfmac_f32_16x16x64_bf16 v[56:59], v[40:43], v[92:99], v2
    ds_read_b128 v[84:87], v14 offset:8192
    v_smfmac_f32_16x16x64_bf16 v[60:63], v[24:27], a[208:215], v2
    ds_read_b128 v[88:91], v14 offset:9216
    v_smfmac_f32_16x16x64_bf16 v[60:63], v[28:31], a[216:223], v2
    v_cvt_pk_bf16_f32 v74, v56, v57
    s_waitcnt lgkmcnt(3)
    v_mfma_f32_16x16x32_bf16 v[148:151], v[100:103], v[76:79], 0
    v_cvt_pk_bf16_f32 v75, v58, v59
    ds_write_b64 v3, v[74:75] offset:1536
    v_mfma_f32_16x16x32_bf16 v[152:155], v[104:107], v[76:79], 0
    ds_read_b128 v[92:95], v14 offset:10240
    ds_read_b64_tr_b16 v[80:81], v4 offset:1024
    v_mfma_f32_16x16x32_bf16 v[156:159], v[132:135], v[76:79], 0
    ds_read_b128 v[96:99], v14 offset:11264
    ds_read_b64_tr_b16 v[82:83], v4 offset:1536
    v_smfmac_f32_16x16x64_bf16 v[60:63], v[32:35], a[224:231], v2
    ds_read2_b32 v[136:137], v6 offset0:0 offset1:32
    v_smfmac_f32_16x16x64_bf16 v[60:63], v[36:39], a[232:239], v2
    ds_read2_b32 v[138:139], v6 offset0:1 offset1:33
    s_waitcnt lgkmcnt(7)
    v_smfmac_f32_16x16x64_bf16 v[60:63], v[40:43], v[84:91], v2
    ds_read_b128 v[84:87], v14 offset:12288
    v_smfmac_f32_16x16x64_bf16 v[64:67], v[24:27], v[176:183], v2
    ds_read_b128 v[88:91], v14 offset:13312
    v_smfmac_f32_16x16x64_bf16 v[64:67], v[28:31], v[184:191], v2
    v_cvt_pk_bf16_f32 v72, v60, v61
    v_smfmac_f32_16x16x64_bf16 v[64:67], v[32:35], v[192:199], v2
    v_cvt_pk_bf16_f32 v73, v62, v63
    v_smfmac_f32_16x16x64_bf16 v[64:67], v[36:39], v[200:207], v2
    ds_write_b64 v3, v[72:73] offset:2048
    s_waitcnt lgkmcnt(6)
    v_smfmac_f32_16x16x64_bf16 v[64:67], v[40:43], v[92:99], v2
    ds_read2_b32 v[140:141], v9 offset0:0 offset1:32
    v_smfmac_f32_16x16x64_bf16 v[68:71], v[24:27], v[224:231], v2
    ds_read2_b32 v[142:143], v9 offset0:1 offset1:33
    v_smfmac_f32_16x16x64_bf16 v[68:71], v[28:31], v[232:239], v2
    v_cvt_pk_bf16_f32 v74, v64, v65
    s_waitcnt lgkmcnt(7)
    v_mfma_f32_16x16x32_bf16 v[148:151], v[108:111], v[80:83], v[148:151]
    ds_read2_b32 v[144:145], v10 offset0:0 offset1:32
    ds_read2_b32 v[146:147], v10 offset0:1 offset1:33
    v_mfma_f32_16x16x32_bf16 v[152:155], v[112:115], v[80:83], v[152:155]
    v_cvt_pk_bf16_f32 v75, v66, v67
    ds_write_b64 v3, v[74:75] offset:2560
    v_mfma_f32_16x16x32_bf16 v[156:159], v[136:139], v[80:83], v[156:159]
    v_smfmac_f32_16x16x64_bf16 v[68:71], v[32:35], v[240:247], v2
    v_smfmac_f32_16x16x64_bf16 v[68:71], v[36:39], v[248:255], v2
    s_waitcnt lgkmcnt(6)
    v_smfmac_f32_16x16x64_bf16 v[68:71], v[40:43], v[84:91], v2
    ds_read_b64_tr_b16 v[76:77], v4 offset:2048
    ds_read_b64_tr_b16 v[78:79], v4 offset:2560
    s_nop 5
    v_cvt_pk_bf16_f32 v72, v68, v69
    v_cvt_pk_bf16_f32 v73, v70, v71
    ds_write_b64 v3, v[72:73] offset:3072
    ds_read_b64_tr_b16 v[80:81], v4 offset:3072
    ds_read_b64_tr_b16 v[82:83], v4 offset:3584
    s_waitcnt lgkmcnt(3)
    v_mfma_f32_16x16x32_bf16 v[148:151], v[116:119], v[76:79], v[148:151]
    v_mfma_f32_16x16x32_bf16 v[152:155], v[120:123], v[76:79], v[152:155]
    v_mfma_f32_16x16x32_bf16 v[156:159], v[140:143], v[76:79], v[156:159]
    s_waitcnt lgkmcnt(0)
    v_mfma_f32_16x16x32_bf16 v[148:151], v[124:127], v[80:83], v[148:151]
    v_mfma_f32_16x16x32_bf16 v[152:155], v[128:131], v[80:83], v[152:155]
    v_mfma_f32_16x16x32_bf16 v[156:159], v[144:147], v[80:83], v[156:159]
    v_add_f32 v148, v148, v148 row_ror:8
    v_add_f32 v149, v149, v149 row_ror:8
    v_add_f32 v150, v150, v150 row_ror:8
    v_add_f32 v151, v151, v151 row_ror:8
    ds_write_b128 v7, v[148:151] offset:0
    v_add_f32 v152, v152, v152 row_ror:8
    v_add_f32 v153, v153, v153 row_ror:8
    v_add_f32 v154, v154, v154 row_ror:8
    v_add_f32 v155, v155, v155 row_ror:8
    ds_write_b128 v7, v[152:155] offset:576
    v_add_f32 v156, v156, v156 row_ror:8
    v_add_f32 v157, v157, v157 row_ror:8
    v_add_f32 v158, v158, v158 row_ror:8
    v_add_f32 v159, v159, v159 row_ror:8
    ds_write_b128 v7, v[156:159] offset:1152
    s_waitcnt vmcnt(0) lgkmcnt(0)
    s_barrier
    ds_read_b64 v[160:161], v8 offset:0
    ds_read_b64 v[162:163], v8 offset:1728
    ds_read_b64 v[164:165], v8 offset:3456
    ds_read_b64 v[166:167], v8 offset:5184
    s_waitcnt lgkmcnt(2)
    v_pk_add_f32 v[160:161], v[160:161], v[162:163]
    s_waitcnt lgkmcnt(0)
    v_pk_add_f32 v[164:165], v[164:165], v[166:167]
    v_pk_add_f32 v[160:161], v[160:161], v[164:165]
    v_max_f32 v162, |v160|, |v161|
    v_cmp_nle_f32 vcc, v162, s56
    s_and_b64 vcc, vcc, s[44:45]
    s_cbranch_vccnz Lslow_45
Lfast_46:
    v_exp_f32 v160, v160
    v_exp_f32 v161, v161
    s_nop 0
    v_add_f32 v163, v160, v161
    s_nop 1
    v_add_f32 v163, v163, v163 row_ror:8
    s_nop 1
    v_add_f32 v163, v163, v163 row_ror:4
    s_nop 1
    v_add_f32 v163, v163, v163 row_ror:2
    s_nop 1
    v_add_f32 v163, v163, v163 row_ror:1
    v_mov_b32 v164, v163
    s_nop 1
    v_permlane16_swap_b32 v163, v164
    v_add_f32 v163, v163, v164
    v_rcp_f32 v163, v163
    s_nop 0
    v_mul_f32 v160, v160, v163
    v_mul_f32 v161, v161, v163
    v_cvt_pk_bf16_f32 v160, v160, v161
    buffer_store_dword v160, v12, s[8:11], s34 offen sc1
    s_add_u32 s16, s14, 2
    s_and_b32 s16, s16, 3
    s_lshl_b32 s16, s16, 14
    s_add_u32 s16, s16, 22020096
    v_mov_b32 v72, -1
    buffer_store_dword v72, v12, s[8:11], s16 offen sc1
    s_add_u32 s16, s37, 14336
    buffer_load_dwordx4 v[100:103], v1, s[8:11], s37 offen offset:0 sc1
    buffer_load_dwordx4 v[108:111], v1, s[8:11], s37 offen offset:1024 sc1
    buffer_load_dwordx4 v[116:119], v1, s[8:11], s37 offen offset:2048 sc1
    buffer_load_dwordx4 v[124:127], v1, s[8:11], s37 offen offset:3072 sc1
    buffer_load_dwordx4 v[104:107], v1, s[8:11], s16 offen offset:0 sc1
    buffer_load_dwordx4 v[112:115], v1, s[8:11], s16 offen offset:1024 sc1
    buffer_load_dwordx4 v[120:123], v1, s[8:11], s16 offen offset:2048 sc1
    buffer_load_dwordx4 v[128:131], v1, s[8:11], s16 offen offset:3072 sc1
    s_add_u32 s37, s37, 28672
    v_mov_b64 v[44:45], 0
    v_mov_b64 v[46:47], 0
    v_mov_b64 v[48:49], 0
    v_mov_b64 v[50:51], 0
    v_mov_b64 v[52:53], 0
    v_mov_b64 v[54:55], 0
    v_mov_b64 v[56:57], 0
    v_mov_b64 v[58:59], 0
    v_mov_b64 v[60:61], 0
    v_mov_b64 v[62:63], 0
    v_mov_b64 v[64:65], 0
    v_mov_b64 v[66:67], 0
    v_mov_b64 v[68:69], 0
    v_mov_b64 v[70:71], 0
    s_add_u32 s14, s14, 1
    s_and_b32 s16, s14, 3
    s_lshl_b32 s17, s16, 13
    s_add_u32 s33, s17, 20971520
    s_lshl_b32 s17, s16, 14
    s_add_u32 s34, s17, 22020096
    s_cmp_lt_u32 s14, 63
    s_cbranch_scc1 LAtop_41
    s_branch L_exit
Lslow_45:
    v_max_f32 v163, v160, v161
    s_nop 1
    v_max_f32 v163, v163, v163 row_ror:8
    s_nop 1
    v_max_f32 v163, v163, v163 row_ror:4
    s_nop 1
    v_max_f32 v163, v163, v163 row_ror:2
    s_nop 1
    v_max_f32 v163, v163, v163 row_ror:1
    v_mov_b32 v164, v163
    s_nop 1
    v_permlane16_swap_b32 v163, v164
    v_max_f32 v163, v163, v164
    v_sub_f32 v160, v160, v163
    v_sub_f32 v161, v161, v163
    s_branch Lfast_46
L_roleBs:
    s_sub_u32 s13, s13, 16
    s_lshl_b32 s19, s12, 2
    v_min_u32 v20, 3, v0
    v_mul_u32_u24 v20, 16, v20
    s_mul_i32 s16, s19, 16
    s_add_u32 s16, s16, 256
Lcw_47:
    buffer_load_dword v21, v20, s[8:11], s16 offen sc1
    s_waitcnt vmcnt(0)
    v_cmp_gt_u32 vcc, 7, v21
    s_cbranch_vccz Lcw_47_d
    s_sleep 2
    s_sub_u32 s32, s32, 1
    s_cbranch_scc0 Lcw_47
    s_branch L_exit
Lcw_47_d:
    v_lshlrev_b32 v1, 4, v0
    v_and_b32 v20, 15, v0
    v_mov_b32 v2, 0x4444
    v_mov_b32 v21, 0xeeee
    v_cmp_lt_u32 vcc, 7, v20
    s_nop 1
    v_cndmask_b32 v2, v2, v21, vcc
    s_lshl_b32 s16, s12, 2
    s_mul_i32 s16, s16, 28
    s_lshl_b32 s17, s13, 1
    s_add_u32 s16, s16, s17
    s_mul_i32 s16, s16, 14336
    s_add_u32 s16, s16, 12582912
    s_lshl_b32 s18, s12, 15
    s_add_u32 s18, s18, 8192
    v_add_u32 v5, s18, v1
    s_add_u32 s17, s16, 10240
    s_add_u32 m0, s18, 0
    s_nop 0
    buffer_load_dwordx4 v1, s[8:11], s17 offen offset:0 sc1 lds
    buffer_load_dwordx4 v1, s[8:11], s17 offen offset:1024 sc1 lds
    buffer_load_dwordx4 v1, s[8:11], s17 offen offset:2048 sc1 lds
    buffer_load_dwordx4 v1, s[8:11], s17 offen offset:3072 sc1 lds
    s_add_u32 s17, s16, 24576
    s_add_u32 m0, s18, 4096
    s_nop 0
    buffer_load_dwordx4 v1, s[8:11], s17 offen offset:0 sc1 lds
    buffer_load_dwordx4 v1, s[8:11], s17 offen offset:1024 sc1 lds
    buffer_load_dwordx4 v1, s[8:11], s17 offen offset:2048 sc1 lds
    buffer_load_dwordx4 v1, s[8:11], s17 offen offset:3072 sc1 lds
    s_add_u32 s17, s16, 411648
    s_add_u32 m0, s18, 8192
    s_nop 0
    buffer_load_dwordx4 v1, s[8:11], s17 offen offset:0 sc1 lds
    buffer_load_dwordx4 v1, s[8:11], s17 offen offset:1024 sc1 lds
    buffer_load_dwordx4 v1, s[8:11], s17 offen offset:2048 sc1 lds
    buffer_load_dwordx4 v1, s[8:11], s17 offen offset:3072 sc1 lds
    s_add_u32 s17, s16, 425984
    s_add_u32 m0, s18, 12288
    s_nop 0
    buffer_load_dwordx4 v1, s[8:11], s17 offen offset:0 sc1 lds
    buffer_load_dwordx4 v1, s[8:11], s17 offen offset:1024 sc1 lds
    buffer_load_dwordx4 v1, s[8:11], s17 offen offset:2048 sc1 lds
    buffer_load_dwordx4 v1, s[8:11], s17 offen offset:3072 sc1 lds
    s_add_u32 s17, s16, 813056
    s_add_u32 m0, s18, 16384
    s_nop 0
    buffer_load_dwordx4 v1, s[8:11], s17 offen offset:0 sc1 lds
    buffer_load_dwordx4 v1, s[8:11], s17 offen offset:1024 sc1 lds
    buffer_load_dwordx4 v1, s[8:11], s17 offen offset:2048 sc1 lds
    buffer_load_dwordx4 v1, s[8:11], s17 offen offset:3072 sc1 lds
    s_add_u32 s17, s16, 827392
    s_add_u32 m0, s18, 20480
    s_nop 0
    buffer_load_dwordx4 v1, s[8:11], s17 offen offset:0 sc1 lds
    buffer_load_dwordx4 v1, s[8:11], s17 offen offset:1024 sc1 lds
    buffer_load_dwordx4 v1, s[8:11], s17 offen offset:2048 sc1 lds
    buffer_load_dwordx4 v1, s[8:11], s17 offen offset:3072 sc1 lds
    s_add_u32 s17, s16, 1214464
    s_add_u32 m0, s18, 24576
    s_nop 0
    buffer_load_dwordx4 v1, s[8:11], s17 offen offset:0 sc1 lds
    buffer_load_dwordx4 v1, s[8:11], s17 offen offset:1024 sc1 lds
    buffer_load_dwordx4 v1, s[8:11], s17 offen offset:2048 sc1 lds
    buffer_load_dwordx4 v1, s[8:11], s17 offen offset:3072 sc1 lds
    s_add_u32 s17, s16, 1228800
    s_add_u32 m0, s18, 28672
    s_nop 0
    buffer_load_dwordx4 v1, s[8:11], s17 offen offset:0 sc1 lds
    buffer_load_dwordx4 v1, s[8:11], s17 offen offset:1024 sc1 lds
    buffer_load_dwordx4 v1, s[8:11], s17 offen offset:2048 sc1 lds
    buffer_load_dwordx4 v1, s[8:11], s17 offen offset:3072 sc1 lds
    s_add_u32 s17, s16, 0
    buffer_load_dwordx4 a[0:3], v1, s[8:11], s17 offen offset:0 sc1
    buffer_load_dwordx4 a[4:7], v1, s[8:11], s17 offen offset:1024 sc1
    s_add_u32 s17, s16, 2048
    buffer_load_dwordx4 a[8:11], v1, s[8:11], s17 offen offset:0 sc1
    buffer_load_dwordx4 a[12:15], v1, s[8:11], s17 offen offset:1024 sc1
    s_add_u32 s17, s16, 4096
    buffer_load_dwordx4 a[16:19], v1, s[8:11], s17 offen offset:0 sc1
    buffer_load_dwordx4 a[20:23], v1, s[8:11], s17 offen offset:1024 sc1
    s_add_u32 s17, s16, 6144
    buffer_load_dwordx4 a[24:27], v1, s[8:11], s17 offen offset:0 sc1
    buffer_load_dwordx4 a[28:31], v1, s[8:11], s17 offen offset:1024 sc1
    s_add_u32 s17, s16, 8192
    buffer_load_dwordx4 a[32:35], v1, s[8:11], s17 offen offset:0 sc1
    buffer_load_dwordx4 a[36:39], v1, s[8:11], s17 offen offset:1024 sc1
    s_add_u32 s17, s16, 14336
    buffer_load_dwordx4 a[40:43], v1, s[8:11], s17 offen offset:0 sc1
    buffer_load_dwordx4 a[44:47], v1, s[8:11], s17 offen offset:1024 sc1
    s_add_u32 s17, s16, 16384
    buffer_load_dwordx4 a[48:51], v1, s[8:11], s17 offen offset:0 sc1
    buffer_load_dwordx4 a[52:55], v1, s[8:11], s17 offen offset:1024 sc1
    s_add_u32 s17, s16, 18432
    buffer_load_dwordx4 a[56:59], v1, s[8:11], s17 offen offset:0 sc1
    buffer_load_dwordx4 a[60:63], v1, s[8:11], s17 offen offset:1024 sc1
    s_add_u32 s17, s16, 20480
    buffer_load_dwordx4 a[64:67], v1, s[8:11], s17 offen offset:0 sc1
    buffer_load_dwordx4 a[68:71], v1, s[8:11], s17 offen offset:1024 sc1
    s_add_u32 s17, s16, 22528
    buffer_load_dwordx4 a[72:75], v1, s[8:11], s17 offen offset:0 sc1
    buffer_load_dwordx4 a[76:79], v1, s[8:11], s17 offen offset:1024 sc1
    s_add_u32 s17, s16, 401408
    buffer_load_dwordx4 a[80:83], v1, s[8:11], s17 offen offset:0 sc1
    buffer_load_dwordx4 a[84:87], v1, s[8:11], s17 offen offset:1024 sc1
    s_add_u32 s17, s16, 403456
    buffer_load_dwordx4 a[88:91], v1, s[8:11], s17 offen offset:0 sc1
    buffer_load_dwordx4 a[92:95], v1, s[8:11], s17 offen offset:1024 sc1
    s_add_u32 s17, s16, 405504
    buffer_load_dwordx4 a[96:99], v1, s[8:11], s17 offen offset:0 sc1
    buffer_load_dwordx4 a[100:103], v1, s[8:11], s17 offen offset:1024 sc1
    s_add_u32 s17, s16, 407552
    buffer_load_dwordx4 a[104:107], v1, s[8:11], s17 offen offset:0 sc1
    buffer_load_dwordx4 a[108:111], v1, s[8:11], s17 offen offset:1024 sc1
    s_add_u32 s17, s16, 409600
    buffer_load_dwordx4 a[112:115], v1, s[8:11], s17 offen offset:0 sc1
    buffer_load_dwordx4 a[116:119], v1, s[8:11], s17 offen offset:1024 sc1
    s_add_u32 s17, s16, 415744
    buffer_load_dwordx4 a[120:123], v1, s[8:11], s17 offen offset:0 sc1
    buffer_load_dwordx4 a[124:127], v1, s[8:11], s17 offen offset:1024 sc1
    s_add_u32 s17, s16, 417792
    buffer_load_dwordx4 a[128:131], v1, s[8:11], s17 offen offset:0 sc1
    buffer_load_dwordx4 a[132:135], v1, s[8:11], s17 offen offset:1024 sc1
    s_add_u32 s17, s16, 419840
    buffer_load_dwordx4 a[136:139], v1, s[8:11], s17 offen offset:0 sc1
    buffer_load_dwordx4 a[140:143], v1, s[8:11], s17 offen offset:1024 sc1
    s_add_u32 s17, s16, 421888
    buffer_load_dwordx4 a[144:147], v1, s[8:11], s17 offen offset:0 sc1
    buffer_load_dwordx4 a[148:151], v1, s[8:11], s17 offen offset:1024 sc1
    s_add_u32 s17, s16, 423936
    buffer_load_dwordx4 a[152:155], v1, s[8:11], s17 offen offset:0 sc1
    buffer_load_dwordx4 a[156:159], v1, s[8:11], s17 offen offset:1024 sc1
    s_add_u32 s17, s16, 802816
    buffer_load_dwordx4 a[160:163], v1, s[8:11], s17 offen offset:0 sc1
    buffer_load_dwordx4 a[164:167], v1, s[8:11], s17 offen offset:1024 sc1
    s_add_u32 s17, s16, 804864
    buffer_load_dwordx4 a[168:171], v1, s[8:11], s17 offen offset:0 sc1
    buffer_load_dwordx4 a[172:175], v1, s[8:11], s17 offen offset:1024 sc1
    s_add_u32 s17, s16, 806912
    buffer_load_dwordx4 a[176:179], v1, s[8:11], s17 offen offset:0 sc1
    buffer_load_dwordx4 a[180:183], v1, s[8:11], s17 offen offset:1024 sc1
    s_add_u32 s17, s16, 808960
    buffer_load_dwordx4 a[184:187], v1, s[8:11], s17 offen offset:0 sc1
    buffer_load_dwordx4 a[188:191], v1, s[8:11], s17 offen offset:1024 sc1
    s_add_u32 s17, s16, 811008
    buffer_load_dwordx4 a[192:195], v1, s[8:11], s17 offen offset:0 sc1
    buffer_load_dwordx4 a[196:199], v1, s[8:11], s17 offen offset:1024 sc1
    s_add_u32 s17, s16, 817152
    buffer_load_dwordx4 a[200:203], v1, s[8:11], s17 offen offset:0 sc1
    buffer_load_dwordx4 a[204:207], v1, s[8:11], s17 offen offset:1024 sc1
    s_add_u32 s17, s16, 819200
    buffer_load_dwordx4 a[208:211], v1, s[8:11], s17 offen offset:0 sc1
    buffer_load_dwordx4 a[212:215], v1, s[8:11], s17 offen offset:1024 sc1
    s_add_u32 s17, s16, 821248
    buffer_load_dwordx4 a[216:219], v1, s[8:11], s17 offen offset:0 sc1
    buffer_load_dwordx4 a[220:223], v1, s[8:11], s17 offen offset:1024 sc1
    s_add_u32 s17, s16, 823296
    buffer_load_dwordx4 a[224:227], v1, s[8:11], s17 offen offset:0 sc1
    buffer_load_dwordx4 a[228:231], v1, s[8:11], s17 offen offset:1024 sc1
    s_add_u32 s17, s16, 825344
    buffer_load_dwordx4 a[232:235], v1, s[8:11], s17 offen offset:0 sc1
    buffer_load_dwordx4 a[236:239], v1, s[8:11], s17 offen offset:1024 sc1
    s_add_u32 s17, s16, 1204224
    buffer_load_dwordx4 a[240:243], v1, s[8:11], s17 offen offset:0 sc1
    buffer_load_dwordx4 a[244:247], v1, s[8:11], s17 offen offset:1024 sc1
    s_add_u32 s17, s16, 1206272
    buffer_load_dwordx4 a[248:251], v1, s[8:11], s17 offen offset:0 sc1
    buffer_load_dwordx4 a[252:255], v1, s[8:11], s17 offen offset:1024 sc1
    s_add_u32 s17, s16, 1208320
    buffer_load_dwordx4 v[192:195], v1, s[8:11], s17 offen offset:0 sc1
    buffer_load_dwordx4 v[196:199], v1, s[8:11], s17 offen offset:1024 sc1
    s_add_u32 s17, s16, 1210368
    buffer_load_dwordx4 v[200:203], v1, s[8:11], s17 offen offset:0 sc1
    buffer_load_dwordx4 v[204:207], v1, s[8:11], s17 offen offset:1024 sc1
    s_add_u32 s17, s16, 1212416
    buffer_load_dwordx4 v[208:211], v1, s[8:11], s17 offen offset:0 sc1
    buffer_load_dwordx4 v[212:215], v1, s[8:11], s17 offen offset:1024 sc1
    s_add_u32 s17, s16, 1218560
    buffer_load_dwordx4 v[216:219], v1, s[8:11], s17 offen offset:0 sc1
    buffer_load_dwordx4 v[220:223], v1, s[8:11], s17 offen offset:1024 sc1
    s_add_u32 s17, s16, 1220608
    buffer_load_dwordx4 v[224:227], v1, s[8:11], s17 offen offset:0 sc1
    buffer_load_dwordx4 v[228:231], v1, s[8:11], s17 offen offset:1024 sc1
    s_add_u32 s17, s16, 1222656
    buffer_load_dwordx4 v[232:235], v1, s[8:11], s17 offen offset:0 sc1
    buffer_load_dwordx4 v[236:239], v1, s[8:11], s17 offen offset:1024 sc1
    s_add_u32 s17, s16, 1224704
    buffer_load_dwordx4 v[240:243], v1, s[8:11], s17 offen offset:0 sc1
    buffer_load_dwordx4 v[244:247], v1, s[8:11], s17 offen offset:1024 sc1
    s_add_u32 s17, s16, 1226752
    buffer_load_dwordx4 v[248:251], v1, s[8:11], s17 offen offset:0 sc1
    buffer_load_dwordx4 v[252:255], v1, s[8:11], s17 offen offset:1024 sc1
    v_and_b32 v20, 15, v0
    v_add_u32 v3, s35, v1
    v_add_u32 v4, s36, v1
    v_lshrrev_b32 v21, 5, v0
    v_lshlrev_b32 v21, 4, v21
    v_add_u32 v21, v21, v20
    v_lshlrev_b32 v6, 4, v21
    v_lshrrev_b32 v21, 5, v0
    v_lshlrev_b32 v21, 9, v21
    v_and_b32 v22, 7, v0
    v_lshl_add_u32 v21, v22, 6, v21
    v_bfe_u32 v22, v0, 4, 1
    v_lshl_add_u32 v21, v22, 5, v21
    v_bfe_u32 v22, v0, 3, 1
    v_lshl_add_u32 v21, v22, 4, v21
    v_mov_b32 v13, v1
    s_mul_i32 s16, s12, 1184
    s_add_u32 s16, s16, 139264
    v_lshrrev_b32 v21, 4, v0
    v_mul_u32_u24 v21, 272, v21
    v_lshl_add_u32 v21, v20, 4, v21
    v_add_u32 v7, s16, v21
    v_and_b32 v21, 31, v0
    v_lshrrev_b32 v22, 2, v21
    v_and_b32 v23, 3, v21
    v_and_b32 v24, 1, v23
    v_lshrrev_b32 v25, 1, v23
    s_lshr_b32 s16, s12, 1
    s_lshl_b32 s16, s16, 3
    s_and_b32 s17, s12, 1
    s_lshl_b32 s17, s17, 1
    s_add_u32 s16, s16, s17
    v_lshlrev_b32 v25, 2, v25
    v_add_u32 v25, s16, v25
    v_lshrrev_b32 v26, 2, v22
    v_mul_u32_u24 v26, 272, v26
    v_lshl_add_u32 v26, v25, 4, v26
    v_mul_u32_u24 v24, 544, v24
    v_add_u32 v26, v26, v24
    v_and_b32 v27, 3, v22
    v_lshl_add_u32 v26, v27, 2, v26
    v_add_u32 v8, 139264, v26
    v_add_u32 v9, 1184, v8
    v_add_u32 v10, 1184, v9
    v_add_u32 v11, 1184, v10
    s_lshl_b32 s16, s13, 9
    s_lshl_b32 s17, s12, 7
    s_add_u32 s16, s16, s17
    v_lshlrev_b32 v26, 2, v21
    v_add_u32 v26, s16, v26
    v_mov_b32 v27, 0x80000000
    v_cmp_lt_u32 vcc, 31, v0
    s_nop 1
    v_cndmask_b32 v12, v26, v27, vcc
    s_lshl_b32 s16, s12, 2
    s_mul_i32 s16, s16, 28
    s_lshl_b32 s17, s13, 1
    s_add_u32 s16, s16, s17
    s_lshl_b32 s16, s16, 10
    s_add_u32 s38, s16, 35651584
    s_lshl_b32 s16, s12, 1
    s_mul_i32 s16, s16, 28
    s_add_u32 s16, s16, s17
    s_lshl_b32 s16, s16, 10
    s_add_u32 s55, s16, 100663296
    s_lshl_b32 s16, s13, 2
    s_add_u32 s16, s16, s12
    s_lshl_b32 s58, s16, 2
    s_waitcnt vmcnt(0) lgkmcnt(0)
    s_barrier
    v_min_u32 v20, 7, v0
    v_mul_u32_u24 v20, 16, v20
    s_mov_b32 s16, 512
Lcw_48:
    buffer_load_dword v21, v20, s[8:11], s16 offen sc1
    s_waitcnt vmcnt(0)
    v_cmp_gt_u32 vcc, 4, v21
    s_cbranch_vccz Lcw_48_d
    s_sleep 2
    s_sub_u32 s32, s32, 1
    s_cbranch_scc0 Lcw_48
    s_branch L_exit
Lcw_48_d:
    s_cmp_ge_u32 s14, 64
    s_cbranch_scc1 Lwu_49_d
    s_lshr_b32 s21, s14, 3
    s_lshl_b32 s21, s21, 10
    s_add_u32 s21, s21, 57344
    v_min_u32 v20, 55, v0
    v_lshlrev_b32 v20, 4, v20
Lwu_49:
    buffer_load_dwordx4 v[22:25], v20, s[8:11], s21 offen sc1
    s_waitcnt vmcnt(0)
    v_min_u32 v22, v22, v23
    v_min3_u32 v22, v22, v24, v25
    v_cmp_eq_u32 vcc, 0, v22
    s_cbranch_vccz Lwu_49_d
    s_sleep 2
    s_sub_u32 s32, s32, 1
    s_cbranch_scc0 Lwu_49
    s_branch L_exit
Lwu_49_d:
    v_mov_b64 v[44:45], 0
    v_mov_b64 v[46:47], 0
    v_mov_b64 v[48:49], 0
    v_mov_b64 v[50:51], 0
    v_mov_b64 v[52:53], 0
    v_mov_b64 v[54:55], 0
    v_mov_b64 v[56:57], 0
    v_mov_b64 v[58:59], 0
    v_mov_b64 v[60:61], 0
    v_mov_b64 v[62:63], 0
    v_mov_b64 v[64:65], 0
    v_mov_b64 v[66:67], 0
    v_mov_b64 v[68:69], 0
    v_mov_b64 v[70:71], 0
    v_mov_b64 v[72:73], 0
    v_mov_b64 v[74:75], 0
    v_mov_b64 v[168:169], 0
    v_mov_b64 v[170:171], 0
    v_mov_b64 v[172:173], 0
    v_mov_b64 v[174:175], 0
    s_branch LBfirst_51
    .p2align 6
LBtop_50:
    s_sleep 1
LBfirst_51:
    s_add_u32 s16, s33, s35
    s_add_u32 s17, s33, s36
Lpl_52:
    buffer_load_dwordx4 v[156:159], v1, s[8:11], s16 offen sc1
    buffer_load_dwordx4 v[160:163], v1, s[8:11], s17 offen sc1
    s_sub_u32 s32, s32, 1
    s_cbranch_scc1 L_exit
    s_waitcnt vmcnt(0)
    v_max3_u32 v188, v156, v157, v158
    v_max3_u32 v189, v159, v160, v161
    v_max3_u32 v188, v188, v162, v163
    v_max_u32 v188, v188, v189
    v_cmp_eq_u32 vcc, -1, v188
    s_cbranch_vccnz Lpl_52
    ds_write_b128 v3, v[156:159]
    ds_write_b128 v4, v[160:163]
    s_add_u32 s16, s38, 0
    buffer_load_dwordx4 v[124:127], v1, s[8:11], s16 offen offset:0 sc1
    buffer_load_dwordx4 v[132:135], v1, s[8:11], s16 offen offset:1024 sc1
    s_add_u32 s16, s38, 28672
    buffer_load_dwordx4 v[128:131], v1, s[8:11], s16 offen offset:0 sc1
    buffer_load_dwordx4 v[136:139], v1, s[8:11], s16 offen offset:1024 sc1
    s_add_u32 s16, s38, 57344
    buffer_load_dwordx4 v[140:143], v1, s[8:11], s16 offen offset:0 sc1
    buffer_load_dwordx4 v[148:151], v1, s[8:11], s16 offen offset:1024 sc1
    s_add_u32 s16, s38, 86016
    buffer_load_dwordx4 v[144:147], v1, s[8:11], s16 offen offset:0 sc1
    buffer_load_dwordx4 v[152:155], v1, s[8:11], s16 offen offset:1024 sc1
    s_add_u32 s38, s38, 458752
    s_waitcnt lgkmcnt(0)
    s_barrier
    ds_read_b128 v[16:19], v1 offset:0
    ds_read_b128 v[20:23], v1 offset:1024
    ds_read_b128 v[24:27], v1 offset:2048
    ds_read_b128 v[28:31], v1 offset:3072
    ds_read_b128 v[32:35], v1 offset:4096
    ds_read_b128 v[36:39], v1 offset:5120
    ds_read_b128 v[40:43], v1 offset:6144
    ds_read_b128 v[92:95], v5 offset:0
    ds_read_b128 v[96:99], v5 offset:1024
    ds_read_b128 v[100:103], v5 offset:2048
    ds_read_b128 v[104:107], v5 offset:3072
    s_add_u32 s16, s14, 2
    s_and_b32 s16, s16, 3
    s_lshl_b32 s16, s16, 13
    s_add_u32 s16, s16, 20971520
    v_mov_b32 v188, -1
    buffer_store_dword v188, v12, s[8:11], s16 offen sc1
    s_waitcnt lgkmcnt(10)
    v_smfmac_f32_16x16x64_bf16 v[44:47], v[16:19], a[0:7], v2
    ds_read_b128 v[108:111], v5 offset:4096
    s_waitcnt lgkmcnt(10)
    v_smfmac_f32_16x16x64_bf16 v[44:47], v[20:23], a[8:15], v2
    ds_read_b128 v[112:115], v5 offset:5120
    s_waitcnt lgkmcnt(10)
    v_smfmac_f32_16x16x64_bf16 v[44:47], v[24:27], a[16:23], v2
    ds_read_b128 v[116:119], v5 offset:6144
    s_waitcnt lgkmcnt(10)
    v_smfmac_f32_16x16x64_bf16 v[44:47], v[28:31], a[24:31], v2
    ds_read_b128 v[120:123], v5 offset:7168
    s_waitcnt lgkmcnt(10)
    v_smfmac_f32_16x16x64_bf16 v[44:47], v[32:35], a[32:39], v2
    s_waitcnt lgkmcnt(9)
    s_waitcnt lgkmcnt(4)
    v_smfmac_f32_16x16x64_bf16 v[44:47], v[36:39], v[92:99], v2
    s_waitcnt lgkmcnt(8)
    v_smfmac_f32_16x16x64_bf16 v[44:47], v[40:43], v[100:107], v2
    v_smfmac_f32_16x16x64_bf16 v[48:51], v[16:19], a[40:47], v2
    ds_read_b128 v[92:95], v5 offset:8192
    v_smfmac_f32_16x16x64_bf16 v[48:51], v[20:23], a[48:55], v2
    ds_read_b128 v[96:99], v5 offset:9216
    v_smfmac_f32_16x16x64_bf16 v[48:51], v[24:27], a[56:63], v2
    ds_read_b128 v[100:103], v5 offset:10240
    v_smfmac_f32_16x16x64_bf16 v[48:51], v[28:31], a[64:71], v2
    ds_read_b128 v[104:107], v5 offset:11264
    v_smfmac_f32_16x16x64_bf16 v[48:51], v[32:35], a[72:79], v2
    v_cvt_pk_bf16_f32 v76, v44, v45
    s_waitcnt lgkmcnt(4)
    v_smfmac_f32_16x16x64_bf16 v[48:51], v[36:39], v[108:115], v2
    v_cvt_pk_bf16_f32 v77, v46, v47
    v_smfmac_f32_16x16x64_bf16 v[48:51], v[40:43], v[116:123], v2
    v_smfmac_f32_16x16x64_bf16 v[52:55], v[16:19], a[80:87], v2
    ds_read_b128 v[108:111], v5 offset:12288
    v_smfmac_f32_16x16x64_bf16 v[52:55], v[20:23], a[88:95], v2
    ds_read_b128 v[112:115], v5 offset:13312
    v_smfmac_f32_16x16x64_bf16 v[52:55], v[24:27], a[96:103], v2
    ds_read_b128 v[116:119], v5 offset:14336
    v_smfmac_f32_16x16x64_bf16 v[52:55], v[28:31], a[104:111], v2
    ds_read_b128 v[120:123], v5 offset:15360
    v_smfmac_f32_16x16x64_bf16 v[52:55], v[32:35], a[112:119], v2
    v_cvt_pk_bf16_f32 v84, v48, v49
    s_waitcnt lgkmcnt(4)
    v_smfmac_f32_16x16x64_bf16 v[52:55], v[36:39], v[92:99], v2
    v_cvt_pk_bf16_f32 v85, v50, v51
    v_smfmac_f32_16x16x64_bf16 v[52:55], v[40:43], v[100:107], v2
    v_smfmac_f32_16x16x64_bf16 v[56:59], v[16:19], a[120:127], v2
    ds_read_b128 v[92:95], v5 offset:16384
    v_smfmac_f32_16x16x64_bf16 v[56:59], v[20:23], a[128:135], v2
    ds_read_b128 v[96:99], v5 offset:17408
    v_smfmac_f32_16x16x64_bf16 v[56:59], v[24:27], a[136:143], v2
    ds_read_b128 v[100:103], v5 offset:18432
    v_smfmac_f32_16x16x64_bf16 v[56:59], v[28:31], a[144:151], v2
    ds_read_b128 v[104:107], v5 offset:19456
    v_smfmac_f32_16x16x64_bf16 v[56:59], v[32:35], a[152:159], v2
    v_cvt_pk_bf16_f32 v78, v52, v53
    s_waitcnt lgkmcnt(4)
    v_smfmac_f32_16x16x64_bf16 v[56:59], v[36:39], v[108:115], v2
    v_cvt_pk_bf16_f32 v79, v54, v55
    v_smfmac_f32_16x16x64_bf16 v[56:59], v[40:43], v[116:123], v2
    v_smfmac_f32_16x16x64_bf16 v[60:63], v[16:19], a[160:167], v2
    ds_read_b128 v[108:111], v5 offset:20480
    v_smfmac_f32_16x16x64_bf16 v[60:63], v[20:23], a[168:175], v2
    ds_read_b128 v[112:115], v5 offset:21504
    v_smfmac_f32_16x16x64_bf16 v[60:63], v[24:27], a[176:183], v2
    ds_read_b128 v[116:119], v5 offset:22528
    v_smfmac_f32_16x16x64_bf16 v[60:63], v[28:31], a[184:191], v2
    ds_read_b128 v[120:123], v5 offset:23552
    v_smfmac_f32_16x16x64_bf16 v[60:63], v[32:35], a[192:199], v2
    v_cvt_pk_bf16_f32 v86, v56, v57
    s_waitcnt lgkmcnt(4)
    v_smfmac_f32_16x16x64_bf16 v[60:63], v[36:39], v[92:99], v2
    v_cvt_pk_bf16_f32 v87, v58, v59
    v_smfmac_f32_16x16x64_bf16 v[60:63], v[40:43], v[100:107], v2
    v_smfmac_f32_16x16x64_bf16 v[64:67], v[16:19], a[200:207], v2
    ds_read_b128 v[92:95], v5 offset:24576
    v_smfmac_f32_16x16x64_bf16 v[64:67], v[20:23], a[208:215], v2
    ds_read_b128 v[96:99], v5 offset:25600
    v_smfmac_f32_16x16x64_bf16 v[64:67], v[24:27], a[216:223], v2
    ds_read_b128 v[100:103], v5 offset:26624
    v_smfmac_f32_16x16x64_bf16 v[64:67], v[28:31], a[224:231], v2
    ds_read_b128 v[104:107], v5 offset:27648
    v_smfmac_f32_16x16x64_bf16 v[64:67], v[32:35], a[232:239], v2
    v_cvt_pk_bf16_f32 v80, v60, v61
    s_waitcnt lgkmcnt(4)
    v_smfmac_f32_16x16x64_bf16 v[64:67], v[36:39], v[108:115], v2
    v_cvt_pk_bf16_f32 v81, v62, v63
    v_smfmac_f32_16x16x64_bf16 v[64:67], v[40:43], v[116:123], v2
    v_smfmac_f32_16x16x64_bf16 v[68:71], v[16:19], a[240:247], v2
    ds_read_b128 v[108:111], v5 offset:28672
    v_smfmac_f32_16x16x64_bf16 v[68:71], v[20:23], a[248:255], v2
    ds_read_b128 v[112:115], v5 offset:29696
    v_smfmac_f32_16x16x64_bf16 v[68:71], v[24:27], v[192:199], v2
    ds_read_b128 v[116:119], v5 offset:30720
    v_smfmac_f32_16x16x64_bf16 v[68:71], v[28:31], v[200:207], v2
    ds_read_b128 v[120:123], v5 offset:31744
    v_smfmac_f32_16x16x64_bf16 v[68:71], v[32:35], v[208:215], v2
    v_cvt_pk_bf16_f32 v88, v64, v65
    s_waitcnt lgkmcnt(4)
    v_smfmac_f32_16x16x64_bf16 v[68:71], v[36:39], v[92:99], v2
    v_cvt_pk_bf16_f32 v89, v66, v67
    v_smfmac_f32_16x16x64_bf16 v[68:71], v[40:43], v[100:107], v2
    v_smfmac_f32_16x16x64_bf16 v[72:75], v[16:19], v[216:223], v2
    v_smfmac_f32_16x16x64_bf16 v[72:75], v[20:23], v[224:231], v2
    v_smfmac_f32_16x16x64_bf16 v[72:75], v[24:27], v[232:239], v2
    v_smfmac_f32_16x16x64_bf16 v[72:75], v[28:31], v[240:247], v2
    v_smfmac_f32_16x16x64_bf16 v[72:75], v[32:35], v[248:255], v2
    v_cvt_pk_bf16_f32 v82, v68, v69
    s_waitcnt lgkmcnt(0)
    v_smfmac_f32_16x16x64_bf16 v[72:75], v[36:39], v[108:115], v2
    v_cvt_pk_bf16_f32 v83, v70, v71
    v_smfmac_f32_16x16x64_bf16 v[72:75], v[40:43], v[116:123], v2
    s_nop 7
    v_cvt_pk_bf16_f32 v90, v72, v73
    v_cvt_pk_bf16_f32 v91, v74, v75
    s_lshl_b32 s16, s12, 11
    s_add_u32 s16, s16, s34
    s_lshl_b32 s17, s12, 9
    s_add_u32 s17, s17, s34
    s_add_u32 s17, s17, 8192
    s_add_u32 s18, s14, 1
    s_lshl_b32 s19, s18, 13
    s_and_b32 s18, s18, 3
    s_lshl_b32 s18, s18, 13
    s_add_u32 s18, s18, 20971520
    buffer_load_dwordx4 v[164:167], v6, s[8:11], s17 offen sc1
    buffer_load_dwordx4 v[156:159], v13, s[8:11], s16 offen sc1
    buffer_load_dwordx4 v[160:163], v13, s[8:11], s16 offen offset:1024 sc1
Lq_54:
    buffer_load_dwordx4 v[184:187], v6, s[8:11], s17 offen sc1
    buffer_load_dwordx4 v[176:179], v13, s[8:11], s16 offen sc1
    buffer_load_dwordx4 v[180:183], v13, s[8:11], s16 offen offset:1024 sc1
    s_waitcnt vmcnt(3)
    v_max3_u32 v188, v156, v157, v158
    v_max3_u32 v189, v159, v160, v161
    v_max3_u32 v188, v188, v162, v163
    v_max3_u32 v189, v189, v164, v165
    v_max3_u32 v188, v188, v166, v167
    v_max_u32 v188, v188, v189
    v_cmp_eq_u32 vcc, -1, v188
    s_cbranch_vccnz Lqa_55
    v_smfmac_f32_16x16x64_bf16 v[168:171], v[164:167], v[76:83], v2
    v_smfmac_f32_16x16x64_bf16 v[172:175], v[164:167], v[84:91], v2
    v_smfmac_f32_16x16x64_bf16 v[168:171], v[156:159], v[124:131], v2
    v_smfmac_f32_16x16x64_bf16 v[172:175], v[156:159], v[132:139], v2
    v_smfmac_f32_16x16x64_bf16 v[168:171], v[160:163], v[140:147], v2
    v_smfmac_f32_16x16x64_bf16 v[172:175], v[160:163], v[148:155], v2
    s_nop 7
    v_permlane32_swap_b32 v168, v172
    v_permlane32_swap_b32 v169, v173
    v_permlane32_swap_b32 v170, v174
    v_permlane32_swap_b32 v171, v175
    v_add_f32 v168, v168, v172
    v_add_f32 v169, v169, v173
    v_add_f32 v170, v170, v174
    v_add_f32 v171, v171, v175
    ds_write_b128 v7, v[168:171]
    s_waitcnt lgkmcnt(0)
    s_barrier
    ds_read2_b32 v[44:45], v8 offset0:0 offset1:4
    ds_read2_b32 v[46:47], v9 offset0:0 offset1:4
    ds_read2_b32 v[48:49], v10 offset0:0 offset1:4
    ds_read2_b32 v[50:51], v11 offset0:0 offset1:4
    s_waitcnt lgkmcnt(2)
    v_pk_add_f32 v[44:45], v[44:45], v[46:47]
    s_waitcnt lgkmcnt(0)
    v_pk_add_f32 v[48:49], v[48:49], v[50:51]
    v_pk_add_f32 v[44:45], v[44:45], v[48:49]
    v_cvt_pk_bf16_f32 v44, v44, v45
    buffer_store_dword v44, v12, s[8:11], s18 offen sc1
    s_branch Lqj_57
Lqa_55:
    buffer_load_dwordx4 v[164:167], v6, s[8:11], s17 offen sc1
    buffer_load_dwordx4 v[156:159], v13, s[8:11], s16 offen sc1
    buffer_load_dwordx4 v[160:163], v13, s[8:11], s16 offen offset:1024 sc1
    s_sub_u32 s32, s32, 1
    s_cbranch_scc1 L_exit
    s_waitcnt vmcnt(3)
    v_max3_u32 v188, v176, v177, v178
    v_max3_u32 v189, v179, v180, v181
    v_max3_u32 v188, v188, v182, v183
    v_max3_u32 v189, v189, v184, v185
    v_max3_u32 v188, v188, v186, v187
    v_max_u32 v188, v188, v189
    v_cmp_eq_u32 vcc, -1, v188
    s_cbranch_vccnz Lq_54
    v_smfmac_f32_16x16x64_bf16 v[168:171], v[184:187], v[76:83], v2
    v_smfmac_f32_16x16x64_bf16 v[172:175], v[184:187], v[84:91], v2
    v_smfmac_f32_16x16x64_bf16 v[168:171], v[176:179], v[124:131], v2
    v_smfmac_f32_16x16x64_bf16 v[172:175], v[176:179], v[132:139], v2
    v_smfmac_f32_16x16x64_bf16 v[168:171], v[180:183], v[140:147], v2
    v_smfmac_f32_16x16x64_bf16 v[172:175], v[180:183], v[148:155], v2
    s_nop 7
    v_permlane32_swap_b32 v168, v172
    v_permlane32_swap_b32 v169, v173
    v_permlane32_swap_b32 v170, v174
    v_permlane32_swap_b32 v171, v175
    v_add_f32 v168, v168, v172
    v_add_f32 v169, v169, v173
    v_add_f32 v170, v170, v174
    v_add_f32 v171, v171, v175
    ds_write_b128 v7, v[168:171]
    s_waitcnt lgkmcnt(0)
    s_barrier
    ds_read2_b32 v[44:45], v8 offset0:0 offset1:4
    ds_read2_b32 v[46:47], v9 offset0:0 offset1:4
    ds_read2_b32 v[48:49], v10 offset0:0 offset1:4
    ds_read2_b32 v[50:51], v11 offset0:0 offset1:4
    s_waitcnt lgkmcnt(2)
    v_pk_add_f32 v[44:45], v[44:45], v[46:47]
    s_waitcnt lgkmcnt(0)
    v_pk_add_f32 v[48:49], v[48:49], v[50:51]
    v_pk_add_f32 v[44:45], v[44:45], v[48:49]
    v_cvt_pk_bf16_f32 v44, v44, v45
    buffer_store_dword v44, v12, s[8:11], s18 offen sc1
Lqj_57:
    s_mov_b32 s17, s19
    s_add_u32 s17, s17, 23068672
    buffer_store_dword v44, v12, s[8:11], s17 offen sc1
    s_nop 1
    v_mov_b64 v[44:45], 0
    v_mov_b64 v[46:47], 0
    v_mov_b64 v[48:49], 0
    v_mov_b64 v[50:51], 0
    v_mov_b64 v[52:53], 0
    v_mov_b64 v[54:55], 0
    v_mov_b64 v[56:57], 0
    v_mov_b64 v[58:59], 0
    v_mov_b64 v[60:61], 0
    v_mov_b64 v[62:63], 0
    v_mov_b64 v[64:65], 0
    v_mov_b64 v[66:67], 0
    v_mov_b64 v[68:69], 0
    v_mov_b64 v[70:71], 0
    v_mov_b64 v[72:73], 0
    v_mov_b64 v[74:75], 0
    v_mov_b64 v[168:169], 0
    v_mov_b64 v[170:171], 0
    v_mov_b64 v[172:173], 0
    v_mov_b64 v[174:175], 0
    s_add_u32 s20, s14, 1
    s_and_b32 s21, s20, 7
    s_cmp_eq_u32 s21, 0
    s_cbranch_scc0 Lng_58
    s_cmp_ge_u32 s20, 64
    s_cbranch_scc1 Lwu_59_d
    s_lshr_b32 s21, s20, 3
    s_lshl_b32 s21, s21, 10
    s_add_u32 s21, s21, 57344
    v_min_u32 v16, 55, v0
    v_lshlrev_b32 v16, 4, v16
Lwu_59:
    buffer_load_dwordx4 v[18:21], v16, s[8:11], s21 offen sc1
    s_waitcnt vmcnt(0)
    v_min_u32 v18, v18, v19
    v_min3_u32 v18, v18, v20, v21
    v_cmp_eq_u32 vcc, 0, v18
    s_cbranch_vccz Lwu_59_d
    s_sleep 2
    s_sub_u32 s32, s32, 1
    s_cbranch_scc0 Lwu_59
    s_branch L_exit
Lwu_59_d:
Lng_58:
    s_add_u32 s14, s14, 1
    s_and_b32 s16, s14, 3
    s_lshl_b32 s17, s16, 13
    s_add_u32 s33, s17, 20971520
    s_lshl_b32 s17, s16, 14
    s_add_u32 s34, s17, 22020096
    s_cmp_lt_u32 s14, 63
    s_cbranch_scc1 LBtop_50
    s_branch L_exit
L_roleX:
    s_sub_u32 s13, s13, 30
    v_lshlrev_b32 v1, 4, v0
    s_cmp_eq_u32 s13, 1
    s_cbranch_scc1 L_exit
    v_and_b32 v20, 15, v0
    v_lshrrev_b32 v21, 4, v0
    s_mul_i32 s18, s12, 7
    s_lshr_b32 s18, s18, 1
    v_lshrrev_b32 v23, 1, v21
    v_lshlrev_b32 v23, 8, v23
    v_and_b32 v24, 7, v20
    v_lshl_add_u32 v23, v24, 4, v23
    v_and_b32 v24, 1, v21
    v_lshl_add_u32 v23, v24, 3, v23
    s_lshl_b32 s19, s18, 9
    v_add_u32 v5, s19, v23
    v_add_u32 v6, 1024, v5
    s_lshl_b32 s19, s18, 10
    s_add_u32 s54, s19, 24117248
    v_add_u32 v3, s35, v1
    v_add_u32 v4, s36, v1
    s_lshl_b32 s58, s12, 2
    v_min_u32 v20, 7, v0
    v_mul_u32_u24 v20, 16, v20
    s_mov_b32 s16, 512
Lcw_61:
    buffer_load_dword v21, v20, s[8:11], s16 offen sc1
    s_waitcnt vmcnt(0)
    v_cmp_gt_u32 vcc, 4, v21
    s_cbranch_vccz Lcw_61_d
    s_sleep 2
    s_sub_u32 s32, s32, 1
    s_cbranch_scc0 Lcw_61
    s_branch L_exit
Lcw_61_d:
LXtop_62:
    s_lshl_b32 s18, s14, 13
    s_add_u32 s18, s18, 23068672
    s_add_u32 s16, s18, s35
    s_add_u32 s17, s18, s36
Lpl_63:
    buffer_load_dwordx4 v[32:35], v1, s[8:11], s16 offen sc1
    buffer_load_dwordx4 v[36:39], v1, s[8:11], s17 offen sc1
    s_sleep 1
    s_sub_u32 s32, s32, 1
    s_cbranch_scc1 L_exit
    s_waitcnt vmcnt(0)
    v_max3_u32 v44, v32, v33, v34
    v_max3_u32 v45, v35, v36, v37
    v_max3_u32 v44, v44, v38, v39
    v_max_u32 v44, v44, v45
    v_cmp_eq_u32 vcc, -1, v44
    s_cbranch_vccnz Lpl_63
    ds_write_b128 v3, v[32:35]
    ds_write_b128 v4, v[36:39]
    s_waitcnt lgkmcnt(0)
    s_barrier
    ds_read2_b32 v[16:17], v5 offset0:0 offset1:32
    ds_read2_b32 v[18:19], v5 offset0:1 offset1:33
    ds_read2_b32 v[20:21], v5 offset0:128 offset1:160
    ds_read2_b32 v[22:23], v5 offset0:129 offset1:161
    ds_read2_b32 v[24:25], v6 offset0:0 offset1:32
    ds_read2_b32 v[26:27], v6 offset0:1 offset1:33
    ds_read2_b32 v[28:29], v6 offset0:128 offset1:160
    ds_read2_b32 v[30:31], v6 offset0:129 offset1:161
    s_mul_i32 s16, s14, 14336
    s_add_u32 s16, s16, s54
    s_waitcnt lgkmcnt(0)
    buffer_store_dwordx4 v[16:19], v1, s[8:11], s16 offen offset:0 sc1
    buffer_store_dwordx4 v[20:23], v1, s[8:11], s16 offen offset:1024 sc1
    buffer_store_dwordx4 v[24:27], v1, s[8:11], s16 offen offset:2048 sc1
    buffer_store_dwordx4 v[28:31], v1, s[8:11], s16 offen offset:3072 sc1
    s_barrier
    s_waitcnt vmcnt(0)
    s_lshl_b32 s16, s14, 6
    s_add_u32 s16, s16, s58
    s_add_u32 s16, s16, 4096
    v_mov_b32 v44, 1
    v_mov_b32 v45, 0
    s_mov_b64 exec, 1
    buffer_store_dword v44, v45, s[8:11], s16 offen sc1
    s_mov_b64 exec, -1
    s_add_u32 s14, s14, 1
    s_cmp_lt_u32 s14, 64
    s_cbranch_scc1 LXtop_62
    s_branch L_exit
E_worker:
    v_lshlrev_b32 v1, 4, v0
    s_lshr_b32 s30, s72, 1
    s_and_b32 s31, s72, 1
    s_lshl_b32 s32, s31, 2
    s_add_u32 s32, s32, s3
    s_mul_i32 s33, s32, 28672
    s_add_u32 s33, s33, 1048576
    s_mul_i32 s34, s30, 57344
    s_cmp_eq_u32 s3, 0
    s_cbranch_scc0 Lwn_65_s
    v_min_u32 v6, 7, v0
    v_mul_u32_u24 v6, 16, v6
    s_mov_b32 s77, 512
Lwn_65:
    buffer_load_dword v7, v6, s[8:11], s77 offen sc1
    s_waitcnt vmcnt(0)
    v_cmp_gt_u32 vcc, 4, v7
    s_cbranch_vccz Lwn_65_s
    s_sleep 2
    s_sub_u32 s76, s76, 1
    s_cbranch_scc0 Lwn_65
    s_branch L_exit
Lwn_65_s:
    s_barrier
    s_mov_b32 s37, s33
    s_add_u32 s36, s37, 0
    buffer_load_dwordx4 v[16:19], v1, s[8:11], s36 offen offset:0 sc1
    s_add_u32 s36, s37, 12288
    buffer_load_dwordx4 v[72:75], v1, s[8:11], s36 offen offset:2048 sc1
    s_add_u32 s36, s37, 0
    buffer_load_dwordx4 v[20:23], v1, s[8:11], s36 offen offset:1024 sc1
    s_add_u32 s36, s37, 12288
    buffer_load_dwordx4 v[76:79], v1, s[8:11], s36 offen offset:3072 sc1
    s_add_u32 s36, s37, 0
    buffer_load_dwordx4 v[24:27], v1, s[8:11], s36 offen offset:2048 sc1
    s_add_u32 s36, s37, 16384
    buffer_load_dwordx4 v[80:83], v1, s[8:11], s36 offen offset:0 sc1
    s_add_u32 s36, s37, 0
    buffer_load_dwordx4 v[28:31], v1, s[8:11], s36 offen offset:3072 sc1
    s_add_u32 s36, s37, 16384
    buffer_load_dwordx4 v[84:87], v1, s[8:11], s36 offen offset:1024 sc1
    s_add_u32 s36, s37, 4096
    buffer_load_dwordx4 v[32:35], v1, s[8:11], s36 offen offset:0 sc1
    s_add_u32 s36, s37, 16384
    buffer_load_dwordx4 v[88:91], v1, s[8:11], s36 offen offset:2048 sc1
    s_add_u32 s36, s37, 4096
    buffer_load_dwordx4 v[36:39], v1, s[8:11], s36 offen offset:1024 sc1
    s_add_u32 s36, s37, 16384
    buffer_load_dwordx4 v[92:95], v1, s[8:11], s36 offen offset:3072 sc1
    s_add_u32 s36, s37, 4096
    buffer_load_dwordx4 v[40:43], v1, s[8:11], s36 offen offset:2048 sc1
    s_add_u32 s36, s37, 20480
    buffer_load_dwordx4 v[96:99], v1, s[8:11], s36 offen offset:0 sc1
    s_add_u32 s36, s37, 4096
    buffer_load_dwordx4 v[44:47], v1, s[8:11], s36 offen offset:3072 sc1
    s_add_u32 s36, s37, 20480
    buffer_load_dwordx4 v[100:103], v1, s[8:11], s36 offen offset:1024 sc1
    s_add_u32 s36, s37, 8192
    buffer_load_dwordx4 v[48:51], v1, s[8:11], s36 offen offset:0 sc1
    s_add_u32 s36, s37, 20480
    buffer_load_dwordx4 v[104:107], v1, s[8:11], s36 offen offset:2048 sc1
    s_add_u32 s36, s37, 8192
    buffer_load_dwordx4 v[52:55], v1, s[8:11], s36 offen offset:1024 sc1
    s_add_u32 s36, s37, 20480
    buffer_load_dwordx4 v[108:111], v1, s[8:11], s36 offen offset:3072 sc1
    s_add_u32 s36, s37, 8192
    buffer_load_dwordx4 v[56:59], v1, s[8:11], s36 offen offset:2048 sc1
    s_add_u32 s36, s37, 24576
    buffer_load_dwordx4 v[112:115], v1, s[8:11], s36 offen offset:0 sc1
    s_add_u32 s36, s37, 8192
    buffer_load_dwordx4 v[60:63], v1, s[8:11], s36 offen offset:3072 sc1
    s_add_u32 s36, s37, 24576
    buffer_load_dwordx4 v[116:119], v1, s[8:11], s36 offen offset:1024 sc1
    s_add_u32 s36, s37, 12288
    buffer_load_dwordx4 v[64:67], v1, s[8:11], s36 offen offset:0 sc1
    s_add_u32 s36, s37, 24576
    buffer_load_dwordx4 v[120:123], v1, s[8:11], s36 offen offset:2048 sc1
    s_add_u32 s36, s37, 12288
    buffer_load_dwordx4 v[68:71], v1, s[8:11], s36 offen offset:1024 sc1
    s_add_u32 s36, s37, 24576
    buffer_load_dwordx4 v[124:127], v1, s[8:11], s36 offen offset:3072 sc1
    s_cmp_eq_u32 s3, 0
    s_cbranch_scc0 Lwn_66_s
    v_min_u32 v6, 15, v0
    v_mul_u32_u24 v6, 16, v6
    s_mov_b32 s77, 256
Lwn_66:
    buffer_load_dword v7, v6, s[8:11], s77 offen sc1
    s_waitcnt vmcnt(0)
    v_cmp_gt_u32 vcc, 7, v7
    s_cbranch_vccz Lwn_66_s
    s_sleep 2
    s_sub_u32 s76, s76, 1
    s_cbranch_scc0 Lwn_66
    s_branch L_exit
Lwn_66_s:
    s_barrier
    s_add_u32 s35, s34, 12582912
    s_add_u32 s36, s35, 0
    buffer_load_dwordx4 a[0:3], v1, s[8:11], s36 offen offset:0 sc1
    buffer_load_dwordx4 a[4:7], v1, s[8:11], s36 offen offset:1024 sc1
    buffer_load_dwordx4 a[8:11], v1, s[8:11], s36 offen offset:2048 sc1
    buffer_load_dwordx4 a[12:15], v1, s[8:11], s36 offen offset:3072 sc1
    s_add_u32 s36, s35, 4096
    buffer_load_dwordx4 a[16:19], v1, s[8:11], s36 offen offset:0 sc1
    buffer_load_dwordx4 a[20:23], v1, s[8:11], s36 offen offset:1024 sc1
    buffer_load_dwordx4 a[24:27], v1, s[8:11], s36 offen offset:2048 sc1
    buffer_load_dwordx4 a[28:31], v1, s[8:11], s36 offen offset:3072 sc1
    s_add_u32 s36, s35, 8192
    buffer_load_dwordx4 a[32:35], v1, s[8:11], s36 offen offset:0 sc1
    buffer_load_dwordx4 a[36:39], v1, s[8:11], s36 offen offset:1024 sc1
    buffer_load_dwordx4 a[40:43], v1, s[8:11], s36 offen offset:2048 sc1
    buffer_load_dwordx4 a[44:47], v1, s[8:11], s36 offen offset:3072 sc1
    s_add_u32 s36, s35, 12288
    buffer_load_dwordx4 a[48:51], v1, s[8:11], s36 offen offset:0 sc1
    buffer_load_dwordx4 a[52:55], v1, s[8:11], s36 offen offset:1024 sc1
    buffer_load_dwordx4 a[56:59], v1, s[8:11], s36 offen offset:2048 sc1
    buffer_load_dwordx4 a[60:63], v1, s[8:11], s36 offen offset:3072 sc1
    s_add_u32 s36, s35, 16384
    buffer_load_dwordx4 a[64:67], v1, s[8:11], s36 offen offset:0 sc1
    buffer_load_dwordx4 a[68:71], v1, s[8:11], s36 offen offset:1024 sc1
    buffer_load_dwordx4 a[72:75], v1, s[8:11], s36 offen offset:2048 sc1
    buffer_load_dwordx4 a[76:79], v1, s[8:11], s36 offen offset:3072 sc1
    s_add_u32 s36, s35, 20480
    buffer_load_dwordx4 a[80:83], v1, s[8:11], s36 offen offset:0 sc1
    buffer_load_dwordx4 a[84:87], v1, s[8:11], s36 offen offset:1024 sc1
    buffer_load_dwordx4 a[88:91], v1, s[8:11], s36 offen offset:2048 sc1
    buffer_load_dwordx4 a[92:95], v1, s[8:11], s36 offen offset:3072 sc1
    s_add_u32 s36, s35, 24576
    buffer_load_dwordx4 a[96:99], v1, s[8:11], s36 offen offset:0 sc1
    buffer_load_dwordx4 a[100:103], v1, s[8:11], s36 offen offset:1024 sc1
    buffer_load_dwordx4 a[104:107], v1, s[8:11], s36 offen offset:2048 sc1
    buffer_load_dwordx4 a[108:111], v1, s[8:11], s36 offen offset:3072 sc1
    s_add_u32 s36, s35, 28672
    buffer_load_dwordx4 a[112:115], v1, s[8:11], s36 offen offset:0 sc1
    buffer_load_dwordx4 a[116:119], v1, s[8:11], s36 offen offset:1024 sc1
    buffer_load_dwordx4 a[120:123], v1, s[8:11], s36 offen offset:2048 sc1
    buffer_load_dwordx4 a[124:127], v1, s[8:11], s36 offen offset:3072 sc1
    s_add_u32 s36, s35, 32768
    buffer_load_dwordx4 a[128:131], v1, s[8:11], s36 offen offset:0 sc1
    buffer_load_dwordx4 a[132:135], v1, s[8:11], s36 offen offset:1024 sc1
    buffer_load_dwordx4 a[136:139], v1, s[8:11], s36 offen offset:2048 sc1
    buffer_load_dwordx4 a[140:143], v1, s[8:11], s36 offen offset:3072 sc1
    s_add_u32 s36, s35, 36864
    buffer_load_dwordx4 a[144:147], v1, s[8:11], s36 offen offset:0 sc1
    buffer_load_dwordx4 a[148:151], v1, s[8:11], s36 offen offset:1024 sc1
    buffer_load_dwordx4 a[152:155], v1, s[8:11], s36 offen offset:2048 sc1
    buffer_load_dwordx4 a[156:159], v1, s[8:11], s36 offen offset:3072 sc1
    s_add_u32 s36, s35, 40960
    buffer_load_dwordx4 a[160:163], v1, s[8:11], s36 offen offset:0 sc1
    buffer_load_dwordx4 a[164:167], v1, s[8:11], s36 offen offset:1024 sc1
    buffer_load_dwordx4 a[168:171], v1, s[8:11], s36 offen offset:2048 sc1
    buffer_load_dwordx4 a[172:175], v1, s[8:11], s36 offen offset:3072 sc1
    s_add_u32 s36, s35, 45056
    buffer_load_dwordx4 a[176:179], v1, s[8:11], s36 offen offset:0 sc1
    buffer_load_dwordx4 a[180:183], v1, s[8:11], s36 offen offset:1024 sc1
    buffer_load_dwordx4 a[184:187], v1, s[8:11], s36 offen offset:2048 sc1
    buffer_load_dwordx4 a[188:191], v1, s[8:11], s36 offen offset:3072 sc1
    s_add_u32 s36, s35, 49152
    buffer_load_dwordx4 a[192:195], v1, s[8:11], s36 offen offset:0 sc1
    buffer_load_dwordx4 a[196:199], v1, s[8:11], s36 offen offset:1024 sc1
    buffer_load_dwordx4 a[200:203], v1, s[8:11], s36 offen offset:2048 sc1
    buffer_load_dwordx4 a[204:207], v1, s[8:11], s36 offen offset:3072 sc1
    s_add_u32 s36, s35, 53248
    buffer_load_dwordx4 a[208:211], v1, s[8:11], s36 offen offset:0 sc1
    buffer_load_dwordx4 a[212:215], v1, s[8:11], s36 offen offset:1024 sc1
    buffer_load_dwordx4 a[216:219], v1, s[8:11], s36 offen offset:2048 sc1
    buffer_load_dwordx4 a[220:223], v1, s[8:11], s36 offen offset:3072 sc1
    s_mul_i32 s38, s32, 458752
    s_lshl_b32 s39, s30, 12
    s_add_u32 s38, s38, s39
    s_add_u32 s38, s38, 35651584
    s_mov_b32 s40, 0
    s_waitcnt vmcnt(0)
Lgs_67:
    s_add_u32 s37, s37, 229376
    s_waitcnt vmcnt(30)
    v_mfma_f32_16x16x32_bf16 v[128:131], v[16:19], a[0:3], 0
    v_mfma_f32_16x16x32_bf16 v[132:135], v[16:19], a[56:59], 0
    v_mfma_f32_16x16x32_bf16 v[136:139], v[16:19], a[112:115], 0
    v_mfma_f32_16x16x32_bf16 v[140:143], v[16:19], a[168:171], 0
    v_mfma_f32_16x16x32_bf16 v[144:147], v[72:75], a[0:3], 0
    v_mfma_f32_16x16x32_bf16 v[148:151], v[72:75], a[56:59], 0
    v_mfma_f32_16x16x32_bf16 v[152:155], v[72:75], a[112:115], 0
    v_mfma_f32_16x16x32_bf16 v[156:159], v[72:75], a[168:171], 0
    s_add_u32 s36, s37, 0
    buffer_load_dwordx4 v[16:19], v1, s[8:11], s36 offen offset:0 sc1
    s_add_u32 s36, s37, 12288
    buffer_load_dwordx4 v[72:75], v1, s[8:11], s36 offen offset:2048 sc1
    s_waitcnt vmcnt(30)
    v_mfma_f32_16x16x32_bf16 v[128:131], v[20:23], a[4:7], v[128:131]
    v_mfma_f32_16x16x32_bf16 v[132:135], v[20:23], a[60:63], v[132:135]
    v_mfma_f32_16x16x32_bf16 v[136:139], v[20:23], a[116:119], v[136:139]
    v_mfma_f32_16x16x32_bf16 v[140:143], v[20:23], a[172:175], v[140:143]
    v_mfma_f32_16x16x32_bf16 v[144:147], v[76:79], a[4:7], v[144:147]
    v_mfma_f32_16x16x32_bf16 v[148:151], v[76:79], a[60:63], v[148:151]
    v_mfma_f32_16x16x32_bf16 v[152:155], v[76:79], a[116:119], v[152:155]
    v_mfma_f32_16x16x32_bf16 v[156:159], v[76:79], a[172:175], v[156:159]
    s_add_u32 s36, s37, 0
    buffer_load_dwordx4 v[20:23], v1, s[8:11], s36 offen offset:1024 sc1
    s_add_u32 s36, s37, 12288
    buffer_load_dwordx4 v[76:79], v1, s[8:11], s36 offen offset:3072 sc1
    s_waitcnt vmcnt(30)
    v_mfma_f32_16x16x32_bf16 v[128:131], v[24:27], a[8:11], v[128:131]
    v_mfma_f32_16x16x32_bf16 v[132:135], v[24:27], a[64:67], v[132:135]
    v_mfma_f32_16x16x32_bf16 v[136:139], v[24:27], a[120:123], v[136:139]
    v_mfma_f32_16x16x32_bf16 v[140:143], v[24:27], a[176:179], v[140:143]
    v_mfma_f32_16x16x32_bf16 v[144:147], v[80:83], a[8:11], v[144:147]
    v_mfma_f32_16x16x32_bf16 v[148:151], v[80:83], a[64:67], v[148:151]
    v_mfma_f32_16x16x32_bf16 v[152:155], v[80:83], a[120:123], v[152:155]
    v_mfma_f32_16x16x32_bf16 v[156:159], v[80:83], a[176:179], v[156:159]
    s_add_u32 s36, s37, 0
    buffer_load_dwordx4 v[24:27], v1, s[8:11], s36 offen offset:2048 sc1
    s_add_u32 s36, s37, 16384
    buffer_load_dwordx4 v[80:83], v1, s[8:11], s36 offen offset:0 sc1
    s_waitcnt vmcnt(30)
    v_mfma_f32_16x16x32_bf16 v[128:131], v[28:31], a[12:15], v[128:131]
    v_mfma_f32_16x16x32_bf16 v[132:135], v[28:31], a[68:71], v[132:135]
    v_mfma_f32_16x16x32_bf16 v[136:139], v[28:31], a[124:127], v[136:139]
    v_mfma_f32_16x16x32_bf16 v[140:143], v[28:31], a[180:183], v[140:143]
    v_mfma_f32_16x16x32_bf16 v[144:147], v[84:87], a[12:15], v[144:147]
    v_mfma_f32_16x16x32_bf16 v[148:151], v[84:87], a[68:71], v[148:151]
    v_mfma_f32_16x16x32_bf16 v[152:155], v[84:87], a[124:127], v[152:155]
    v_mfma_f32_16x16x32_bf16 v[156:159], v[84:87], a[180:183], v[156:159]
    s_add_u32 s36, s37, 0
    buffer_load_dwordx4 v[28:31], v1, s[8:11], s36 offen offset:3072 sc1
    s_add_u32 s36, s37, 16384
    buffer_load_dwordx4 v[84:87], v1, s[8:11], s36 offen offset:1024 sc1
    s_waitcnt vmcnt(30)
    v_mfma_f32_16x16x32_bf16 v[128:131], v[32:35], a[16:19], v[128:131]
    v_mfma_f32_16x16x32_bf16 v[132:135], v[32:35], a[72:75], v[132:135]
    v_mfma_f32_16x16x32_bf16 v[136:139], v[32:35], a[128:131], v[136:139]
    v_mfma_f32_16x16x32_bf16 v[140:143], v[32:35], a[184:187], v[140:143]
    v_mfma_f32_16x16x32_bf16 v[144:147], v[88:91], a[16:19], v[144:147]
    v_mfma_f32_16x16x32_bf16 v[148:151], v[88:91], a[72:75], v[148:151]
    v_mfma_f32_16x16x32_bf16 v[152:155], v[88:91], a[128:131], v[152:155]
    v_mfma_f32_16x16x32_bf16 v[156:159], v[88:91], a[184:187], v[156:159]
    s_add_u32 s36, s37, 4096
    buffer_load_dwordx4 v[32:35], v1, s[8:11], s36 offen offset:0 sc1
    s_add_u32 s36, s37, 16384
    buffer_load_dwordx4 v[88:91], v1, s[8:11], s36 offen offset:2048 sc1
    s_waitcnt vmcnt(30)
    v_mfma_f32_16x16x32_bf16 v[128:131], v[36:39], a[20:23], v[128:131]
    v_mfma_f32_16x16x32_bf16 v[132:135], v[36:39], a[76:79], v[132:135]
    v_mfma_f32_16x16x32_bf16 v[136:139], v[36:39], a[132:135], v[136:139]
    v_mfma_f32_16x16x32_bf16 v[140:143], v[36:39], a[188:191], v[140:143]
    v_mfma_f32_16x16x32_bf16 v[144:147], v[92:95], a[20:23], v[144:147]
    v_mfma_f32_16x16x32_bf16 v[148:151], v[92:95], a[76:79], v[148:151]
    v_mfma_f32_16x16x32_bf16 v[152:155], v[92:95], a[132:135], v[152:155]
    v_mfma_f32_16x16x32_bf16 v[156:159], v[92:95], a[188:191], v[156:159]
    s_add_u32 s36, s37, 4096
    buffer_load_dwordx4 v[36:39], v1, s[8:11], s36 offen offset:1024 sc1
    s_add_u32 s36, s37, 16384
    buffer_load_dwordx4 v[92:95], v1, s[8:11], s36 offen offset:3072 sc1
    s_waitcnt vmcnt(30)
    v_mfma_f32_16x16x32_bf16 v[128:131], v[40:43], a[24:27], v[128:131]
    v_mfma_f32_16x16x32_bf16 v[132:135], v[40:43], a[80:83], v[132:135]
    v_mfma_f32_16x16x32_bf16 v[136:139], v[40:43], a[136:139], v[136:139]
    v_mfma_f32_16x16x32_bf16 v[140:143], v[40:43], a[192:195], v[140:143]
    v_mfma_f32_16x16x32_bf16 v[144:147], v[96:99], a[24:27], v[144:147]
    v_mfma_f32_16x16x32_bf16 v[148:151], v[96:99], a[80:83], v[148:151]
    v_mfma_f32_16x16x32_bf16 v[152:155], v[96:99], a[136:139], v[152:155]
    v_mfma_f32_16x16x32_bf16 v[156:159], v[96:99], a[192:195], v[156:159]
    s_add_u32 s36, s37, 4096
    buffer_load_dwordx4 v[40:43], v1, s[8:11], s36 offen offset:2048 sc1
    s_add_u32 s36, s37, 20480
    buffer_load_dwordx4 v[96:99], v1, s[8:11], s36 offen offset:0 sc1
    s_waitcnt vmcnt(30)
    v_mfma_f32_16x16x32_bf16 v[128:131], v[44:47], a[28:31], v[128:131]
    v_mfma_f32_16x16x32_bf16 v[132:135], v[44:47], a[84:87], v[132:135]
    v_mfma_f32_16x16x32_bf16 v[136:139], v[44:47], a[140:143], v[136:139]
    v_mfma_f32_16x16x32_bf16 v[140:143], v[44:47], a[196:199], v[140:143]
    v_mfma_f32_16x16x32_bf16 v[144:147], v[100:103], a[28:31], v[144:147]
    v_mfma_f32_16x16x32_bf16 v[148:151], v[100:103], a[84:87], v[148:151]
    v_mfma_f32_16x16x32_bf16 v[152:155], v[100:103], a[140:143], v[152:155]
    v_mfma_f32_16x16x32_bf16 v[156:159], v[100:103], a[196:199], v[156:159]
    s_add_u32 s36, s37, 4096
    buffer_load_dwordx4 v[44:47], v1, s[8:11], s36 offen offset:3072 sc1
    s_add_u32 s36, s37, 20480
    buffer_load_dwordx4 v[100:103], v1, s[8:11], s36 offen offset:1024 sc1
    s_waitcnt vmcnt(30)
    v_mfma_f32_16x16x32_bf16 v[128:131], v[48:51], a[32:35], v[128:131]
    v_mfma_f32_16x16x32_bf16 v[132:135], v[48:51], a[88:91], v[132:135]
    v_mfma_f32_16x16x32_bf16 v[136:139], v[48:51], a[144:147], v[136:139]
    v_mfma_f32_16x16x32_bf16 v[140:143], v[48:51], a[200:203], v[140:143]
    v_mfma_f32_16x16x32_bf16 v[144:147], v[104:107], a[32:35], v[144:147]
    v_mfma_f32_16x16x32_bf16 v[148:151], v[104:107], a[88:91], v[148:151]
    v_mfma_f32_16x16x32_bf16 v[152:155], v[104:107], a[144:147], v[152:155]
    v_mfma_f32_16x16x32_bf16 v[156:159], v[104:107], a[200:203], v[156:159]
    s_add_u32 s36, s37, 8192
    buffer_load_dwordx4 v[48:51], v1, s[8:11], s36 offen offset:0 sc1
    s_add_u32 s36, s37, 20480
    buffer_load_dwordx4 v[104:107], v1, s[8:11], s36 offen offset:2048 sc1
    s_waitcnt vmcnt(30)
    v_mfma_f32_16x16x32_bf16 v[128:131], v[52:55], a[36:39], v[128:131]
    v_mfma_f32_16x16x32_bf16 v[132:135], v[52:55], a[92:95], v[132:135]
    v_mfma_f32_16x16x32_bf16 v[136:139], v[52:55], a[148:151], v[136:139]
    v_mfma_f32_16x16x32_bf16 v[140:143], v[52:55], a[204:207], v[140:143]
    v_mfma_f32_16x16x32_bf16 v[144:147], v[108:111], a[36:39], v[144:147]
    v_mfma_f32_16x16x32_bf16 v[148:151], v[108:111], a[92:95], v[148:151]
    v_mfma_f32_16x16x32_bf16 v[152:155], v[108:111], a[148:151], v[152:155]
    v_mfma_f32_16x16x32_bf16 v[156:159], v[108:111], a[204:207], v[156:159]
    s_add_u32 s36, s37, 8192
    buffer_load_dwordx4 v[52:55], v1, s[8:11], s36 offen offset:1024 sc1
    s_add_u32 s36, s37, 20480
    buffer_load_dwordx4 v[108:111], v1, s[8:11], s36 offen offset:3072 sc1
    s_waitcnt vmcnt(30)
    v_mfma_f32_16x16x32_bf16 v[128:131], v[56:59], a[40:43], v[128:131]
    v_mfma_f32_16x16x32_bf16 v[132:135], v[56:59], a[96:99], v[132:135]
    v_mfma_f32_16x16x32_bf16 v[136:139], v[56:59], a[152:155], v[136:139]
    v_mfma_f32_16x16x32_bf16 v[140:143], v[56:59], a[208:211], v[140:143]
    v_mfma_f32_16x16x32_bf16 v[144:147], v[112:115], a[40:43], v[144:147]
    v_mfma_f32_16x16x32_bf16 v[148:151], v[112:115], a[96:99], v[148:151]
    v_mfma_f32_16x16x32_bf16 v[152:155], v[112:115], a[152:155], v[152:155]
    v_mfma_f32_16x16x32_bf16 v[156:159], v[112:115], a[208:211], v[156:159]
    s_add_u32 s36, s37, 8192
    buffer_load_dwordx4 v[56:59], v1, s[8:11], s36 offen offset:2048 sc1
    s_add_u32 s36, s37, 24576
    buffer_load_dwordx4 v[112:115], v1, s[8:11], s36 offen offset:0 sc1
    s_waitcnt vmcnt(30)
    v_mfma_f32_16x16x32_bf16 v[128:131], v[60:63], a[44:47], v[128:131]
    v_mfma_f32_16x16x32_bf16 v[132:135], v[60:63], a[100:103], v[132:135]
    v_mfma_f32_16x16x32_bf16 v[136:139], v[60:63], a[156:159], v[136:139]
    v_mfma_f32_16x16x32_bf16 v[140:143], v[60:63], a[212:215], v[140:143]
    v_mfma_f32_16x16x32_bf16 v[144:147], v[116:119], a[44:47], v[144:147]
    v_mfma_f32_16x16x32_bf16 v[148:151], v[116:119], a[100:103], v[148:151]
    v_mfma_f32_16x16x32_bf16 v[152:155], v[116:119], a[156:159], v[152:155]
    v_mfma_f32_16x16x32_bf16 v[156:159], v[116:119], a[212:215], v[156:159]
    s_add_u32 s36, s37, 8192
    buffer_load_dwordx4 v[60:63], v1, s[8:11], s36 offen offset:3072 sc1
    s_add_u32 s36, s37, 24576
    buffer_load_dwordx4 v[116:119], v1, s[8:11], s36 offen offset:1024 sc1
    s_waitcnt vmcnt(30)
    v_mfma_f32_16x16x32_bf16 v[128:131], v[64:67], a[48:51], v[128:131]
    v_mfma_f32_16x16x32_bf16 v[132:135], v[64:67], a[104:107], v[132:135]
    v_mfma_f32_16x16x32_bf16 v[136:139], v[64:67], a[160:163], v[136:139]
    v_mfma_f32_16x16x32_bf16 v[140:143], v[64:67], a[216:219], v[140:143]
    v_mfma_f32_16x16x32_bf16 v[144:147], v[120:123], a[48:51], v[144:147]
    v_mfma_f32_16x16x32_bf16 v[148:151], v[120:123], a[104:107], v[148:151]
    v_mfma_f32_16x16x32_bf16 v[152:155], v[120:123], a[160:163], v[152:155]
    v_mfma_f32_16x16x32_bf16 v[156:159], v[120:123], a[216:219], v[156:159]
    s_add_u32 s36, s37, 12288
    buffer_load_dwordx4 v[64:67], v1, s[8:11], s36 offen offset:0 sc1
    s_add_u32 s36, s37, 24576
    buffer_load_dwordx4 v[120:123], v1, s[8:11], s36 offen offset:2048 sc1
    s_waitcnt vmcnt(30)
    v_mfma_f32_16x16x32_bf16 v[128:131], v[68:71], a[52:55], v[128:131]
    v_mfma_f32_16x16x32_bf16 v[132:135], v[68:71], a[108:111], v[132:135]
    v_mfma_f32_16x16x32_bf16 v[136:139], v[68:71], a[164:167], v[136:139]
    v_mfma_f32_16x16x32_bf16 v[140:143], v[68:71], a[220:223], v[140:143]
    v_mfma_f32_16x16x32_bf16 v[144:147], v[124:127], a[52:55], v[144:147]
    v_mfma_f32_16x16x32_bf16 v[148:151], v[124:127], a[108:111], v[148:151]
    v_mfma_f32_16x16x32_bf16 v[152:155], v[124:127], a[164:167], v[152:155]
    v_mfma_f32_16x16x32_bf16 v[156:159], v[124:127], a[220:223], v[156:159]
    s_add_u32 s36, s37, 12288
    buffer_load_dwordx4 v[68:71], v1, s[8:11], s36 offen offset:1024 sc1
    s_add_u32 s36, s37, 24576
    buffer_load_dwordx4 v[124:127], v1, s[8:11], s36 offen offset:3072 sc1
    v_cvt_pk_bf16_f32 v160, v128, v129
    v_cvt_pk_bf16_f32 v161, v130, v131
    v_cvt_pk_bf16_f32 v162, v144, v145
    v_cvt_pk_bf16_f32 v163, v146, v147
    v_cvt_pk_bf16_f32 v164, v132, v133
    v_cvt_pk_bf16_f32 v165, v134, v135
    v_cvt_pk_bf16_f32 v166, v148, v149
    v_cvt_pk_bf16_f32 v167, v150, v151
    v_cvt_pk_bf16_f32 v168, v136, v137
    v_cvt_pk_bf16_f32 v169, v138, v139
    v_cvt_pk_bf16_f32 v170, v152, v153
    v_cvt_pk_bf16_f32 v171, v154, v155
    v_cvt_pk_bf16_f32 v172, v140, v141
    v_cvt_pk_bf16_f32 v173, v142, v143
    v_cvt_pk_bf16_f32 v174, v156, v157
    v_cvt_pk_bf16_f32 v175, v158, v159
    buffer_store_dwordx4 v[160:163], v1, s[8:11], s38 offen offset:0 sc1
    buffer_store_dwordx4 v[164:167], v1, s[8:11], s38 offen offset:1024 sc1
    buffer_store_dwordx4 v[168:171], v1, s[8:11], s38 offen offset:2048 sc1
    buffer_store_dwordx4 v[172:175], v1, s[8:11], s38 offen offset:3072 sc1
    s_add_u32 s38, s38, 3670016
    s_cmp_eq_u32 s40, 1
    s_cbranch_scc1 Lgq_68
    s_cmp_eq_u32 s40, 0
    s_cbranch_scc0 Lg0_69
    s_waitcnt vmcnt(0)
    s_mov_b32 s41, 0
    s_branch Lg0_69_f
Lg0_69:
    s_waitcnt vmcnt(32)
    s_sub_u32 s41, s40, 1
Lg0_69_f:
    s_barrier
    s_cmp_eq_u32 s3, 0
    s_cbranch_scc0 Lgq_68
    s_lshl_b32 s41, s41, 10
    s_lshl_b32 s42, s72, 2
    s_add_u32 s41, s41, s42
    s_add_u32 s41, s41, 57344
    v_mov_b32 v6, 0
    v_mov_b32 v7, 1
    s_mov_b64 exec, 1
    buffer_store_dword v7, v6, s[8:11], s41 offen sc1
    s_mov_b64 exec, -1
Lgq_68:
    s_add_u32 s40, s40, 1
    s_cmp_lt_u32 s40, 8
    s_cbranch_scc1 Lgs_67
    s_lshl_b32 s77, s72, 2
    s_add_u32 s77, s77, 64512
    s_waitcnt vmcnt(0)
    s_barrier
    s_cmp_eq_u32 s3, 0
    s_cbranch_scc0 Lsf_70
    v_mov_b32 v6, 0
    v_mov_b32 v7, 1
    s_mov_b64 exec, 1
    buffer_store_dword v7, v6, s[8:11], s77 offen sc1
    s_mov_b64 exec, -1
Lsf_70:
    s_mov_b32 s37, s33
    s_add_u32 s36, s37, 0
    buffer_load_dwordx4 v[16:19], v1, s[8:11], s36 offen offset:0 sc1
    s_add_u32 s36, s37, 12288
    buffer_load_dwordx4 v[72:75], v1, s[8:11], s36 offen offset:2048 sc1
    s_add_u32 s36, s37, 0
    buffer_load_dwordx4 v[20:23], v1, s[8:11], s36 offen offset:1024 sc1
    s_add_u32 s36, s37, 12288
    buffer_load_dwordx4 v[76:79], v1, s[8:11], s36 offen offset:3072 sc1
    s_add_u32 s36, s37, 0
    buffer_load_dwordx4 v[24:27], v1, s[8:11], s36 offen offset:2048 sc1
    s_add_u32 s36, s37, 16384
    buffer_load_dwordx4 v[80:83], v1, s[8:11], s36 offen offset:0 sc1
    s_add_u32 s36, s37, 0
    buffer_load_dwordx4 v[28:31], v1, s[8:11], s36 offen offset:3072 sc1
    s_add_u32 s36, s37, 16384
    buffer_load_dwordx4 v[84:87], v1, s[8:11], s36 offen offset:1024 sc1
    s_add_u32 s36, s37, 4096
    buffer_load_dwordx4 v[32:35], v1, s[8:11], s36 offen offset:0 sc1
    s_add_u32 s36, s37, 16384
    buffer_load_dwordx4 v[88:91], v1, s[8:11], s36 offen offset:2048 sc1
    s_add_u32 s36, s37, 4096
    buffer_load_dwordx4 v[36:39], v1, s[8:11], s36 offen offset:1024 sc1
    s_add_u32 s36, s37, 16384
    buffer_load_dwordx4 v[92:95], v1, s[8:11], s36 offen offset:3072 sc1
    s_add_u32 s36, s37, 4096
    buffer_load_dwordx4 v[40:43], v1, s[8:11], s36 offen offset:2048 sc1
    s_add_u32 s36, s37, 20480
    buffer_load_dwordx4 v[96:99], v1, s[8:11], s36 offen offset:0 sc1
    s_add_u32 s36, s37, 4096
    buffer_load_dwordx4 v[44:47], v1, s[8:11], s36 offen offset:3072 sc1
    s_add_u32 s36, s37, 20480
    buffer_load_dwordx4 v[100:103], v1, s[8:11], s36 offen offset:1024 sc1
    s_add_u32 s36, s37, 8192
    buffer_load_dwordx4 v[48:51], v1, s[8:11], s36 offen offset:0 sc1
    s_add_u32 s36, s37, 20480
    buffer_load_dwordx4 v[104:107], v1, s[8:11], s36 offen offset:2048 sc1
    s_add_u32 s36, s37, 8192
    buffer_load_dwordx4 v[52:55], v1, s[8:11], s36 offen offset:1024 sc1
    s_add_u32 s36, s37, 20480
    buffer_load_dwordx4 v[108:111], v1, s[8:11], s36 offen offset:3072 sc1
    s_add_u32 s36, s37, 8192
    buffer_load_dwordx4 v[56:59], v1, s[8:11], s36 offen offset:2048 sc1
    s_add_u32 s36, s37, 24576
    buffer_load_dwordx4 v[112:115], v1, s[8:11], s36 offen offset:0 sc1
    s_add_u32 s36, s37, 8192
    buffer_load_dwordx4 v[60:63], v1, s[8:11], s36 offen offset:3072 sc1
    s_add_u32 s36, s37, 24576
    buffer_load_dwordx4 v[116:119], v1, s[8:11], s36 offen offset:1024 sc1
    s_add_u32 s36, s37, 12288
    buffer_load_dwordx4 v[64:67], v1, s[8:11], s36 offen offset:0 sc1
    s_add_u32 s36, s37, 24576
    buffer_load_dwordx4 v[120:123], v1, s[8:11], s36 offen offset:2048 sc1
    s_add_u32 s36, s37, 12288
    buffer_load_dwordx4 v[68:71], v1, s[8:11], s36 offen offset:1024 sc1
    s_add_u32 s36, s37, 24576
    buffer_load_dwordx4 v[124:127], v1, s[8:11], s36 offen offset:3072 sc1
    s_cmp_eq_u32 s3, 0
    s_cbranch_scc0 Lwn_71_s
    v_min_u32 v6, 15, v0
    v_mul_u32_u24 v6, 16, v6
    s_mov_b32 s77, 0
Lwn_71:
    buffer_load_dword v7, v6, s[8:11], s77 offen sc1
    s_waitcnt vmcnt(0)
    v_cmp_gt_u32 vcc, 7, v7
    s_cbranch_vccz Lwn_71_s
    s_sleep 2
    s_sub_u32 s76, s76, 1
    s_cbranch_scc0 Lwn_71
    s_branch L_exit
Lwn_71_s:
    s_barrier
    s_add_u32 s35, s34, 5242880
    s_add_u32 s36, s35, 0
    buffer_load_dwordx4 a[0:3], v1, s[8:11], s36 offen offset:0 sc1
    buffer_load_dwordx4 a[4:7], v1, s[8:11], s36 offen offset:1024 sc1
    buffer_load_dwordx4 a[8:11], v1, s[8:11], s36 offen offset:2048 sc1
    buffer_load_dwordx4 a[12:15], v1, s[8:11], s36 offen offset:3072 sc1
    s_add_u32 s36, s35, 4096
    buffer_load_dwordx4 a[16:19], v1, s[8:11], s36 offen offset:0 sc1
    buffer_load_dwordx4 a[20:23], v1, s[8:11], s36 offen offset:1024 sc1
    buffer_load_dwordx4 a[24:27], v1, s[8:11], s36 offen offset:2048 sc1
    buffer_load_dwordx4 a[28:31], v1, s[8:11], s36 offen offset:3072 sc1
    s_add_u32 s36, s35, 8192
    buffer_load_dwordx4 a[32:35], v1, s[8:11], s36 offen offset:0 sc1
    buffer_load_dwordx4 a[36:39], v1, s[8:11], s36 offen offset:1024 sc1
    buffer_load_dwordx4 a[40:43], v1, s[8:11], s36 offen offset:2048 sc1
    buffer_load_dwordx4 a[44:47], v1, s[8:11], s36 offen offset:3072 sc1
    s_add_u32 s36, s35, 12288
    buffer_load_dwordx4 a[48:51], v1, s[8:11], s36 offen offset:0 sc1
    buffer_load_dwordx4 a[52:55], v1, s[8:11], s36 offen offset:1024 sc1
    buffer_load_dwordx4 a[56:59], v1, s[8:11], s36 offen offset:2048 sc1
    buffer_load_dwordx4 a[60:63], v1, s[8:11], s36 offen offset:3072 sc1
    s_add_u32 s36, s35, 16384
    buffer_load_dwordx4 a[64:67], v1, s[8:11], s36 offen offset:0 sc1
    buffer_load_dwordx4 a[68:71], v1, s[8:11], s36 offen offset:1024 sc1
    buffer_load_dwordx4 a[72:75], v1, s[8:11], s36 offen offset:2048 sc1
    buffer_load_dwordx4 a[76:79], v1, s[8:11], s36 offen offset:3072 sc1
    s_add_u32 s36, s35, 20480
    buffer_load_dwordx4 a[80:83], v1, s[8:11], s36 offen offset:0 sc1
    buffer_load_dwordx4 a[84:87], v1, s[8:11], s36 offen offset:1024 sc1
    buffer_load_dwordx4 a[88:91], v1, s[8:11], s36 offen offset:2048 sc1
    buffer_load_dwordx4 a[92:95], v1, s[8:11], s36 offen offset:3072 sc1
    s_add_u32 s36, s35, 24576
    buffer_load_dwordx4 a[96:99], v1, s[8:11], s36 offen offset:0 sc1
    buffer_load_dwordx4 a[100:103], v1, s[8:11], s36 offen offset:1024 sc1
    buffer_load_dwordx4 a[104:107], v1, s[8:11], s36 offen offset:2048 sc1
    buffer_load_dwordx4 a[108:111], v1, s[8:11], s36 offen offset:3072 sc1
    s_add_u32 s36, s35, 28672
    buffer_load_dwordx4 a[112:115], v1, s[8:11], s36 offen offset:0 sc1
    buffer_load_dwordx4 a[116:119], v1, s[8:11], s36 offen offset:1024 sc1
    buffer_load_dwordx4 a[120:123], v1, s[8:11], s36 offen offset:2048 sc1
    buffer_load_dwordx4 a[124:127], v1, s[8:11], s36 offen offset:3072 sc1
    s_add_u32 s36, s35, 32768
    buffer_load_dwordx4 a[128:131], v1, s[8:11], s36 offen offset:0 sc1
    buffer_load_dwordx4 a[132:135], v1, s[8:11], s36 offen offset:1024 sc1
    buffer_load_dwordx4 a[136:139], v1, s[8:11], s36 offen offset:2048 sc1
    buffer_load_dwordx4 a[140:143], v1, s[8:11], s36 offen offset:3072 sc1
    s_add_u32 s36, s35, 36864
    buffer_load_dwordx4 a[144:147], v1, s[8:11], s36 offen offset:0 sc1
    buffer_load_dwordx4 a[148:151], v1, s[8:11], s36 offen offset:1024 sc1
    buffer_load_dwordx4 a[152:155], v1, s[8:11], s36 offen offset:2048 sc1
    buffer_load_dwordx4 a[156:159], v1, s[8:11], s36 offen offset:3072 sc1
    s_add_u32 s36, s35, 40960
    buffer_load_dwordx4 a[160:163], v1, s[8:11], s36 offen offset:0 sc1
    buffer_load_dwordx4 a[164:167], v1, s[8:11], s36 offen offset:1024 sc1
    buffer_load_dwordx4 a[168:171], v1, s[8:11], s36 offen offset:2048 sc1
    buffer_load_dwordx4 a[172:175], v1, s[8:11], s36 offen offset:3072 sc1
    s_add_u32 s36, s35, 45056
    buffer_load_dwordx4 a[176:179], v1, s[8:11], s36 offen offset:0 sc1
    buffer_load_dwordx4 a[180:183], v1, s[8:11], s36 offen offset:1024 sc1
    buffer_load_dwordx4 a[184:187], v1, s[8:11], s36 offen offset:2048 sc1
    buffer_load_dwordx4 a[188:191], v1, s[8:11], s36 offen offset:3072 sc1
    s_add_u32 s36, s35, 49152
    buffer_load_dwordx4 a[192:195], v1, s[8:11], s36 offen offset:0 sc1
    buffer_load_dwordx4 a[196:199], v1, s[8:11], s36 offen offset:1024 sc1
    buffer_load_dwordx4 a[200:203], v1, s[8:11], s36 offen offset:2048 sc1
    buffer_load_dwordx4 a[204:207], v1, s[8:11], s36 offen offset:3072 sc1
    s_add_u32 s36, s35, 53248
    buffer_load_dwordx4 a[208:211], v1, s[8:11], s36 offen offset:0 sc1
    buffer_load_dwordx4 a[212:215], v1, s[8:11], s36 offen offset:1024 sc1
    buffer_load_dwordx4 a[216:219], v1, s[8:11], s36 offen offset:2048 sc1
    buffer_load_dwordx4 a[220:223], v1, s[8:11], s36 offen offset:3072 sc1
    s_mul_i32 s38, s32, 458752
    s_lshl_b32 s39, s30, 11
    s_add_u32 s38, s38, s39
    s_add_u32 s38, s38, 67108864
    s_mov_b32 s40, 0
    s_waitcnt vmcnt(0)
Lgs_72:
    s_add_u32 s37, s37, 229376
    s_waitcnt vmcnt(30)
    v_mfma_f32_16x16x32_bf16 v[128:131], a[0:3], v[16:19], 0
    v_mfma_f32_16x16x32_bf16 v[132:135], a[56:59], v[16:19], 0
    v_mfma_f32_16x16x32_bf16 v[136:139], a[112:115], v[16:19], 0
    v_mfma_f32_16x16x32_bf16 v[140:143], a[168:171], v[16:19], 0
    v_mfma_f32_16x16x32_bf16 v[144:147], a[0:3], v[72:75], 0
    v_mfma_f32_16x16x32_bf16 v[148:151], a[56:59], v[72:75], 0
    v_mfma_f32_16x16x32_bf16 v[152:155], a[112:115], v[72:75], 0
    v_mfma_f32_16x16x32_bf16 v[156:159], a[168:171], v[72:75], 0
    s_add_u32 s36, s37, 0
    buffer_load_dwordx4 v[16:19], v1, s[8:11], s36 offen offset:0 sc1
    s_add_u32 s36, s37, 12288
    buffer_load_dwordx4 v[72:75], v1, s[8:11], s36 offen offset:2048 sc1
    s_waitcnt vmcnt(30)
    v_mfma_f32_16x16x32_bf16 v[128:131], a[4:7], v[20:23], v[128:131]
    v_mfma_f32_16x16x32_bf16 v[132:135], a[60:63], v[20:23], v[132:135]
    v_mfma_f32_16x16x32_bf16 v[136:139], a[116:119], v[20:23], v[136:139]
    v_mfma_f32_16x16x32_bf16 v[140:143], a[172:175], v[20:23], v[140:143]
    v_mfma_f32_16x16x32_bf16 v[144:147], a[4:7], v[76:79], v[144:147]
    v_mfma_f32_16x16x32_bf16 v[148:151], a[60:63], v[76:79], v[148:151]
    v_mfma_f32_16x16x32_bf16 v[152:155], a[116:119], v[76:79], v[152:155]
    v_mfma_f32_16x16x32_bf16 v[156:159], a[172:175], v[76:79], v[156:159]
    s_add_u32 s36, s37, 0
    buffer_load_dwordx4 v[20:23], v1, s[8:11], s36 offen offset:1024 sc1
    s_add_u32 s36, s37, 12288
    buffer_load_dwordx4 v[76:79], v1, s[8:11], s36 offen offset:3072 sc1
    s_waitcnt vmcnt(30)
    v_mfma_f32_16x16x32_bf16 v[128:131], a[8:11], v[24:27], v[128:131]
    v_mfma_f32_16x16x32_bf16 v[132:135], a[64:67], v[24:27], v[132:135]
    v_mfma_f32_16x16x32_bf16 v[136:139], a[120:123], v[24:27], v[136:139]
    v_mfma_f32_16x16x32_bf16 v[140:143], a[176:179], v[24:27], v[140:143]
    v_mfma_f32_16x16x32_bf16 v[144:147], a[8:11], v[80:83], v[144:147]
    v_mfma_f32_16x16x32_bf16 v[148:151], a[64:67], v[80:83], v[148:151]
    v_mfma_f32_16x16x32_bf16 v[152:155], a[120:123], v[80:83], v[152:155]
    v_mfma_f32_16x16x32_bf16 v[156:159], a[176:179], v[80:83], v[156:159]
    s_add_u32 s36, s37, 0
    buffer_load_dwordx4 v[24:27], v1, s[8:11], s36 offen offset:2048 sc1
    s_add_u32 s36, s37, 16384
    buffer_load_dwordx4 v[80:83], v1, s[8:11], s36 offen offset:0 sc1
    s_waitcnt vmcnt(30)
    v_mfma_f32_16x16x32_bf16 v[128:131], a[12:15], v[28:31], v[128:131]
    v_mfma_f32_16x16x32_bf16 v[132:135], a[68:71], v[28:31], v[132:135]
    v_mfma_f32_16x16x32_bf16 v[136:139], a[124:127], v[28:31], v[136:139]
    v_mfma_f32_16x16x32_bf16 v[140:143], a[180:183], v[28:31], v[140:143]
    v_mfma_f32_16x16x32_bf16 v[144:147], a[12:15], v[84:87], v[144:147]
    v_mfma_f32_16x16x32_bf16 v[148:151], a[68:71], v[84:87], v[148:151]
    v_mfma_f32_16x16x32_bf16 v[152:155], a[124:127], v[84:87], v[152:155]
    v_mfma_f32_16x16x32_bf16 v[156:159], a[180:183], v[84:87], v[156:159]
    s_add_u32 s36, s37, 0
    buffer_load_dwordx4 v[28:31], v1, s[8:11], s36 offen offset:3072 sc1
    s_add_u32 s36, s37, 16384
    buffer_load_dwordx4 v[84:87], v1, s[8:11], s36 offen offset:1024 sc1
    s_waitcnt vmcnt(30)
    v_mfma_f32_16x16x32_bf16 v[128:131], a[16:19], v[32:35], v[128:131]
    v_mfma_f32_16x16x32_bf16 v[132:135], a[72:75], v[32:35], v[132:135]
    v_mfma_f32_16x16x32_bf16 v[136:139], a[128:131], v[32:35], v[136:139]
    v_mfma_f32_16x16x32_bf16 v[140:143], a[184:187], v[32:35], v[140:143]
    v_mfma_f32_16x16x32_bf16 v[144:147], a[16:19], v[88:91], v[144:147]
    v_mfma_f32_16x16x32_bf16 v[148:151], a[72:75], v[88:91], v[148:151]
    v_mfma_f32_16x16x32_bf16 v[152:155], a[128:131], v[88:91], v[152:155]
    v_mfma_f32_16x16x32_bf16 v[156:159], a[184:187], v[88:91], v[156:159]
    s_add_u32 s36, s37, 4096
    buffer_load_dwordx4 v[32:35], v1, s[8:11], s36 offen offset:0 sc1
    s_add_u32 s36, s37, 16384
    buffer_load_dwordx4 v[88:91], v1, s[8:11], s36 offen offset:2048 sc1
    s_waitcnt vmcnt(30)
    v_mfma_f32_16x16x32_bf16 v[128:131], a[20:23], v[36:39], v[128:131]
    v_mfma_f32_16x16x32_bf16 v[132:135], a[76:79], v[36:39], v[132:135]
    v_mfma_f32_16x16x32_bf16 v[136:139], a[132:135], v[36:39], v[136:139]
    v_mfma_f32_16x16x32_bf16 v[140:143], a[188:191], v[36:39], v[140:143]
    v_mfma_f32_16x16x32_bf16 v[144:147], a[20:23], v[92:95], v[144:147]
    v_mfma_f32_16x16x32_bf16 v[148:151], a[76:79], v[92:95], v[148:151]
    v_mfma_f32_16x16x32_bf16 v[152:155], a[132:135], v[92:95], v[152:155]
    v_mfma_f32_16x16x32_bf16 v[156:159], a[188:191], v[92:95], v[156:159]
    s_add_u32 s36, s37, 4096
    buffer_load_dwordx4 v[36:39], v1, s[8:11], s36 offen offset:1024 sc1
    s_add_u32 s36, s37, 16384
    buffer_load_dwordx4 v[92:95], v1, s[8:11], s36 offen offset:3072 sc1
    s_waitcnt vmcnt(30)
    v_mfma_f32_16x16x32_bf16 v[128:131], a[24:27], v[40:43], v[128:131]
    v_mfma_f32_16x16x32_bf16 v[132:135], a[80:83], v[40:43], v[132:135]
    v_mfma_f32_16x16x32_bf16 v[136:139], a[136:139], v[40:43], v[136:139]
    v_mfma_f32_16x16x32_bf16 v[140:143], a[192:195], v[40:43], v[140:143]
    v_mfma_f32_16x16x32_bf16 v[144:147], a[24:27], v[96:99], v[144:147]
    v_mfma_f32_16x16x32_bf16 v[148:151], a[80:83], v[96:99], v[148:151]
    v_mfma_f32_16x16x32_bf16 v[152:155], a[136:139], v[96:99], v[152:155]
    v_mfma_f32_16x16x32_bf16 v[156:159], a[192:195], v[96:99], v[156:159]
    s_add_u32 s36, s37, 4096
    buffer_load_dwordx4 v[40:43], v1, s[8:11], s36 offen offset:2048 sc1
    s_add_u32 s36, s37, 20480
    buffer_load_dwordx4 v[96:99], v1, s[8:11], s36 offen offset:0 sc1
    s_waitcnt vmcnt(30)
    v_mfma_f32_16x16x32_bf16 v[128:131], a[28:31], v[44:47], v[128:131]
    v_mfma_f32_16x16x32_bf16 v[132:135], a[84:87], v[44:47], v[132:135]
    v_mfma_f32_16x16x32_bf16 v[136:139], a[140:143], v[44:47], v[136:139]
    v_mfma_f32_16x16x32_bf16 v[140:143], a[196:199], v[44:47], v[140:143]
    v_mfma_f32_16x16x32_bf16 v[144:147], a[28:31], v[100:103], v[144:147]
    v_mfma_f32_16x16x32_bf16 v[148:151], a[84:87], v[100:103], v[148:151]
    v_mfma_f32_16x16x32_bf16 v[152:155], a[140:143], v[100:103], v[152:155]
    v_mfma_f32_16x16x32_bf16 v[156:159], a[196:199], v[100:103], v[156:159]
    s_add_u32 s36, s37, 4096
    buffer_load_dwordx4 v[44:47], v1, s[8:11], s36 offen offset:3072 sc1
    s_add_u32 s36, s37, 20480
    buffer_load_dwordx4 v[100:103], v1, s[8:11], s36 offen offset:1024 sc1
    s_waitcnt vmcnt(30)
    v_mfma_f32_16x16x32_bf16 v[128:131], a[32:35], v[48:51], v[128:131]
    v_mfma_f32_16x16x32_bf16 v[132:135], a[88:91], v[48:51], v[132:135]
    v_mfma_f32_16x16x32_bf16 v[136:139], a[144:147], v[48:51], v[136:139]
    v_mfma_f32_16x16x32_bf16 v[140:143], a[200:203], v[48:51], v[140:143]
    v_mfma_f32_16x16x32_bf16 v[144:147], a[32:35], v[104:107], v[144:147]
    v_mfma_f32_16x16x32_bf16 v[148:151], a[88:91], v[104:107], v[148:151]
    v_mfma_f32_16x16x32_bf16 v[152:155], a[144:147], v[104:107], v[152:155]
    v_mfma_f32_16x16x32_bf16 v[156:159], a[200:203], v[104:107], v[156:159]
    s_add_u32 s36, s37, 8192
    buffer_load_dwordx4 v[48:51], v1, s[8:11], s36 offen offset:0 sc1
    s_add_u32 s36, s37, 20480
    buffer_load_dwordx4 v[104:107], v1, s[8:11], s36 offen offset:2048 sc1
    s_waitcnt vmcnt(30)
    v_mfma_f32_16x16x32_bf16 v[128:131], a[36:39], v[52:55], v[128:131]
    v_mfma_f32_16x16x32_bf16 v[132:135], a[92:95], v[52:55], v[132:135]
    v_mfma_f32_16x16x32_bf16 v[136:139], a[148:151], v[52:55], v[136:139]
    v_mfma_f32_16x16x32_bf16 v[140:143], a[204:207], v[52:55], v[140:143]
    v_mfma_f32_16x16x32_bf16 v[144:147], a[36:39], v[108:111], v[144:147]
    v_mfma_f32_16x16x32_bf16 v[148:151], a[92:95], v[108:111], v[148:151]
    v_mfma_f32_16x16x32_bf16 v[152:155], a[148:151], v[108:111], v[152:155]
    v_mfma_f32_16x16x32_bf16 v[156:159], a[204:207], v[108:111], v[156:159]
    s_add_u32 s36, s37, 8192
    buffer_load_dwordx4 v[52:55], v1, s[8:11], s36 offen offset:1024 sc1
    s_add_u32 s36, s37, 20480
    buffer_load_dwordx4 v[108:111], v1, s[8:11], s36 offen offset:3072 sc1
    s_waitcnt vmcnt(30)
    v_mfma_f32_16x16x32_bf16 v[128:131], a[40:43], v[56:59], v[128:131]
    v_mfma_f32_16x16x32_bf16 v[132:135], a[96:99], v[56:59], v[132:135]
    v_mfma_f32_16x16x32_bf16 v[136:139], a[152:155], v[56:59], v[136:139]
    v_mfma_f32_16x16x32_bf16 v[140:143], a[208:211], v[56:59], v[140:143]
    v_mfma_f32_16x16x32_bf16 v[144:147], a[40:43], v[112:115], v[144:147]
    v_mfma_f32_16x16x32_bf16 v[148:151], a[96:99], v[112:115], v[148:151]
    v_mfma_f32_16x16x32_bf16 v[152:155], a[152:155], v[112:115], v[152:155]
    v_mfma_f32_16x16x32_bf16 v[156:159], a[208:211], v[112:115], v[156:159]
    s_add_u32 s36, s37, 8192
    buffer_load_dwordx4 v[56:59], v1, s[8:11], s36 offen offset:2048 sc1
    s_add_u32 s36, s37, 24576
    buffer_load_dwordx4 v[112:115], v1, s[8:11], s36 offen offset:0 sc1
    s_waitcnt vmcnt(30)
    v_mfma_f32_16x16x32_bf16 v[128:131], a[44:47], v[60:63], v[128:131]
    v_mfma_f32_16x16x32_bf16 v[132:135], a[100:103], v[60:63], v[132:135]
    v_mfma_f32_16x16x32_bf16 v[136:139], a[156:159], v[60:63], v[136:139]
    v_mfma_f32_16x16x32_bf16 v[140:143], a[212:215], v[60:63], v[140:143]
    v_mfma_f32_16x16x32_bf16 v[144:147], a[44:47], v[116:119], v[144:147]
    v_mfma_f32_16x16x32_bf16 v[148:151], a[100:103], v[116:119], v[148:151]
    v_mfma_f32_16x16x32_bf16 v[152:155], a[156:159], v[116:119], v[152:155]
    v_mfma_f32_16x16x32_bf16 v[156:159], a[212:215], v[116:119], v[156:159]
    s_add_u32 s36, s37, 8192
    buffer_load_dwordx4 v[60:63], v1, s[8:11], s36 offen offset:3072 sc1
    s_add_u32 s36, s37, 24576
    buffer_load_dwordx4 v[116:119], v1, s[8:11], s36 offen offset:1024 sc1
    s_waitcnt vmcnt(30)
    v_mfma_f32_16x16x32_bf16 v[128:131], a[48:51], v[64:67], v[128:131]
    v_mfma_f32_16x16x32_bf16 v[132:135], a[104:107], v[64:67], v[132:135]
    v_mfma_f32_16x16x32_bf16 v[136:139], a[160:163], v[64:67], v[136:139]
    v_mfma_f32_16x16x32_bf16 v[140:143], a[216:219], v[64:67], v[140:143]
    v_mfma_f32_16x16x32_bf16 v[144:147], a[48:51], v[120:123], v[144:147]
    v_mfma_f32_16x16x32_bf16 v[148:151], a[104:107], v[120:123], v[148:151]
    v_mfma_f32_16x16x32_bf16 v[152:155], a[160:163], v[120:123], v[152:155]
    v_mfma_f32_16x16x32_bf16 v[156:159], a[216:219], v[120:123], v[156:159]
    s_add_u32 s36, s37, 12288
    buffer_load_dwordx4 v[64:67], v1, s[8:11], s36 offen offset:0 sc1
    s_add_u32 s36, s37, 24576
    buffer_load_dwordx4 v[120:123], v1, s[8:11], s36 offen offset:2048 sc1
    s_waitcnt vmcnt(30)
    v_mfma_f32_16x16x32_bf16 v[128:131], a[52:55], v[68:71], v[128:131]
    v_mfma_f32_16x16x32_bf16 v[132:135], a[108:111], v[68:71], v[132:135]
    v_mfma_f32_16x16x32_bf16 v[136:139], a[164:167], v[68:71], v[136:139]
    v_mfma_f32_16x16x32_bf16 v[140:143], a[220:223], v[68:71], v[140:143]
    v_mfma_f32_16x16x32_bf16 v[144:147], a[52:55], v[124:127], v[144:147]
    v_mfma_f32_16x16x32_bf16 v[148:151], a[108:111], v[124:127], v[148:151]
    v_mfma_f32_16x16x32_bf16 v[152:155], a[164:167], v[124:127], v[152:155]
    v_mfma_f32_16x16x32_bf16 v[156:159], a[220:223], v[124:127], v[156:159]
    s_add_u32 s36, s37, 12288
    buffer_load_dwordx4 v[68:71], v1, s[8:11], s36 offen offset:1024 sc1
    s_add_u32 s36, s37, 24576
    buffer_load_dwordx4 v[124:127], v1, s[8:11], s36 offen offset:3072 sc1
    v_cvt_pk_bf16_f32 v160, v128, v129
    v_cvt_pk_bf16_f32 v161, v130, v131
    v_cvt_pk_bf16_f32 v162, v132, v133
    v_cvt_pk_bf16_f32 v163, v134, v135
    v_cvt_pk_bf16_f32 v164, v136, v137
    v_cvt_pk_bf16_f32 v165, v138, v139
    v_cvt_pk_bf16_f32 v166, v140, v141
    v_cvt_pk_bf16_f32 v167, v142, v143
    v_cvt_pk_bf16_f32 v168, v144, v145
    v_cvt_pk_bf16_f32 v169, v146, v147
    v_cvt_pk_bf16_f32 v170, v148, v149
    v_cvt_pk_bf16_f32 v171, v150, v151
    v_cvt_pk_bf16_f32 v172, v152, v153
    v_cvt_pk_bf16_f32 v173, v154, v155
    v_cvt_pk_bf16_f32 v174, v156, v157
    v_cvt_pk_bf16_f32 v175, v158, v159
    s_add_u32 s36, s38, 0
    buffer_store_dwordx4 v[160:163], v1, s[8:11], s36 offen offset:0 sc1
    buffer_store_dwordx4 v[164:167], v1, s[8:11], s36 offen offset:1024 sc1
    s_add_u32 s36, s38, 229376
    buffer_store_dwordx4 v[168:171], v1, s[8:11], s36 offen offset:0 sc1
    buffer_store_dwordx4 v[172:175], v1, s[8:11], s36 offen offset:1024 sc1
    s_add_u32 s38, s38, 3670016
    s_cmp_eq_u32 s40, 1
    s_cbranch_scc1 Lgq_73
    s_cmp_eq_u32 s40, 0
    s_cbranch_scc0 Lg0_74
    s_waitcnt vmcnt(0)
    s_mov_b32 s41, 0
    s_branch Lg0_74_f
Lg0_74:
    s_waitcnt vmcnt(32)
    s_sub_u32 s41, s40, 1
Lg0_74_f:
    s_barrier
    s_cmp_eq_u32 s3, 0
    s_cbranch_scc0 Lgq_73
    s_lshl_b32 s41, s41, 10
    s_lshl_b32 s42, s72, 2
    s_add_u32 s41, s41, s42
    s_add_u32 s41, s41, 65536
    v_mov_b32 v6, 0
    v_mov_b32 v7, 1
    s_mov_b64 exec, 1
    buffer_store_dword v7, v6, s[8:11], s41 offen sc1
    s_mov_b64 exec, -1
Lgq_73:
    s_add_u32 s40, s40, 1
    s_cmp_lt_u32 s40, 8
    s_cbranch_scc1 Lgs_72
    s_lshl_b32 s77, s72, 2
    s_add_u32 s77, s77, 72704
    s_waitcnt vmcnt(0)
    s_barrier
    s_cmp_eq_u32 s3, 0
    s_cbranch_scc0 Lsf_75
    v_mov_b32 v6, 0
    v_mov_b32 v7, 1
    s_mov_b64 exec, 1
    buffer_store_dword v7, v6, s[8:11], s77 offen sc1
    s_mov_b64 exec, -1
Lsf_75:
    s_load_dwordx2 s[56:57], s[0:1], 64
    s_load_dwordx2 s[60:61], s[0:1], 72
    s_load_dwordx2 s[64:65], s[0:1], 80
    s_mov_b32 s58, 1605632
    s_mov_b32 s59, 0x20000
    s_mov_b32 s62, 1605632
    s_mov_b32 s63, 0x20000
    s_mov_b32 s66, 1605632
    s_mov_b32 s67, 0x20000
    s_lshl_b32 s38, s72, 2
    s_add_u32 s38, s38, s3
    s_waitcnt lgkmcnt(0)
    v_and_b32 v6, 15, v0
    v_lshrrev_b32 v7, 4, v0
    v_lshlrev_b32 v3, 4, v0
    v_lshrrev_b32 v8, 1, v0
    v_and_b32 v9, 1, v0
    v_lshlrev_b32 v9, 4, v9
    v_mul_u32_u24 v10, 3584, v8
    v_add_u32 v10, v10, v9
    v_mul_u32_u24 v11, 896, v8
    v_add_u32 v11, v11, v9
    s_lshl_b32 s32, s3, 13
    v_add_u32 v4, s32, v3
    v_and_b32 v12, 3, v6
    v_lshrrev_b32 v13, 2, v6
    v_lshl_add_u32 v13, v7, 2, v13
    v_lshlrev_b32 v13, 5, v13
    v_lshl_add_u32 v13, v12, 3, v13
    v_add_u32 v5, s32, v13
    s_mov_b32 s39, s38
Lwt_76:
    s_cmp_ge_u32 s39, 4704
    s_cbranch_scc1 Lwte_79
    s_cmp_ge_u32 s39, 3136
    s_cbranch_scc1 Lwtd_77
    s_mul_hi_u32 s48, s39, 153391690
    s_mul_i32 s49, s48, 28
    s_sub_u32 s49, s39, s49
    s_cmp_ge_u32 s49, 14
    s_cselect_b32 s50, 14, 0
    s_sub_u32 s51, s49, s50
    s_mul_i32 s51, s51, 114688
    s_lshl_b32 s52, s48, 5
    s_add_u32 s51, s51, s52
    s_lshl_b32 s53, s39, 10
    s_add_u32 s53, s53, 25165824
    s_cbranch_scc0 Lwtg_78
Lwtg_78:
    s_cmp_ge_u32 s49, 14
    s_cbranch_scc1 Lwtu_80
    buffer_load_dwordx4 v[16:19], v10, s[56:59], s51 offen
    s_branch Lwtc_81
Lwtu_80:
    buffer_load_dwordx4 v[16:19], v10, s[60:63], s51 offen
    s_branch Lwtc_81
Lwtd_77:
    s_sub_u32 s48, s39, 3136
    s_mul_hi_u32 s49, s48, 76695845
    s_mul_i32 s50, s49, 56
    s_sub_u32 s50, s48, s50
    s_mul_i32 s51, s50, 28672
    s_lshl_b32 s52, s49, 5
    s_add_u32 s51, s51, s52
    s_lshl_b32 s53, s48, 10
    s_add_u32 s53, s53, 29360128
    buffer_load_dwordx4 v[16:19], v11, s[64:67], s51 offen
Lwtc_81:
    s_waitcnt vmcnt(0)
    ds_write_b128 v4, v[16:19]
    ds_read_b64_tr_b16 v[20:21], v5
    ds_read_b64_tr_b16 v[22:23], v5 offset:512
    s_waitcnt lgkmcnt(0)
    buffer_store_dwordx4 v[20:23], v3, s[8:11], s53 offen sc1
    s_add_u32 s39, s39, 896
    s_branch Lwt_76
Lwte_79:
    s_waitcnt vmcnt(0)
    s_mov_b32 s77, 3072
    s_waitcnt vmcnt(0)
    s_barrier
    s_cmp_eq_u32 s3, 0
    s_cbranch_scc0 Lsg_82
    v_mov_b32 v6, 0
    v_mov_b32 v7, 1
    s_mov_b64 exec, 1
    buffer_atomic_add v7, v6, s[8:11], s77 offen sc1
    s_mov_b64 exec, -1
Lsg_82:
    s_mov_b32 s73, 0
    s_mov_b32 s29, s72
    s_cmp_lt_u32 s29, 16
    s_cbranch_scc1 W_att1
    s_cmp_lt_u32 s29, 72
    s_cbranch_scc1 W_vg0
    s_cmp_lt_u32 s29, 100
    s_cbranch_scc1 W_att2
    s_cmp_lt_u32 s29, 156
    s_cbranch_scc1 W_ffn10
    s_cmp_lt_u32 s29, 212
    s_cbranch_scc1 W_ffn20
    s_branch L_exit
W_att1:
    s_lshr_b32 s30, s72, 2
    s_lshl_b32 s31, s73, 2
    s_add_u32 s30, s30, s31
    s_and_b32 s31, s72, 3
    s_lshr_b32 s77, s30, 3
    s_lshl_b32 s77, s77, 10
    s_add_u32 s77, s77, 65536
    s_cmp_eq_u32 s3, 0
    s_cbranch_scc0 Lwq_83_s
    v_min_u32 v6, 55, v0
    v_lshlrev_b32 v6, 4, v6
Lwq_83:
    buffer_load_dwordx4 v[8:11], v6, s[8:11], s77 offen sc1
    s_waitcnt vmcnt(0)
    v_min_u32 v8, v8, v9
    v_min3_u32 v8, v8, v10, v11
    v_cmp_eq_u32 vcc, 0, v8
    s_cbranch_vccz Lwq_83_s
    s_sleep 2
    s_sub_u32 s76, s76, 1
    s_cbranch_scc0 Lwq_83
    s_branch L_exit
Lwq_83_s:
    s_barrier
    v_lshlrev_b32 v1, 4, v0
    s_lshl_b32 s32, s31, 2
    s_add_u32 s32, s32, s3
    s_mul_i32 s33, s30, 28672
    s_mul_i32 s34, s3, 7168
    s_add_u32 s33, s33, s34
    s_add_u32 s33, s33, 1048576
    s_mov_b32 m0, s34
    s_nop 0
    buffer_load_dwordx4 v1, s[8:11], s33 offen offset:0 sc1 lds
    buffer_load_dwordx4 v1, s[8:11], s33 offen offset:1024 sc1 lds
    buffer_load_dwordx4 v1, s[8:11], s33 offen offset:2048 sc1 lds
    buffer_load_dwordx4 v1, s[8:11], s33 offen offset:3072 sc1 lds
    s_add_u32 s33, s33, 4096
    s_add_u32 m0, s34, 4096
    s_nop 0
    buffer_load_dwordx4 v1, s[8:11], s33 offen offset:0 sc1 lds
    buffer_load_dwordx4 v1, s[8:11], s33 offen offset:1024 sc1 lds
    buffer_load_dwordx4 v1, s[8:11], s33 offen offset:2048 sc1 lds
    s_lshl_b32 s35, s30, 1
    s_lshl_b32 s35, s35, 4
    s_add_u32 s35, s35, s32
    s_mul_i32 s35, s35, 14336
    s_add_u32 s35, s35, 67108864
    s_add_u32 s36, s35, 0
    buffer_load_dwordx4 a[0:3], v1, s[8:11], s36 offen offset:0 sc1
    buffer_load_dwordx4 a[4:7], v1, s[8:11], s36 offen offset:1024 sc1
    buffer_load_dwordx4 a[8:11], v1, s[8:11], s36 offen offset:2048 sc1
    buffer_load_dwordx4 a[12:15], v1, s[8:11], s36 offen offset:3072 sc1
    s_add_u32 s36, s35, 4096
    buffer_load_dwordx4 a[16:19], v1, s[8:11], s36 offen offset:0 sc1
    buffer_load_dwordx4 a[20:23], v1, s[8:11], s36 offen offset:1024 sc1
    buffer_load_dwordx4 a[24:27], v1, s[8:11], s36 offen offset:2048 sc1
    buffer_load_dwordx4 a[28:31], v1, s[8:11], s36 offen offset:3072 sc1
    s_add_u32 s36, s35, 8192
    buffer_load_dwordx4 a[32:35], v1, s[8:11], s36 offen offset:0 sc1
    buffer_load_dwordx4 a[36:39], v1, s[8:11], s36 offen offset:1024 sc1
    buffer_load_dwordx4 a[40:43], v1, s[8:11], s36 offen offset:2048 sc1
    buffer_load_dwordx4 a[44:47], v1, s[8:11], s36 offen offset:3072 sc1
    s_add_u32 s36, s35, 12288
    buffer_load_dwordx4 a[48:51], v1, s[8:11], s36 offen offset:0 sc1
    buffer_load_dwordx4 a[52:55], v1, s[8:11], s36 offen offset:1024 sc1
    s_add_u32 s36, s35, 229376
    buffer_load_dwordx4 a[56:59], v1, s[8:11], s36 offen offset:0 sc1
    buffer_load_dwordx4 a[60:63], v1, s[8:11], s36 offen offset:1024 sc1
    buffer_load_dwordx4 a[64:67], v1, s[8:11], s36 offen offset:2048 sc1
    buffer_load_dwordx4 a[68:71], v1, s[8:11], s36 offen offset:3072 sc1
    s_add_u32 s36, s35, 233472
    buffer_load_dwordx4 a[72:75], v1, s[8:11], s36 offen offset:0 sc1
    buffer_load_dwordx4 a[76:79], v1, s[8:11], s36 offen offset:1024 sc1
    buffer_load_dwordx4 a[80:83], v1, s[8:11], s36 offen offset:2048 sc1
    buffer_load_dwordx4 a[84:87], v1, s[8:11], s36 offen offset:3072 sc1
    s_add_u32 s36, s35, 237568
    buffer_load_dwordx4 a[88:91], v1, s[8:11], s36 offen offset:0 sc1
    buffer_load_dwordx4 a[92:95], v1, s[8:11], s36 offen offset:1024 sc1
    buffer_load_dwordx4 a[96:99], v1, s[8:11], s36 offen offset:2048 sc1
    buffer_load_dwordx4 a[100:103], v1, s[8:11], s36 offen offset:3072 sc1
    s_add_u32 s36, s35, 241664
    buffer_load_dwordx4 a[104:107], v1, s[8:11], s36 offen offset:0 sc1
    buffer_load_dwordx4 a[108:111], v1, s[8:11], s36 offen offset:1024 sc1
    s_lshl_b32 s77, s30, 6
    s_add_u32 s77, s77, 4096
    s_cmp_eq_u32 s3, 0
    s_cbranch_scc0 Lwf_84_s
    v_lshlrev_b32 v6, 2, v0
    v_min_u32 v6, 12, v6
Lwf_84:
    buffer_load_dword v7, v6, s[8:11], s77 offen sc1
    s_waitcnt vmcnt(0)
    v_cmp_eq_u32 vcc, 0, v7
    s_cbranch_vccz Lwf_84_s
    s_sleep 1
    s_sub_u32 s76, s76, 1
    s_cbranch_scc0 Lwf_84
    s_branch L_exit
Lwf_84_s:
    s_barrier
    s_lshl_b32 s34, s3, 2
    s_min_u32 s34, s34, 10
    s_lshl_b32 s34, s34, 10
    s_mul_i32 s33, s30, 14336
    s_add_u32 s33, s33, s34
    s_add_u32 s33, s33, 24117248
    s_add_u32 m0, s34, 28672
    s_nop 0
    buffer_load_dwordx4 v1, s[8:11], s33 offen offset:0 sc1 lds
    buffer_load_dwordx4 v1, s[8:11], s33 offen offset:1024 sc1 lds
    buffer_load_dwordx4 v1, s[8:11], s33 offen offset:2048 sc1 lds
    buffer_load_dwordx4 v1, s[8:11], s33 offen offset:3072 sc1 lds
    v_and_b32 v4, 15, v0
    v_lshrrev_b32 v5, 4, v0
    v_lshlrev_b32 v5, 2, v5
    v_add_u32 v6, 0, v5
    v_cmp_le_u32 s[60:61], v6, v4
    v_add_u32 v6, 1, v5
    v_cmp_le_u32 s[62:63], v6, v4
    v_add_u32 v6, 2, v5
    v_cmp_le_u32 s[64:65], v6, v4
    v_add_u32 v6, 3, v5
    v_cmp_le_u32 s[66:67], v6, v4
    v_cmp_gt_u32 s[68:69], 32, v0
    s_mov_b32 s70, 1035512379
    s_mov_b32 s71, 4048155338
    s_waitcnt vmcnt(0)
    s_barrier
    ds_read_b128 v[40:43], v1 offset:0
    ds_read_b128 v[44:47], v1 offset:14336
    ds_read_b128 v[48:51], v1 offset:28672
    ds_read_b128 v[52:55], v1 offset:1024
    ds_read_b128 v[56:59], v1 offset:15360
    ds_read_b128 v[60:63], v1 offset:29696
    ds_read_b128 v[64:67], v1 offset:2048
    ds_read_b128 v[68:71], v1 offset:16384
    ds_read_b128 v[72:75], v1 offset:30720
    s_waitcnt lgkmcnt(6)
    v_mfma_f32_16x16x32_bf16 v[16:19], v[40:43], a[0:3], 0
    v_mfma_f32_16x16x32_bf16 v[24:27], v[48:51], a[0:3], 0
    v_mfma_f32_16x16x32_bf16 v[28:31], v[40:43], a[56:59], 0
    v_mfma_f32_16x16x32_bf16 v[32:35], v[44:47], a[56:59], 0
    v_mfma_f32_16x16x32_bf16 v[36:39], v[48:51], a[56:59], 0
    ds_read_b128 v[40:43], v1 offset:3072
    ds_read_b128 v[44:47], v1 offset:17408
    ds_read_b128 v[48:51], v1 offset:31744
    s_waitcnt lgkmcnt(6)
    v_mfma_f32_16x16x32_bf16 v[16:19], v[52:55], a[4:7], v[16:19]
    v_mfma_f32_16x16x32_bf16 v[24:27], v[60:63], a[4:7], v[24:27]
    v_mfma_f32_16x16x32_bf16 v[28:31], v[52:55], a[60:63], v[28:31]
    v_mfma_f32_16x16x32_bf16 v[32:35], v[56:59], a[60:63], v[32:35]
    v_mfma_f32_16x16x32_bf16 v[36:39], v[60:63], a[60:63], v[36:39]
    ds_read_b128 v[52:55], v1 offset:4096
    ds_read_b128 v[56:59], v1 offset:18432
    ds_read_b128 v[60:63], v1 offset:32768
    s_waitcnt lgkmcnt(6)
    v_mfma_f32_16x16x32_bf16 v[16:19], v[64:67], a[8:11], v[16:19]
    v_mfma_f32_16x16x32_bf16 v[24:27], v[72:75], a[8:11], v[24:27]
    v_mfma_f32_16x16x32_bf16 v[28:31], v[64:67], a[64:67], v[28:31]
    v_mfma_f32_16x16x32_bf16 v[32:35], v[68:71], a[64:67], v[32:35]
    v_mfma_f32_16x16x32_bf16 v[36:39], v[72:75], a[64:67], v[36:39]
    ds_read_b128 v[64:67], v1 offset:5120
    ds_read_b128 v[68:71], v1 offset:19456
    ds_read_b128 v[72:75], v1 offset:33792
    s_waitcnt lgkmcnt(6)
    v_mfma_f32_16x16x32_bf16 v[16:19], v[40:43], a[12:15], v[16:19]
    v_mfma_f32_16x16x32_bf16 v[24:27], v[48:51], a[12:15], v[24:27]
    v_mfma_f32_16x16x32_bf16 v[28:31], v[40:43], a[68:71], v[28:31]
    v_mfma_f32_16x16x32_bf16 v[32:35], v[44:47], a[68:71], v[32:35]
    v_mfma_f32_16x16x32_bf16 v[36:39], v[48:51], a[68:71], v[36:39]
    ds_read_b128 v[40:43], v1 offset:6144
    ds_read_b128 v[44:47], v1 offset:20480
    ds_read_b128 v[48:51], v1 offset:34816
    s_waitcnt lgkmcnt(6)
    v_mfma_f32_16x16x32_bf16 v[16:19], v[52:55], a[16:19], v[16:19]
    v_mfma_f32_16x16x32_bf16 v[24:27], v[60:63], a[16:19], v[24:27]
    v_mfma_f32_16x16x32_bf16 v[28:31], v[52:55], a[72:75], v[28:31]
    v_mfma_f32_16x16x32_bf16 v[32:35], v[56:59], a[72:75], v[32:35]
    v_mfma_f32_16x16x32_bf16 v[36:39], v[60:63], a[72:75], v[36:39]
    ds_read_b128 v[52:55], v1 offset:7168
    ds_read_b128 v[56:59], v1 offset:21504
    ds_read_b128 v[60:63], v1 offset:35840
    s_waitcnt lgkmcnt(6)
    v_mfma_f32_16x16x32_bf16 v[16:19], v[64:67], a[20:23], v[16:19]
    v_mfma_f32_16x16x32_bf16 v[24:27], v[72:75], a[20:23], v[24:27]
    v_mfma_f32_16x16x32_bf16 v[28:31], v[64:67], a[76:79], v[28:31]
    v_mfma_f32_16x16x32_bf16 v[32:35], v[68:71], a[76:79], v[32:35]
    v_mfma_f32_16x16x32_bf16 v[36:39], v[72:75], a[76:79], v[36:39]
    ds_read_b128 v[64:67], v1 offset:8192
    ds_read_b128 v[68:71], v1 offset:22528
    ds_read_b128 v[72:75], v1 offset:36864
    s_waitcnt lgkmcnt(6)
    v_mfma_f32_16x16x32_bf16 v[16:19], v[40:43], a[24:27], v[16:19]
    v_mfma_f32_16x16x32_bf16 v[24:27], v[48:51], a[24:27], v[24:27]
    v_mfma_f32_16x16x32_bf16 v[28:31], v[40:43], a[80:83], v[28:31]
    v_mfma_f32_16x16x32_bf16 v[32:35], v[44:47], a[80:83], v[32:35]
    v_mfma_f32_16x16x32_bf16 v[36:39], v[48:51], a[80:83], v[36:39]
    ds_read_b128 v[40:43], v1 offset:9216
    ds_read_b128 v[44:47], v1 offset:23552
    ds_read_b128 v[48:51], v1 offset:37888
    s_waitcnt lgkmcnt(6)
    v_mfma_f32_16x16x32_bf16 v[16:19], v[52:55], a[28:31], v[16:19]
    v_mfma_f32_16x16x32_bf16 v[24:27], v[60:63], a[28:31], v[24:27]
    v_mfma_f32_16x16x32_bf16 v[28:31], v[52:55], a[84:87], v[28:31]
    v_mfma_f32_16x16x32_bf16 v[32:35], v[56:59], a[84:87], v[32:35]
    v_mfma_f32_16x16x32_bf16 v[36:39], v[60:63], a[84:87], v[36:39]
    ds_read_b128 v[52:55], v1 offset:10240
    ds_read_b128 v[56:59], v1 offset:24576
    ds_read_b128 v[60:63], v1 offset:38912
    s_waitcnt lgkmcnt(6)
    v_mfma_f32_16x16x32_bf16 v[16:19], v[64:67], a[32:35], v[16:19]
    v_mfma_f32_16x16x32_bf16 v[24:27], v[72:75], a[32:35], v[24:27]
    v_mfma_f32_16x16x32_bf16 v[28:31], v[64:67], a[88:91], v[28:31]
    v_mfma_f32_16x16x32_bf16 v[32:35], v[68:71], a[88:91], v[32:35]
    v_mfma_f32_16x16x32_bf16 v[36:39], v[72:75], a[88:91], v[36:39]
    ds_read_b128 v[64:67], v1 offset:11264
    ds_read_b128 v[68:71], v1 offset:25600
    ds_read_b128 v[72:75], v1 offset:39936
    s_waitcnt lgkmcnt(6)
    v_mfma_f32_16x16x32_bf16 v[16:19], v[40:43], a[36:39], v[16:19]
    v_mfma_f32_16x16x32_bf16 v[24:27], v[48:51], a[36:39], v[24:27]
    v_mfma_f32_16x16x32_bf16 v[28:31], v[40:43], a[92:95], v[28:31]
    v_mfma_f32_16x16x32_bf16 v[32:35], v[44:47], a[92:95], v[32:35]
    v_mfma_f32_16x16x32_bf16 v[36:39], v[48:51], a[92:95], v[36:39]
    ds_read_b128 v[40:43], v1 offset:12288
    ds_read_b128 v[44:47], v1 offset:26624
    ds_read_b128 v[48:51], v1 offset:40960
    s_waitcnt lgkmcnt(6)
    v_mfma_f32_16x16x32_bf16 v[16:19], v[52:55], a[40:43], v[16:19]
    v_mfma_f32_16x16x32_bf16 v[24:27], v[60:63], a[40:43], v[24:27]
    v_mfma_f32_16x16x32_bf16 v[28:31], v[52:55], a[96:99], v[28:31]
    v_mfma_f32_16x16x32_bf16 v[32:35], v[56:59], a[96:99], v[32:35]
    v_mfma_f32_16x16x32_bf16 v[36:39], v[60:63], a[96:99], v[36:39]
    ds_read_b128 v[52:55], v1 offset:13312
    ds_read_b128 v[56:59], v1 offset:27648
    ds_read_b128 v[60:63], v1 offset:41984
    s_waitcnt lgkmcnt(6)
    v_mfma_f32_16x16x32_bf16 v[16:19], v[64:67], a[44:47], v[16:19]
    v_mfma_f32_16x16x32_bf16 v[24:27], v[72:75], a[44:47], v[24:27]
    v_mfma_f32_16x16x32_bf16 v[28:31], v[64:67], a[100:103], v[28:31]
    v_mfma_f32_16x16x32_bf16 v[32:35], v[68:71], a[100:103], v[32:35]
    v_mfma_f32_16x16x32_bf16 v[36:39], v[72:75], a[100:103], v[36:39]
    s_waitcnt lgkmcnt(3)
    v_mfma_f32_16x16x32_bf16 v[16:19], v[40:43], a[48:51], v[16:19]
    v_mfma_f32_16x16x32_bf16 v[24:27], v[48:51], a[48:51], v[24:27]
    v_mfma_f32_16x16x32_bf16 v[28:31], v[40:43], a[104:107], v[28:31]
    v_mfma_f32_16x16x32_bf16 v[32:35], v[44:47], a[104:107], v[32:35]
    v_mfma_f32_16x16x32_bf16 v[36:39], v[48:51], a[104:107], v[36:39]
    s_waitcnt lgkmcnt(0)
    v_mfma_f32_16x16x32_bf16 v[16:19], v[52:55], a[52:55], v[16:19]
    v_mfma_f32_16x16x32_bf16 v[24:27], v[60:63], a[52:55], v[24:27]
    v_mfma_f32_16x16x32_bf16 v[28:31], v[52:55], a[108:111], v[28:31]
    v_mfma_f32_16x16x32_bf16 v[32:35], v[56:59], a[108:111], v[32:35]
    v_mfma_f32_16x16x32_bf16 v[36:39], v[60:63], a[108:111], v[36:39]
    s_lshl_b32 s35, s30, 1
    s_mul_i32 s35, s35, 24576
    s_add_u32 s35, s35, 31457280
    s_lshl_b32 s36, s32, 10
    v_mov_b32 v110, s71
    s_lshr_b32 s37, s32, 2
    s_add_u32 s37, s37, 16
    s_lshl_b32 s37, s37, 10
    s_bfe_u32 s38, s32, 0x10001
    s_lshl_b32 s38, s38, 3
    s_add_u32 s37, s37, s38
    s_and_b32 s38, s32, 1
    v_lshrrev_b32 v109, 5, v0
    v_mov_b32 v111, 0x80000000
    v_cmp_eq_u32 vcc, s38, v109
    s_nop 1
    v_cndmask_b32 v111, v111, v1, vcc
    v_cndmask_b32 v16, v110, v16, s[60:61]
    v_cndmask_b32 v17, v110, v17, s[62:63]
    v_cndmask_b32 v18, v110, v18, s[64:65]
    v_cndmask_b32 v19, v110, v19, s[66:67]
    v_max3_f32 v80, v16, v17, v18
    v_max3_f32 v80, v80, v19, v24
    v_max3_f32 v80, v80, v25, v26
    v_max_f32 v80, v80, v27
    v_mov_b32 v81, v80
    s_nop 1
    v_permlane16_swap_b32 v80, v81
    v_max_f32 v80, v80, v81
    v_mov_b32 v81, v80
    s_nop 1
    v_permlane32_swap_b32 v80, v81
    v_max_f32 v80, v80, v81
    v_sub_f32 v16, v16, v80
    v_sub_f32 v17, v17, v80
    v_sub_f32 v18, v18, v80
    v_sub_f32 v19, v19, v80
    v_sub_f32 v24, v24, v80
    v_sub_f32 v25, v25, v80
    v_sub_f32 v26, v26, v80
    v_sub_f32 v27, v27, v80
    v_exp_f32 v16, v16
    v_exp_f32 v17, v17
    v_exp_f32 v18, v18
    v_exp_f32 v19, v19
    v_exp_f32 v24, v24
    v_exp_f32 v25, v25
    v_exp_f32 v26, v26
    v_exp_f32 v27, v27
    v_add_f32 v82, v24, v25
    v_add_f32 v83, v26, v27
    v_add_f32 v82, v82, v83
    v_mov_b32 v83, 0
    v_cndmask_b32 v82, v83, v82, s[68:69]
    v_add_f32 v82, v82, v16
    v_add_f32 v82, v82, v17
    v_add_f32 v82, v82, v18
    v_add_f32 v82, v82, v19
    v_mov_b32 v81, v82
    s_nop 1
    v_permlane16_swap_b32 v82, v81
    v_add_f32 v82, v82, v81
    v_mov_b32 v81, v82
    s_nop 1
    v_permlane32_swap_b32 v82, v81
    v_add_f32 v82, v82, v81
    v_rcp_f32 v82, v82
    s_nop 0
    v_mul_f32 v16, v16, v82
    v_mul_f32 v17, v17, v82
    v_mul_f32 v18, v18, v82
    v_mul_f32 v19, v19, v82
    v_mul_f32 v24, v24, v82
    v_mul_f32 v25, v25, v82
    v_mul_f32 v26, v26, v82
    v_mul_f32 v27, v27, v82
    v_cvt_pk_bf16_f32 v84, v16, v17
    v_cvt_pk_bf16_f32 v85, v18, v19
    v_mov_b32 v86, 0
    v_mov_b32 v87, 0
    v_cvt_pk_bf16_f32 v88, v24, v25
    v_cvt_pk_bf16_f32 v89, v26, v27
    s_add_u32 s39, s35, 0
    s_add_u32 s40, s39, s36
    buffer_store_dwordx4 v[84:87], v1, s[8:11], s40 offen sc1
    s_add_u32 s40, s39, s37
    buffer_store_dwordx2 v[88:89], v111, s[8:11], s40 offen sc1
    s_nop 1
    v_cndmask_b32 v32, v110, v32, s[60:61]
    v_cndmask_b32 v33, v110, v33, s[62:63]
    v_cndmask_b32 v34, v110, v34, s[64:65]
    v_cndmask_b32 v35, v110, v35, s[66:67]
    v_max3_f32 v80, v28, v29, v30
    v_max3_f32 v80, v80, v31, v32
    v_max3_f32 v80, v80, v33, v34
    v_max3_f32 v80, v80, v35, v36
    v_max3_f32 v80, v80, v37, v38
    v_max_f32 v80, v80, v39
    v_mov_b32 v81, v80
    s_nop 1
    v_permlane16_swap_b32 v80, v81
    v_max_f32 v80, v80, v81
    v_mov_b32 v81, v80
    s_nop 1
    v_permlane32_swap_b32 v80, v81
    v_max_f32 v80, v80, v81
    v_sub_f32 v28, v28, v80
    v_sub_f32 v29, v29, v80
    v_sub_f32 v30, v30, v80
    v_sub_f32 v31, v31, v80
    v_sub_f32 v32, v32, v80
    v_sub_f32 v33, v33, v80
    v_sub_f32 v34, v34, v80
    v_sub_f32 v35, v35, v80
    v_sub_f32 v36, v36, v80
    v_sub_f32 v37, v37, v80
    v_sub_f32 v38, v38, v80
    v_sub_f32 v39, v39, v80
    v_exp_f32 v28, v28
    v_exp_f32 v29, v29
    v_exp_f32 v30, v30
    v_exp_f32 v31, v31
    v_exp_f32 v32, v32
    v_exp_f32 v33, v33
    v_exp_f32 v34, v34
    v_exp_f32 v35, v35
    v_exp_f32 v36, v36
    v_exp_f32 v37, v37
    v_exp_f32 v38, v38
    v_exp_f32 v39, v39
    v_add_f32 v82, v36, v37
    v_add_f32 v83, v38, v39
    v_add_f32 v82, v82, v83
    v_mov_b32 v83, 0
    v_cndmask_b32 v82, v83, v82, s[68:69]
    v_add_f32 v82, v82, v28
    v_add_f32 v82, v82, v29
    v_add_f32 v82, v82, v30
    v_add_f32 v82, v82, v31
    v_add_f32 v82, v82, v32
    v_add_f32 v82, v82, v33
    v_add_f32 v82, v82, v34
    v_add_f32 v82, v82, v35
    v_mov_b32 v81, v82
    s_nop 1
    v_permlane16_swap_b32 v82, v81
    v_add_f32 v82, v82, v81
    v_mov_b32 v81, v82
    s_nop 1
    v_permlane32_swap_b32 v82, v81
    v_add_f32 v82, v82, v81
    v_rcp_f32 v82, v82
    s_nop 0
    v_mul_f32 v28, v28, v82
    v_mul_f32 v29, v29, v82
    v_mul_f32 v30, v30, v82
    v_mul_f32 v31, v31, v82
    v_mul_f32 v32, v32, v82
    v_mul_f32 v33, v33, v82
    v_mul_f32 v34, v34, v82
    v_mul_f32 v35, v35, v82
    v_mul_f32 v36, v36, v82
    v_mul_f32 v37, v37, v82
    v_mul_f32 v38, v38, v82
    v_mul_f32 v39, v39, v82
    v_cvt_pk_bf16_f32 v84, v28, v29
    v_cvt_pk_bf16_f32 v85, v30, v31
    v_cvt_pk_bf16_f32 v86, v32, v33
    v_cvt_pk_bf16_f32 v87, v34, v35
    v_cvt_pk_bf16_f32 v88, v36, v37
    v_cvt_pk_bf16_f32 v89, v38, v39
    s_add_u32 s39, s35, 24576
    s_add_u32 s40, s39, s36
    buffer_store_dwordx4 v[84:87], v1, s[8:11], s40 offen sc1
    s_add_u32 s40, s39, s37
    buffer_store_dwordx2 v[88:89], v111, s[8:11], s40 offen sc1
    s_nop 1
    s_waitcnt vmcnt(0)
    s_lshl_b32 s77, s30, 6
    s_add_u32 s77, s77, 12288
    s_lshl_b32 s78, s31, 2
    s_add_u32 s77, s77, s78
    s_waitcnt vmcnt(0)
    s_barrier
    s_cmp_eq_u32 s3, 0
    s_cbranch_scc0 Lsf_85
    v_mov_b32 v6, 0
    v_mov_b32 v7, 1
    s_mov_b64 exec, 1
    buffer_store_dword v7, v6, s[8:11], s77 offen sc1
    s_mov_b64 exec, -1
Lsf_85:
    s_add_u32 s73, s73, 1
    s_cmp_lt_u32 s73, 16
    s_cbranch_scc0 L_exit
    s_barrier
    s_branch W_att1
W_vg0:
    s_sub_u32 s31, s72, 16
    v_lshlrev_b32 v1, 4, v0
    s_lshl_b32 s32, s31, 3
    s_lshl_b32 s33, s3, 1
    s_add_u32 s32, s32, s33
    s_mul_i32 s34, s32, 14336
    s_add_u32 s34, s34, 12582912
    s_add_u32 s35, s34, 0
    buffer_load_dwordx4 a[0:3], v1, s[8:11], s35 offen offset:0 sc1
    buffer_load_dwordx4 a[4:7], v1, s[8:11], s35 offen offset:1024 sc1
    buffer_load_dwordx4 a[8:11], v1, s[8:11], s35 offen offset:2048 sc1
    buffer_load_dwordx4 a[12:15], v1, s[8:11], s35 offen offset:3072 sc1
    s_add_u32 s35, s34, 4096
    buffer_load_dwordx4 a[16:19], v1, s[8:11], s35 offen offset:0 sc1
    buffer_load_dwordx4 a[20:23], v1, s[8:11], s35 offen offset:1024 sc1
    buffer_load_dwordx4 a[24:27], v1, s[8:11], s35 offen offset:2048 sc1
    buffer_load_dwordx4 a[28:31], v1, s[8:11], s35 offen offset:3072 sc1
    s_add_u32 s35, s34, 8192
    buffer_load_dwordx4 a[32:35], v1, s[8:11], s35 offen offset:0 sc1
    buffer_load_dwordx4 a[36:39], v1, s[8:11], s35 offen offset:1024 sc1
    buffer_load_dwordx4 a[40:43], v1, s[8:11], s35 offen offset:2048 sc1
    buffer_load_dwordx4 a[44:47], v1, s[8:11], s35 offen offset:3072 sc1
    s_add_u32 s35, s34, 12288
    buffer_load_dwordx4 a[48:51], v1, s[8:11], s35 offen offset:0 sc1
    buffer_load_dwordx4 a[52:55], v1, s[8:11], s35 offen offset:1024 sc1
    buffer_load_dwordx4 a[56:59], v1, s[8:11], s35 offen offset:2048 sc1
    buffer_load_dwordx4 a[60:63], v1, s[8:11], s35 offen offset:3072 sc1
    s_add_u32 s35, s34, 16384
    buffer_load_dwordx4 a[64:67], v1, s[8:11], s35 offen offset:0 sc1
    buffer_load_dwordx4 a[68:71], v1, s[8:11], s35 offen offset:1024 sc1
    buffer_load_dwordx4 a[72:75], v1, s[8:11], s35 offen offset:2048 sc1
    buffer_load_dwordx4 a[76:79], v1, s[8:11], s35 offen offset:3072 sc1
    s_add_u32 s35, s34, 20480
    buffer_load_dwordx4 a[80:83], v1, s[8:11], s35 offen offset:0 sc1
    buffer_load_dwordx4 a[84:87], v1, s[8:11], s35 offen offset:1024 sc1
    buffer_load_dwordx4 a[88:91], v1, s[8:11], s35 offen offset:2048 sc1
    buffer_load_dwordx4 a[92:95], v1, s[8:11], s35 offen offset:3072 sc1
    s_add_u32 s35, s34, 24576
    buffer_load_dwordx4 a[96:99], v1, s[8:11], s35 offen offset:0 sc1
    buffer_load_dwordx4 a[100:103], v1, s[8:11], s35 offen offset:1024 sc1
    buffer_load_dwordx4 a[104:107], v1, s[8:11], s35 offen offset:2048 sc1
    buffer_load_dwordx4 a[108:111], v1, s[8:11], s35 offen offset:3072 sc1
W_vg:
    s_mov_b32 s30, s73
    s_lshl_b32 s77, s30, 1
    s_add_u32 s77, s77, 1
    s_lshl_b32 s77, s77, 6
    s_add_u32 s77, s77, 4096
    s_cmp_eq_u32 s3, 0
    s_cbranch_scc0 Lwf_86_s
    v_lshlrev_b32 v6, 2, v0
    v_min_u32 v6, 12, v6
Lwf_86:
    buffer_load_dword v7, v6, s[8:11], s77 offen sc1
    s_waitcnt vmcnt(0)
    v_cmp_eq_u32 vcc, 0, v7
    s_cbranch_vccz Lwf_86_s
    s_sleep 1
    s_sub_u32 s76, s76, 1
    s_cbranch_scc0 Lwf_86
    s_branch L_exit
Lwf_86_s:
    s_barrier
    v_bfe_u32 v4, v0, 3, 1
    v_mul_u32_u24 v4, 14336, v4
    v_add_u32 v4, v4, v1
    s_lshl_b32 s35, s30, 1
    s_mul_i32 s35, s35, 14336
    s_add_u32 s35, s35, 24117248
    s_add_u32 s36, s35, 0
    buffer_load_dwordx4 v[16:19], v4, s[8:11], s36 offen offset:0 sc1
    buffer_load_dwordx4 v[20:23], v4, s[8:11], s36 offen offset:1024 sc1
    buffer_load_dwordx4 v[24:27], v4, s[8:11], s36 offen offset:2048 sc1
    buffer_load_dwordx4 v[28:31], v4, s[8:11], s36 offen offset:3072 sc1
    s_add_u32 s36, s35, 4096
    buffer_load_dwordx4 v[32:35], v4, s[8:11], s36 offen offset:0 sc1
    buffer_load_dwordx4 v[36:39], v4, s[8:11], s36 offen offset:1024 sc1
    buffer_load_dwordx4 v[40:43], v4, s[8:11], s36 offen offset:2048 sc1
    buffer_load_dwordx4 v[44:47], v4, s[8:11], s36 offen offset:3072 sc1
    s_add_u32 s36, s35, 8192
    buffer_load_dwordx4 v[48:51], v4, s[8:11], s36 offen offset:0 sc1
    buffer_load_dwordx4 v[52:55], v4, s[8:11], s36 offen offset:1024 sc1
    buffer_load_dwordx4 v[56:59], v4, s[8:11], s36 offen offset:2048 sc1
    buffer_load_dwordx4 v[60:63], v4, s[8:11], s36 offen offset:3072 sc1
    s_add_u32 s36, s35, 12288
    buffer_load_dwordx4 v[64:67], v4, s[8:11], s36 offen offset:0 sc1
    buffer_load_dwordx4 v[68:71], v4, s[8:11], s36 offen offset:1024 sc1
    v_lshrrev_b32 v5, 5, v0
    v_mul_u32_u24 v5, 114688, v5
    v_and_b32 v6, 31, v0
    v_lshl_add_u32 v5, v6, 4, v5
    s_waitcnt vmcnt(13)
    v_mfma_f32_16x16x32_bf16 v[80:83], v[16:19], a[0:3], 0
    v_mfma_f32_16x16x32_bf16 v[84:87], v[16:19], a[56:59], 0
    s_waitcnt vmcnt(12)
    v_mfma_f32_16x16x32_bf16 v[80:83], v[20:23], a[4:7], v[80:83]
    v_mfma_f32_16x16x32_bf16 v[84:87], v[20:23], a[60:63], v[84:87]
    s_waitcnt vmcnt(11)
    v_mfma_f32_16x16x32_bf16 v[80:83], v[24:27], a[8:11], v[80:83]
    v_mfma_f32_16x16x32_bf16 v[84:87], v[24:27], a[64:67], v[84:87]
    s_waitcnt vmcnt(10)
    v_mfma_f32_16x16x32_bf16 v[80:83], v[28:31], a[12:15], v[80:83]
    v_mfma_f32_16x16x32_bf16 v[84:87], v[28:31], a[68:71], v[84:87]
    s_waitcnt vmcnt(9)
    v_mfma_f32_16x16x32_bf16 v[80:83], v[32:35], a[16:19], v[80:83]
    v_mfma_f32_16x16x32_bf16 v[84:87], v[32:35], a[72:75], v[84:87]
    s_waitcnt vmcnt(8)
    v_mfma_f32_16x16x32_bf16 v[80:83], v[36:39], a[20:23], v[80:83]
    v_mfma_f32_16x16x32_bf16 v[84:87], v[36:39], a[76:79], v[84:87]
    s_waitcnt vmcnt(7)
    v_mfma_f32_16x16x32_bf16 v[80:83], v[40:43], a[24:27], v[80:83]
    v_mfma_f32_16x16x32_bf16 v[84:87], v[40:43], a[80:83], v[84:87]
    s_waitcnt vmcnt(6)
    v_mfma_f32_16x16x32_bf16 v[80:83], v[44:47], a[28:31], v[80:83]
    v_mfma_f32_16x16x32_bf16 v[84:87], v[44:47], a[84:87], v[84:87]
    s_waitcnt vmcnt(5)
    v_mfma_f32_16x16x32_bf16 v[80:83], v[48:51], a[32:35], v[80:83]
    v_mfma_f32_16x16x32_bf16 v[84:87], v[48:51], a[88:91], v[84:87]
    s_waitcnt vmcnt(4)
    v_mfma_f32_16x16x32_bf16 v[80:83], v[52:55], a[36:39], v[80:83]
    v_mfma_f32_16x16x32_bf16 v[84:87], v[52:55], a[92:95], v[84:87]
    s_waitcnt vmcnt(3)
    v_mfma_f32_16x16x32_bf16 v[80:83], v[56:59], a[40:43], v[80:83]
    v_mfma_f32_16x16x32_bf16 v[84:87], v[56:59], a[96:99], v[84:87]
    s_waitcnt vmcnt(2)
    v_mfma_f32_16x16x32_bf16 v[80:83], v[60:63], a[44:47], v[80:83]
    v_mfma_f32_16x16x32_bf16 v[84:87], v[60:63], a[100:103], v[84:87]
    s_waitcnt vmcnt(1)
    v_mfma_f32_16x16x32_bf16 v[80:83], v[64:67], a[48:51], v[80:83]
    v_mfma_f32_16x16x32_bf16 v[84:87], v[64:67], a[104:107], v[84:87]
    s_waitcnt vmcnt(0)
    v_mfma_f32_16x16x32_bf16 v[80:83], v[68:71], a[52:55], v[80:83]
    v_mfma_f32_16x16x32_bf16 v[84:87], v[68:71], a[108:111], v[84:87]
    s_add_u32 s40, s32, 0
    s_mul_hi_u32 s41, s40, 153391690
    s_mul_i32 s42, s41, 28
    s_sub_u32 s42, s40, s42
    s_lshr_b32 s43, s41, 2
    s_mul_i32 s43, s43, 28
    s_add_u32 s43, s43, s42
    s_lshl_b32 s43, s43, 10
    s_and_b32 s44, s41, 1
    s_lshl_b32 s44, s44, 9
    s_add_u32 s43, s43, s44
    s_bfe_u32 s44, s41, 0x10001
    s_lshl_b32 s44, s44, 3
    s_add_u32 s43, s43, s44
    s_lshl_b32 s44, s30, 1
    s_mul_i32 s44, s44, 114688
    s_add_u32 s43, s43, s44
    s_add_u32 s43, s43, 100663296
    v_cvt_pk_bf16_f32 v100, v80, v81
    v_cvt_pk_bf16_f32 v101, v82, v83
    buffer_store_dwordx2 v[100:101], v5, s[8:11], s43 offen sc1
    s_add_u32 s40, s32, 1
    s_mul_hi_u32 s41, s40, 153391690
    s_mul_i32 s42, s41, 28
    s_sub_u32 s42, s40, s42
    s_lshr_b32 s43, s41, 2
    s_mul_i32 s43, s43, 28
    s_add_u32 s43, s43, s42
    s_lshl_b32 s43, s43, 10
    s_and_b32 s44, s41, 1
    s_lshl_b32 s44, s44, 9
    s_add_u32 s43, s43, s44
    s_bfe_u32 s44, s41, 0x10001
    s_lshl_b32 s44, s44, 3
    s_add_u32 s43, s43, s44
    s_lshl_b32 s44, s30, 1
    s_mul_i32 s44, s44, 114688
    s_add_u32 s43, s43, s44
    s_add_u32 s43, s43, 100663296
    v_cvt_pk_bf16_f32 v102, v84, v85
    v_cvt_pk_bf16_f32 v103, v86, v87
    buffer_store_dwordx2 v[102:103], v5, s[8:11], s43 offen sc1
    s_lshl_b32 s77, s30, 8
    s_add_u32 s77, s77, 24576
    s_lshl_b32 s78, s31, 2
    s_add_u32 s77, s77, s78
    s_waitcnt vmcnt(0)
    s_barrier
    s_cmp_eq_u32 s3, 0
    s_cbranch_scc0 Lsf_87
    v_mov_b32 v6, 0
    v_mov_b32 v7, 1
    s_mov_b64 exec, 1
    buffer_store_dword v7, v6, s[8:11], s77 offen sc1
    s_mov_b64 exec, -1
Lsf_87:
    s_add_u32 s73, s73, 1
    s_cmp_lt_u32 s73, 32
    s_cbranch_scc0 L_exit
    s_barrier
    s_branch W_vg
W_att2:
    s_sub_u32 s29, s72, 72
    s_mul_hi_u32 s30, s29, 613566757
    s_mul_i32 s31, s30, 7
    s_sub_u32 s31, s29, s31
    s_lshl_b32 s28, s73, 2
    s_add_u32 s30, s30, s28
    s_lshr_b32 s77, s30, 3
    s_lshl_b32 s77, s77, 10
    s_add_u32 s77, s77, 57344
    s_cmp_eq_u32 s3, 0
    s_cbranch_scc0 Lwq_88_s
    v_min_u32 v6, 55, v0
    v_lshlrev_b32 v6, 4, v6
Lwq_88:
    buffer_load_dwordx4 v[8:11], v6, s[8:11], s77 offen sc1
    s_waitcnt vmcnt(0)
    v_min_u32 v8, v8, v9
    v_min3_u32 v8, v8, v10, v11
    v_cmp_eq_u32 vcc, 0, v8
    s_cbranch_vccz Lwq_88_s
    s_sleep 2
    s_sub_u32 s76, s76, 1
    s_cbranch_scc0 Lwq_88
    s_branch L_exit
Lwq_88_s:
    s_barrier
    v_lshlrev_b32 v1, 4, v0
    s_lshr_b32 s32, s3, 1
    s_lshl_b32 s33, s31, 1
    s_add_u32 s32, s32, s33
    s_and_b32 s33, s3, 1
    s_mul_i32 s34, s30, 448
    s_lshl_b32 s35, s32, 1
    s_add_u32 s34, s34, s35
    s_lshl_b32 s34, s34, 10
    s_add_u32 s34, s34, 35651584
    s_add_u32 s36, s34, 0
    buffer_load_dwordx4 a[0:3], v1, s[8:11], s36 offen offset:0 sc1
    buffer_load_dwordx4 a[4:7], v1, s[8:11], s36 offen offset:1024 sc1
    s_add_u32 s36, s34, 28672
    buffer_load_dwordx4 a[8:11], v1, s[8:11], s36 offen offset:0 sc1
    buffer_load_dwordx4 a[12:15], v1, s[8:11], s36 offen offset:1024 sc1
    s_add_u32 s36, s34, 57344
    buffer_load_dwordx4 a[16:19], v1, s[8:11], s36 offen offset:0 sc1
    buffer_load_dwordx4 a[20:23], v1, s[8:11], s36 offen offset:1024 sc1
    s_add_u32 s36, s34, 86016
    buffer_load_dwordx4 a[24:27], v1, s[8:11], s36 offen offset:0 sc1
    buffer_load_dwordx4 a[28:31], v1, s[8:11], s36 offen offset:1024 sc1
    s_add_u32 s36, s34, 114688
    buffer_load_dwordx4 a[32:35], v1, s[8:11], s36 offen offset:0 sc1
    buffer_load_dwordx4 a[36:39], v1, s[8:11], s36 offen offset:1024 sc1
    s_add_u32 s36, s34, 143360
    buffer_load_dwordx4 a[40:43], v1, s[8:11], s36 offen offset:0 sc1
    buffer_load_dwordx4 a[44:47], v1, s[8:11], s36 offen offset:1024 sc1
    s_add_u32 s36, s34, 172032
    buffer_load_dwordx4 a[48:51], v1, s[8:11], s36 offen offset:0 sc1
    buffer_load_dwordx4 a[52:55], v1, s[8:11], s36 offen offset:1024 sc1
    s_add_u32 s36, s34, 200704
    buffer_load_dwordx4 a[56:59], v1, s[8:11], s36 offen offset:0 sc1
    buffer_load_dwordx4 a[60:63], v1, s[8:11], s36 offen offset:1024 sc1
    s_add_u32 s36, s34, 229376
    buffer_load_dwordx4 a[64:67], v1, s[8:11], s36 offen offset:0 sc1
    buffer_load_dwordx4 a[68:71], v1, s[8:11], s36 offen offset:1024 sc1
    s_add_u32 s36, s34, 258048
    buffer_load_dwordx4 a[72:75], v1, s[8:11], s36 offen offset:0 sc1
    buffer_load_dwordx4 a[76:79], v1, s[8:11], s36 offen offset:1024 sc1
    s_add_u32 s36, s34, 286720
    buffer_load_dwordx4 a[80:83], v1, s[8:11], s36 offen offset:0 sc1
    buffer_load_dwordx4 a[84:87], v1, s[8:11], s36 offen offset:1024 sc1
    s_add_u32 s36, s34, 315392
    buffer_load_dwordx4 a[88:91], v1, s[8:11], s36 offen offset:0 sc1
    buffer_load_dwordx4 a[92:95], v1, s[8:11], s36 offen offset:1024 sc1
    s_add_u32 s36, s34, 344064
    buffer_load_dwordx4 a[96:99], v1, s[8:11], s36 offen offset:0 sc1
    buffer_load_dwordx4 a[100:103], v1, s[8:11], s36 offen offset:1024 sc1
    s_add_u32 s36, s34, 372736
    buffer_load_dwordx4 a[104:107], v1, s[8:11], s36 offen offset:0 sc1
    buffer_load_dwordx4 a[108:111], v1, s[8:11], s36 offen offset:1024 sc1
    s_add_u32 s36, s34, 401408
    buffer_load_dwordx4 a[112:115], v1, s[8:11], s36 offen offset:0 sc1
    buffer_load_dwordx4 a[116:119], v1, s[8:11], s36 offen offset:1024 sc1
    s_add_u32 s36, s34, 430080
    buffer_load_dwordx4 a[120:123], v1, s[8:11], s36 offen offset:0 sc1
    buffer_load_dwordx4 a[124:127], v1, s[8:11], s36 offen offset:1024 sc1
    v_and_b32 v4, 15, v0
    v_lshrrev_b32 v5, 4, v0
    s_lshl_b32 s36, s30, 5
    s_lshl_b32 s37, s33, 4
    s_add_u32 s36, s36, s37
    v_add_u32 v4, s36, v4
    v_mul_u32_u24 v4, 896, v4
    v_lshl_add_u32 v4, v5, 3, v4
    s_lshl_b32 s36, s32, 6
    buffer_load_dwordx2 v[8:9], v4, s[20:23], s36 offen
    buffer_load_dwordx2 v[10:11], v4, s[20:23], s36 offen offset:32
    s_lshl_b32 s77, s30, 6
    s_add_u32 s77, s77, 12288
    s_cmp_eq_u32 s3, 0
    s_cbranch_scc0 Lwf_89_s
    v_lshlrev_b32 v6, 2, v0
    v_min_u32 v6, 12, v6
Lwf_89:
    buffer_load_dword v7, v6, s[8:11], s77 offen sc1
    s_waitcnt vmcnt(0)
    v_cmp_eq_u32 vcc, 0, v7
    s_cbranch_vccz Lwf_89_s
    s_sleep 1
    s_sub_u32 s76, s76, 1
    s_cbranch_scc0 Lwf_89
    s_branch L_exit
Lwf_89_s:
    s_barrier
    s_lshr_b32 s77, s30, 1
    s_lshl_b32 s77, s77, 8
    s_add_u32 s77, s77, 24576
    s_cmp_eq_u32 s3, 0
    s_cbranch_scc0 Lwf_90_s
    v_lshlrev_b32 v6, 2, v0
    v_min_u32 v6, 220, v6
Lwf_90:
    buffer_load_dword v7, v6, s[8:11], s77 offen sc1
    s_waitcnt vmcnt(0)
    v_cmp_eq_u32 vcc, 0, v7
    s_cbranch_vccz Lwf_90_s
    s_sleep 1
    s_sub_u32 s76, s76, 1
    s_cbranch_scc0 Lwf_90
    s_branch L_exit
Lwf_90_s:
    s_barrier
    s_mul_i32 s34, s30, 112
    s_lshl_b32 s35, s32, 1
    s_add_u32 s34, s34, s35
    s_lshl_b32 s34, s34, 10
    s_add_u32 s34, s34, 100663296
    s_lshl_b32 s35, s30, 1
    s_add_u32 s35, s35, s33
    s_mul_i32 s35, s35, 24576
    s_add_u32 s35, s35, 31457280
    s_add_u32 s36, s35, 0
    buffer_load_dwordx4 v[80:83], v1, s[8:11], s36 offen offset:0 sc1
    buffer_load_dwordx4 v[84:87], v1, s[8:11], s36 offen offset:1024 sc1
    buffer_load_dwordx4 v[88:91], v1, s[8:11], s36 offen offset:2048 sc1
    buffer_load_dwordx4 v[92:95], v1, s[8:11], s36 offen offset:3072 sc1
    s_add_u32 s36, s35, 4096
    buffer_load_dwordx4 v[96:99], v1, s[8:11], s36 offen offset:0 sc1
    buffer_load_dwordx4 v[100:103], v1, s[8:11], s36 offen offset:1024 sc1
    buffer_load_dwordx4 v[104:107], v1, s[8:11], s36 offen offset:2048 sc1
    buffer_load_dwordx4 v[108:111], v1, s[8:11], s36 offen offset:3072 sc1
    s_add_u32 s36, s35, 8192
    buffer_load_dwordx4 v[112:115], v1, s[8:11], s36 offen offset:0 sc1
    buffer_load_dwordx4 v[116:119], v1, s[8:11], s36 offen offset:1024 sc1
    buffer_load_dwordx4 v[120:123], v1, s[8:11], s36 offen offset:2048 sc1
    buffer_load_dwordx4 v[124:127], v1, s[8:11], s36 offen offset:3072 sc1
    s_add_u32 s36, s35, 12288
    buffer_load_dwordx4 v[128:131], v1, s[8:11], s36 offen offset:0 sc1
    buffer_load_dwordx4 v[132:135], v1, s[8:11], s36 offen offset:1024 sc1
    buffer_load_dwordx4 v[136:139], v1, s[8:11], s36 offen offset:2048 sc1
    buffer_load_dwordx4 v[140:143], v1, s[8:11], s36 offen offset:3072 sc1
    s_add_u32 s36, s35, 16384
    buffer_load_dwordx4 v[144:147], v1, s[8:11], s36 offen offset:0 sc1
    buffer_load_dwordx4 v[148:151], v1, s[8:11], s36 offen offset:1024 sc1
    buffer_load_dwordx4 v[152:155], v1, s[8:11], s36 offen offset:2048 sc1
    buffer_load_dwordx4 v[156:159], v1, s[8:11], s36 offen offset:3072 sc1
    s_add_u32 s36, s34, 0
    buffer_load_dwordx4 v[16:19], v1, s[8:11], s36 offen offset:0 sc1
    buffer_load_dwordx4 v[20:23], v1, s[8:11], s36 offen offset:1024 sc1
    s_add_u32 s36, s34, 28672
    buffer_load_dwordx4 v[24:27], v1, s[8:11], s36 offen offset:0 sc1
    buffer_load_dwordx4 v[28:31], v1, s[8:11], s36 offen offset:1024 sc1
    s_add_u32 s36, s34, 57344
    buffer_load_dwordx4 v[32:35], v1, s[8:11], s36 offen offset:0 sc1
    buffer_load_dwordx4 v[36:39], v1, s[8:11], s36 offen offset:1024 sc1
    s_add_u32 s36, s34, 86016
    buffer_load_dwordx4 v[40:43], v1, s[8:11], s36 offen offset:0 sc1
    buffer_load_dwordx4 v[44:47], v1, s[8:11], s36 offen offset:1024 sc1
    s_waitcnt vmcnt(24)
    v_mfma_f32_16x16x32_bf16 v[176:179], a[0:3], v[80:83], 0
    v_mfma_f32_16x16x32_bf16 v[180:183], a[4:7], v[80:83], 0
    v_mfma_f32_16x16x32_bf16 v[176:179], a[8:11], v[84:87], v[176:179]
    v_mfma_f32_16x16x32_bf16 v[180:183], a[12:15], v[84:87], v[180:183]
    v_mfma_f32_16x16x32_bf16 v[176:179], a[16:19], v[88:91], v[176:179]
    v_mfma_f32_16x16x32_bf16 v[180:183], a[20:23], v[88:91], v[180:183]
    v_mfma_f32_16x16x32_bf16 v[176:179], a[24:27], v[92:95], v[176:179]
    v_mfma_f32_16x16x32_bf16 v[180:183], a[28:31], v[92:95], v[180:183]
    s_waitcnt vmcnt(20)
    v_mfma_f32_16x16x32_bf16 v[176:179], a[32:35], v[96:99], v[176:179]
    v_mfma_f32_16x16x32_bf16 v[180:183], a[36:39], v[96:99], v[180:183]
    v_mfma_f32_16x16x32_bf16 v[176:179], a[40:43], v[100:103], v[176:179]
    v_mfma_f32_16x16x32_bf16 v[180:183], a[44:47], v[100:103], v[180:183]
    v_mfma_f32_16x16x32_bf16 v[176:179], a[48:51], v[104:107], v[176:179]
    v_mfma_f32_16x16x32_bf16 v[180:183], a[52:55], v[104:107], v[180:183]
    v_mfma_f32_16x16x32_bf16 v[176:179], a[56:59], v[108:111], v[176:179]
    v_mfma_f32_16x16x32_bf16 v[180:183], a[60:63], v[108:111], v[180:183]
    s_waitcnt vmcnt(16)
    v_mfma_f32_16x16x32_bf16 v[176:179], a[64:67], v[112:115], v[176:179]
    v_mfma_f32_16x16x32_bf16 v[180:183], a[68:71], v[112:115], v[180:183]
    v_mfma_f32_16x16x32_bf16 v[176:179], a[72:75], v[116:119], v[176:179]
    v_mfma_f32_16x16x32_bf16 v[180:183], a[76:79], v[116:119], v[180:183]
    v_mfma_f32_16x16x32_bf16 v[176:179], a[80:83], v[120:123], v[176:179]
    v_mfma_f32_16x16x32_bf16 v[180:183], a[84:87], v[120:123], v[180:183]
    v_mfma_f32_16x16x32_bf16 v[176:179], a[88:91], v[124:127], v[176:179]
    v_mfma_f32_16x16x32_bf16 v[180:183], a[92:95], v[124:127], v[180:183]
    s_waitcnt vmcnt(12)
    v_mfma_f32_16x16x32_bf16 v[176:179], a[96:99], v[128:131], v[176:179]
    v_mfma_f32_16x16x32_bf16 v[180:183], a[100:103], v[128:131], v[180:183]
    v_mfma_f32_16x16x32_bf16 v[176:179], a[104:107], v[132:135], v[176:179]
    v_mfma_f32_16x16x32_bf16 v[180:183], a[108:111], v[132:135], v[180:183]
    v_mfma_f32_16x16x32_bf16 v[176:179], a[112:115], v[136:139], v[176:179]
    v_mfma_f32_16x16x32_bf16 v[180:183], a[116:119], v[136:139], v[180:183]
    v_mfma_f32_16x16x32_bf16 v[176:179], a[120:123], v[140:143], v[176:179]
    v_mfma_f32_16x16x32_bf16 v[180:183], a[124:127], v[140:143], v[180:183]
    s_waitcnt vmcnt(0)
    v_mfma_f32_16x16x32_bf16 v[176:179], v[16:19], v[144:147], v[176:179]
    v_mfma_f32_16x16x32_bf16 v[180:183], v[20:23], v[144:147], v[180:183]
    v_mfma_f32_16x16x32_bf16 v[176:179], v[24:27], v[148:151], v[176:179]
    v_mfma_f32_16x16x32_bf16 v[180:183], v[28:31], v[148:151], v[180:183]
    v_mfma_f32_16x16x32_bf16 v[176:179], v[32:35], v[152:155], v[176:179]
    v_mfma_f32_16x16x32_bf16 v[180:183], v[36:39], v[152:155], v[180:183]
    v_mfma_f32_16x16x32_bf16 v[176:179], v[40:43], v[156:159], v[176:179]
    v_mfma_f32_16x16x32_bf16 v[180:183], v[44:47], v[156:159], v[180:183]
    v_lshlrev_b32 v184, 16, v8
    v_and_b32 v185, 0xffff0000, v8
    s_nop 1
    v_add_f32 v184, v184, v176
    v_add_f32 v185, v185, v177
    v_cvt_pk_bf16_f32 v188, v184, v185
    v_lshlrev_b32 v184, 16, v9
    v_and_b32 v185, 0xffff0000, v9
    v_add_f32 v184, v184, v178
    v_add_f32 v185, v185, v179
    v_cvt_pk_bf16_f32 v189, v184, v185
    v_lshlrev_b32 v184, 16, v10
    v_and_b32 v185, 0xffff0000, v10
    v_add_f32 v184, v184, v180
    v_add_f32 v185, v185, v181
    v_cvt_pk_bf16_f32 v190, v184, v185
    v_lshlrev_b32 v184, 16, v11
    v_and_b32 v185, 0xffff0000, v11
    v_add_f32 v184, v184, v182
    v_add_f32 v185, v185, v183
    v_cvt_pk_bf16_f32 v191, v184, v185
    s_lshl_b32 s35, s30, 1
    s_add_u32 s35, s35, s33
    s_mul_i32 s35, s35, 14
    s_add_u32 s35, s35, s32
    s_lshl_b32 s35, s35, 10
    s_add_u32 s35, s35, 3145728
    buffer_store_dwordx4 v[188:191], v1, s[8:11], s35 offen sc1
    s_waitcnt vmcnt(0)
    s_lshl_b32 s77, s30, 5
    s_add_u32 s77, s77, 16384
    s_lshl_b32 s78, s31, 2
    s_add_u32 s77, s77, s78
    s_waitcnt vmcnt(0)
    s_barrier
    s_cmp_eq_u32 s3, 0
    s_cbranch_scc0 Lsf_91
    v_mov_b32 v6, 0
    v_mov_b32 v7, 1
    s_mov_b64 exec, 1
    buffer_store_dword v7, v6, s[8:11], s77 offen sc1
    s_mov_b64 exec, -1
Lsf_91:
    s_add_u32 s73, s73, 1
    s_cmp_lt_u32 s73, 16
    s_cbranch_scc0 L_exit
    s_barrier
    s_branch W_att2
W_ffn10:
    s_sub_u32 s31, s72, 100
    s_mov_b32 s77, 3072
    s_cmp_eq_u32 s3, 0
    s_cbranch_scc0 Lwc_92_s
    v_mov_b32 v6, 0
Lwc_92:
    buffer_load_dword v7, v6, s[8:11], s77 offen sc1
    s_waitcnt vmcnt(0)
    v_readfirstlane_b32 s78, v7
    s_cmp_ge_u32 s78, 224
    s_cbranch_scc1 Lwc_92_s
    s_sleep 2
    s_sub_u32 s76, s76, 1
    s_cbranch_scc0 Lwc_92
    s_branch L_exit
Lwc_92_s:
    s_barrier
    v_lshlrev_b32 v1, 4, v0
    s_mul_i32 s32, s31, 57344
    s_add_u32 s32, s32, 25165824
    s_add_u32 s34, s32, 0
    buffer_load_dwordx4 a[0:3], v1, s[8:11], s34 offen offset:0 sc1
    buffer_load_dwordx4 a[4:7], v1, s[8:11], s34 offen offset:1024 sc1
    buffer_load_dwordx4 a[8:11], v1, s[8:11], s34 offen offset:2048 sc1
    buffer_load_dwordx4 a[12:15], v1, s[8:11], s34 offen offset:3072 sc1
    s_add_u32 s34, s32, 4096
    buffer_load_dwordx4 a[16:19], v1, s[8:11], s34 offen offset:0 sc1
    buffer_load_dwordx4 a[20:23], v1, s[8:11], s34 offen offset:1024 sc1
    buffer_load_dwordx4 a[24:27], v1, s[8:11], s34 offen offset:2048 sc1
    buffer_load_dwordx4 a[28:31], v1, s[8:11], s34 offen offset:3072 sc1
    s_add_u32 s34, s32, 8192
    buffer_load_dwordx4 a[32:35], v1, s[8:11], s34 offen offset:0 sc1
    buffer_load_dwordx4 a[36:39], v1, s[8:11], s34 offen offset:1024 sc1
    buffer_load_dwordx4 a[40:43], v1, s[8:11], s34 offen offset:2048 sc1
    buffer_load_dwordx4 a[44:47], v1, s[8:11], s34 offen offset:3072 sc1
    s_add_u32 s34, s32, 12288
    buffer_load_dwordx4 a[48:51], v1, s[8:11], s34 offen offset:0 sc1
    buffer_load_dwordx4 a[52:55], v1, s[8:11], s34 offen offset:1024 sc1
    buffer_load_dwordx4 a[56:59], v1, s[8:11], s34 offen offset:2048 sc1
    buffer_load_dwordx4 a[60:63], v1, s[8:11], s34 offen offset:3072 sc1
    s_add_u32 s34, s32, 16384
    buffer_load_dwordx4 a[64:67], v1, s[8:11], s34 offen offset:0 sc1
    buffer_load_dwordx4 a[68:71], v1, s[8:11], s34 offen offset:1024 sc1
    buffer_load_dwordx4 a[72:75], v1, s[8:11], s34 offen offset:2048 sc1
    buffer_load_dwordx4 a[76:79], v1, s[8:11], s34 offen offset:3072 sc1
    s_add_u32 s34, s32, 20480
    buffer_load_dwordx4 a[80:83], v1, s[8:11], s34 offen offset:0 sc1
    buffer_load_dwordx4 a[84:87], v1, s[8:11], s34 offen offset:1024 sc1
    buffer_load_dwordx4 a[88:91], v1, s[8:11], s34 offen offset:2048 sc1
    buffer_load_dwordx4 a[92:95], v1, s[8:11], s34 offen offset:3072 sc1
    s_add_u32 s34, s32, 24576
    buffer_load_dwordx4 a[96:99], v1, s[8:11], s34 offen offset:0 sc1
    buffer_load_dwordx4 a[100:103], v1, s[8:11], s34 offen offset:1024 sc1
    buffer_load_dwordx4 a[104:107], v1, s[8:11], s34 offen offset:2048 sc1
    buffer_load_dwordx4 a[108:111], v1, s[8:11], s34 offen offset:3072 sc1
    s_add_u32 s34, s32, 28672
    buffer_load_dwordx4 a[112:115], v1, s[8:11], s34 offen offset:0 sc1
    buffer_load_dwordx4 a[116:119], v1, s[8:11], s34 offen offset:1024 sc1
    buffer_load_dwordx4 a[120:123], v1, s[8:11], s34 offen offset:2048 sc1
    buffer_load_dwordx4 a[124:127], v1, s[8:11], s34 offen offset:3072 sc1
    s_add_u32 s34, s32, 32768
    buffer_load_dwordx4 a[128:131], v1, s[8:11], s34 offen offset:0 sc1
    buffer_load_dwordx4 a[132:135], v1, s[8:11], s34 offen offset:1024 sc1
    buffer_load_dwordx4 a[136:139], v1, s[8:11], s34 offen offset:2048 sc1
    buffer_load_dwordx4 a[140:143], v1, s[8:11], s34 offen offset:3072 sc1
    s_add_u32 s34, s32, 36864
    buffer_load_dwordx4 a[144:147], v1, s[8:11], s34 offen offset:0 sc1
    buffer_load_dwordx4 a[148:151], v1, s[8:11], s34 offen offset:1024 sc1
    buffer_load_dwordx4 a[152:155], v1, s[8:11], s34 offen offset:2048 sc1
    buffer_load_dwordx4 a[156:159], v1, s[8:11], s34 offen offset:3072 sc1
    s_add_u32 s34, s32, 40960
    buffer_load_dwordx4 a[160:163], v1, s[8:11], s34 offen offset:0 sc1
    buffer_load_dwordx4 a[164:167], v1, s[8:11], s34 offen offset:1024 sc1
    buffer_load_dwordx4 a[168:171], v1, s[8:11], s34 offen offset:2048 sc1
    buffer_load_dwordx4 a[172:175], v1, s[8:11], s34 offen offset:3072 sc1
    s_add_u32 s34, s32, 45056
    buffer_load_dwordx4 a[176:179], v1, s[8:11], s34 offen offset:0 sc1
    buffer_load_dwordx4 a[180:183], v1, s[8:11], s34 offen offset:1024 sc1
    buffer_load_dwordx4 a[184:187], v1, s[8:11], s34 offen offset:2048 sc1
    buffer_load_dwordx4 a[188:191], v1, s[8:11], s34 offen offset:3072 sc1
    s_add_u32 s34, s32, 49152
    buffer_load_dwordx4 a[192:195], v1, s[8:11], s34 offen offset:0 sc1
    buffer_load_dwordx4 a[196:199], v1, s[8:11], s34 offen offset:1024 sc1
    buffer_load_dwordx4 a[200:203], v1, s[8:11], s34 offen offset:2048 sc1
    buffer_load_dwordx4 a[204:207], v1, s[8:11], s34 offen offset:3072 sc1
    s_add_u32 s34, s32, 53248
    buffer_load_dwordx4 a[208:211], v1, s[8:11], s34 offen offset:0 sc1
    buffer_load_dwordx4 a[212:215], v1, s[8:11], s34 offen offset:1024 sc1
    buffer_load_dwordx4 a[216:219], v1, s[8:11], s34 offen offset:2048 sc1
    buffer_load_dwordx4 a[220:223], v1, s[8:11], s34 offen offset:3072 sc1
    v_mov_b32 v196, 0x3f803f80
    v_mov_b32 v197, 0x3f803f80
    v_mov_b32 v198, 0x3f803f80
    v_mov_b32 v199, 0x3f803f80
    v_and_b32 v4, 15, v0
    v_lshrrev_b32 v5, 4, v0
    v_lshlrev_b32 v5, 2, v5
    v_add_u32 v6, 0, v5
    v_cmp_eq_u32 s[60:61], v6, v4
    v_add_u32 v6, 1, v5
    v_cmp_eq_u32 s[62:63], v6, v4
    v_add_u32 v6, 2, v5
    v_cmp_eq_u32 s[64:65], v6, v4
    v_add_u32 v6, 3, v5
    v_cmp_eq_u32 s[66:67], v6, v4
    s_waitcnt vmcnt(0)
    v_mfma_f32_16x16x32_bf16 v[200:203], a[0:3], v[196:199], 0
    v_mfma_f32_16x16x32_bf16 v[200:203], a[4:7], v[196:199], v[200:203]
    v_mfma_f32_16x16x32_bf16 v[200:203], a[8:11], v[196:199], v[200:203]
    v_mfma_f32_16x16x32_bf16 v[200:203], a[12:15], v[196:199], v[200:203]
    v_mfma_f32_16x16x32_bf16 v[200:203], a[16:19], v[196:199], v[200:203]
    v_mfma_f32_16x16x32_bf16 v[200:203], a[20:23], v[196:199], v[200:203]
    v_mfma_f32_16x16x32_bf16 v[200:203], a[24:27], v[196:199], v[200:203]
    v_mfma_f32_16x16x32_bf16 v[200:203], a[28:31], v[196:199], v[200:203]
    v_mfma_f32_16x16x32_bf16 v[200:203], a[32:35], v[196:199], v[200:203]
    v_mfma_f32_16x16x32_bf16 v[200:203], a[36:39], v[196:199], v[200:203]
    v_mfma_f32_16x16x32_bf16 v[200:203], a[40:43], v[196:199], v[200:203]
    v_mfma_f32_16x16x32_bf16 v[200:203], a[44:47], v[196:199], v[200:203]
    v_mfma_f32_16x16x32_bf16 v[200:203], a[48:51], v[196:199], v[200:203]
    v_mfma_f32_16x16x32_bf16 v[200:203], a[52:55], v[196:199], v[200:203]
    v_mfma_f32_16x16x32_bf16 v[204:207], a[56:59], v[196:199], 0
    v_mfma_f32_16x16x32_bf16 v[204:207], a[60:63], v[196:199], v[204:207]
    v_mfma_f32_16x16x32_bf16 v[204:207], a[64:67], v[196:199], v[204:207]
    v_mfma_f32_16x16x32_bf16 v[204:207], a[68:71], v[196:199], v[204:207]
    v_mfma_f32_16x16x32_bf16 v[204:207], a[72:75], v[196:199], v[204:207]
    v_mfma_f32_16x16x32_bf16 v[204:207], a[76:79], v[196:199], v[204:207]
    v_mfma_f32_16x16x32_bf16 v[204:207], a[80:83], v[196:199], v[204:207]
    v_mfma_f32_16x16x32_bf16 v[204:207], a[84:87], v[196:199], v[204:207]
    v_mfma_f32_16x16x32_bf16 v[204:207], a[88:91], v[196:199], v[204:207]
    v_mfma_f32_16x16x32_bf16 v[204:207], a[92:95], v[196:199], v[204:207]
    v_mfma_f32_16x16x32_bf16 v[204:207], a[96:99], v[196:199], v[204:207]
    v_mfma_f32_16x16x32_bf16 v[204:207], a[100:103], v[196:199], v[204:207]
    v_mfma_f32_16x16x32_bf16 v[204:207], a[104:107], v[196:199], v[204:207]
    v_mfma_f32_16x16x32_bf16 v[204:207], a[108:111], v[196:199], v[204:207]
    v_mfma_f32_16x16x32_bf16 v[208:211], a[112:115], v[196:199], 0
    v_mfma_f32_16x16x32_bf16 v[208:211], a[116:119], v[196:199], v[208:211]
    v_mfma_f32_16x16x32_bf16 v[208:211], a[120:123], v[196:199], v[208:211]
    v_mfma_f32_16x16x32_bf16 v[208:211], a[124:127], v[196:199], v[208:211]
    v_mfma_f32_16x16x32_bf16 v[208:211], a[128:131], v[196:199], v[208:211]
    v_mfma_f32_16x16x32_bf16 v[208:211], a[132:135], v[196:199], v[208:211]
    v_mfma_f32_16x16x32_bf16 v[208:211], a[136:139], v[196:199], v[208:211]
    v_mfma_f32_16x16x32_bf16 v[208:211], a[140:143], v[196:199], v[208:211]
    v_mfma_f32_16x16x32_bf16 v[208:211], a[144:147], v[196:199], v[208:211]
    v_mfma_f32_16x16x32_bf16 v[208:211], a[148:151], v[196:199], v[208:211]
    v_mfma_f32_16x16x32_bf16 v[208:211], a[152:155], v[196:199], v[208:211]
    v_mfma_f32_16x16x32_bf16 v[208:211], a[156:159], v[196:199], v[208:211]
    v_mfma_f32_16x16x32_bf16 v[208:211], a[160:163], v[196:199], v[208:211]
    v_mfma_f32_16x16x32_bf16 v[208:211], a[164:167], v[196:199], v[208:211]
    v_mfma_f32_16x16x32_bf16 v[212:215], a[168:171], v[196:199], 0
    v_mfma_f32_16x16x32_bf16 v[212:215], a[172:175], v[196:199], v[212:215]
    v_mfma_f32_16x16x32_bf16 v[212:215], a[176:179], v[196:199], v[212:215]
    v_mfma_f32_16x16x32_bf16 v[212:215], a[180:183], v[196:199], v[212:215]
    v_mfma_f32_16x16x32_bf16 v[212:215], a[184:187], v[196:199], v[212:215]
    v_mfma_f32_16x16x32_bf16 v[212:215], a[188:191], v[196:199], v[212:215]
    v_mfma_f32_16x16x32_bf16 v[212:215], a[192:195], v[196:199], v[212:215]
    v_mfma_f32_16x16x32_bf16 v[212:215], a[196:199], v[196:199], v[212:215]
    v_mfma_f32_16x16x32_bf16 v[212:215], a[200:203], v[196:199], v[212:215]
    v_mfma_f32_16x16x32_bf16 v[212:215], a[204:207], v[196:199], v[212:215]
    v_mfma_f32_16x16x32_bf16 v[212:215], a[208:211], v[196:199], v[212:215]
    v_mfma_f32_16x16x32_bf16 v[212:215], a[212:215], v[196:199], v[212:215]
    v_mfma_f32_16x16x32_bf16 v[212:215], a[216:219], v[196:199], v[212:215]
    v_mfma_f32_16x16x32_bf16 v[212:215], a[220:223], v[196:199], v[212:215]
W_ffn1:
    s_mov_b32 s30, s73
    s_lshl_b32 s77, s30, 6
    s_add_u32 s77, s77, 16384
    s_cmp_eq_u32 s3, 0
    s_cbranch_scc0 Lwf_93_s
    v_lshlrev_b32 v6, 2, v0
    v_min_u32 v6, 60, v6
    v_and_b32 v7, 28, v6
    v_cmp_eq_u32 vcc, 28, v7
    v_subrev_u32 v7, 4, v6
    s_nop 0
    v_cndmask_b32 v6, v6, v7, vcc
Lwf_93:
    buffer_load_dword v7, v6, s[8:11], s77 offen sc1
    s_waitcnt vmcnt(0)
    v_cmp_eq_u32 vcc, 0, v7
    s_cbranch_vccz Lwf_93_s
    s_sleep 1
    s_sub_u32 s76, s76, 1
    s_cbranch_scc0 Lwf_93
    s_branch L_exit
Lwf_93_s:
    s_barrier
    s_lshl_b32 s35, s30, 2
    s_add_u32 s35, s35, s3
    s_mul_i32 s36, s35, 14336
    s_add_u32 s36, s36, 3145728
    s_add_u32 s37, s36, 0
    buffer_load_dwordx4 v[16:19], v1, s[8:11], s37 offen offset:0 sc1
    s_add_u32 s37, s36, 0
    buffer_load_dwordx4 v[20:23], v1, s[8:11], s37 offen offset:1024 sc1
    s_add_u32 s37, s36, 0
    buffer_load_dwordx4 v[24:27], v1, s[8:11], s37 offen offset:2048 sc1
    s_add_u32 s37, s36, 0
    buffer_load_dwordx4 v[28:31], v1, s[8:11], s37 offen offset:3072 sc1
    s_add_u32 s37, s36, 4096
    buffer_load_dwordx4 v[32:35], v1, s[8:11], s37 offen offset:0 sc1
    s_add_u32 s37, s36, 4096
    buffer_load_dwordx4 v[36:39], v1, s[8:11], s37 offen offset:1024 sc1
    s_add_u32 s37, s36, 4096
    buffer_load_dwordx4 v[40:43], v1, s[8:11], s37 offen offset:2048 sc1
    s_add_u32 s37, s36, 4096
    buffer_load_dwordx4 v[44:47], v1, s[8:11], s37 offen offset:3072 sc1
    s_add_u32 s37, s36, 8192
    buffer_load_dwordx4 v[48:51], v1, s[8:11], s37 offen offset:0 sc1
    s_add_u32 s37, s36, 8192
    buffer_load_dwordx4 v[52:55], v1, s[8:11], s37 offen offset:1024 sc1
    s_add_u32 s37, s36, 8192
    buffer_load_dwordx4 v[56:59], v1, s[8:11], s37 offen offset:2048 sc1
    s_add_u32 s37, s36, 8192
    buffer_load_dwordx4 v[60:63], v1, s[8:11], s37 offen offset:3072 sc1
    s_add_u32 s37, s36, 12288
    buffer_load_dwordx4 v[64:67], v1, s[8:11], s37 offen offset:0 sc1
    s_add_u32 s37, s36, 12288
    buffer_load_dwordx4 v[68:71], v1, s[8:11], s37 offen offset:1024 sc1
    s_mov_b32 s38, 0x3727c5ac
    s_mov_b32 s39, 0x3b124925
    s_mov_b32 s40, 0x3fb8aa3b
    s_mul_i32 s41, s35, 56
    s_add_u32 s41, s41, s31
    s_lshl_b32 s41, s41, 10
    s_add_u32 s41, s41, 117440512
    s_waitcnt vmcnt(13)
    v_mfma_f32_16x16x32_bf16 v[128:131], a[0:3], v[16:19], 0
    v_mfma_f32_16x16x32_bf16 v[132:135], a[56:59], v[16:19], 0
    v_mfma_f32_16x16x32_bf16 v[136:139], a[112:115], v[16:19], 0
    v_mfma_f32_16x16x32_bf16 v[140:143], a[168:171], v[16:19], 0
    v_mfma_f32_16x16x32_bf16 v[160:163], v[196:199], v[16:19], 0
    v_mfma_f32_16x16x32_bf16 v[168:171], v[16:19], v[16:19], 0
    s_waitcnt vmcnt(12)
    v_mfma_f32_16x16x32_bf16 v[128:131], a[4:7], v[20:23], v[128:131]
    v_mfma_f32_16x16x32_bf16 v[132:135], a[60:63], v[20:23], v[132:135]
    v_mfma_f32_16x16x32_bf16 v[136:139], a[116:119], v[20:23], v[136:139]
    v_mfma_f32_16x16x32_bf16 v[140:143], a[172:175], v[20:23], v[140:143]
    v_mfma_f32_16x16x32_bf16 v[160:163], v[196:199], v[20:23], v[160:163]
    v_mfma_f32_16x16x32_bf16 v[168:171], v[20:23], v[20:23], v[168:171]
    s_waitcnt vmcnt(11)
    v_mfma_f32_16x16x32_bf16 v[128:131], a[8:11], v[24:27], v[128:131]
    v_mfma_f32_16x16x32_bf16 v[132:135], a[64:67], v[24:27], v[132:135]
    v_mfma_f32_16x16x32_bf16 v[136:139], a[120:123], v[24:27], v[136:139]
    v_mfma_f32_16x16x32_bf16 v[140:143], a[176:179], v[24:27], v[140:143]
    v_mfma_f32_16x16x32_bf16 v[160:163], v[196:199], v[24:27], v[160:163]
    v_mfma_f32_16x16x32_bf16 v[168:171], v[24:27], v[24:27], v[168:171]
    s_waitcnt vmcnt(10)
    v_mfma_f32_16x16x32_bf16 v[128:131], a[12:15], v[28:31], v[128:131]
    v_mfma_f32_16x16x32_bf16 v[132:135], a[68:71], v[28:31], v[132:135]
    v_mfma_f32_16x16x32_bf16 v[136:139], a[124:127], v[28:31], v[136:139]
    v_mfma_f32_16x16x32_bf16 v[140:143], a[180:183], v[28:31], v[140:143]
    v_mfma_f32_16x16x32_bf16 v[160:163], v[196:199], v[28:31], v[160:163]
    v_mfma_f32_16x16x32_bf16 v[168:171], v[28:31], v[28:31], v[168:171]
    s_waitcnt vmcnt(9)
    v_mfma_f32_16x16x32_bf16 v[128:131], a[16:19], v[32:35], v[128:131]
    v_mfma_f32_16x16x32_bf16 v[132:135], a[72:75], v[32:35], v[132:135]
    v_mfma_f32_16x16x32_bf16 v[136:139], a[128:131], v[32:35], v[136:139]
    v_mfma_f32_16x16x32_bf16 v[140:143], a[184:187], v[32:35], v[140:143]
    v_mfma_f32_16x16x32_bf16 v[160:163], v[196:199], v[32:35], v[160:163]
    v_mfma_f32_16x16x32_bf16 v[168:171], v[32:35], v[32:35], v[168:171]
    s_waitcnt vmcnt(8)
    v_mfma_f32_16x16x32_bf16 v[128:131], a[20:23], v[36:39], v[128:131]
    v_mfma_f32_16x16x32_bf16 v[132:135], a[76:79], v[36:39], v[132:135]
    v_mfma_f32_16x16x32_bf16 v[136:139], a[132:135], v[36:39], v[136:139]
    v_mfma_f32_16x16x32_bf16 v[140:143], a[188:191], v[36:39], v[140:143]
    v_mfma_f32_16x16x32_bf16 v[160:163], v[196:199], v[36:39], v[160:163]
    v_mfma_f32_16x16x32_bf16 v[168:171], v[36:39], v[36:39], v[168:171]
    s_waitcnt vmcnt(7)
    v_mfma_f32_16x16x32_bf16 v[128:131], a[24:27], v[40:43], v[128:131]
    v_mfma_f32_16x16x32_bf16 v[132:135], a[80:83], v[40:43], v[132:135]
    v_mfma_f32_16x16x32_bf16 v[136:139], a[136:139], v[40:43], v[136:139]
    v_mfma_f32_16x16x32_bf16 v[140:143], a[192:195], v[40:43], v[140:143]
    v_mfma_f32_16x16x32_bf16 v[160:163], v[196:199], v[40:43], v[160:163]
    v_mfma_f32_16x16x32_bf16 v[168:171], v[40:43], v[40:43], v[168:171]
    s_waitcnt vmcnt(6)
    v_mfma_f32_16x16x32_bf16 v[128:131], a[28:31], v[44:47], v[128:131]
    v_mfma_f32_16x16x32_bf16 v[132:135], a[84:87], v[44:47], v[132:135]
    v_mfma_f32_16x16x32_bf16 v[136:139], a[140:143], v[44:47], v[136:139]
    v_mfma_f32_16x16x32_bf16 v[140:143], a[196:199], v[44:47], v[140:143]
    v_mfma_f32_16x16x32_bf16 v[160:163], v[196:199], v[44:47], v[160:163]
    v_mfma_f32_16x16x32_bf16 v[168:171], v[44:47], v[44:47], v[168:171]
    s_waitcnt vmcnt(5)
    v_mfma_f32_16x16x32_bf16 v[128:131], a[32:35], v[48:51], v[128:131]
    v_mfma_f32_16x16x32_bf16 v[132:135], a[88:91], v[48:51], v[132:135]
    v_mfma_f32_16x16x32_bf16 v[136:139], a[144:147], v[48:51], v[136:139]
    v_mfma_f32_16x16x32_bf16 v[140:143], a[200:203], v[48:51], v[140:143]
    v_mfma_f32_16x16x32_bf16 v[160:163], v[196:199], v[48:51], v[160:163]
    v_mfma_f32_16x16x32_bf16 v[168:171], v[48:51], v[48:51], v[168:171]
    s_waitcnt vmcnt(4)
    v_mfma_f32_16x16x32_bf16 v[128:131], a[36:39], v[52:55], v[128:131]
    v_mfma_f32_16x16x32_bf16 v[132:135], a[92:95], v[52:55], v[132:135]
    v_mfma_f32_16x16x32_bf16 v[136:139], a[148:151], v[52:55], v[136:139]
    v_mfma_f32_16x16x32_bf16 v[140:143], a[204:207], v[52:55], v[140:143]
    v_mfma_f32_16x16x32_bf16 v[160:163], v[196:199], v[52:55], v[160:163]
    v_mfma_f32_16x16x32_bf16 v[168:171], v[52:55], v[52:55], v[168:171]
    s_waitcnt vmcnt(3)
    v_mfma_f32_16x16x32_bf16 v[128:131], a[40:43], v[56:59], v[128:131]
    v_mfma_f32_16x16x32_bf16 v[132:135], a[96:99], v[56:59], v[132:135]
    v_mfma_f32_16x16x32_bf16 v[136:139], a[152:155], v[56:59], v[136:139]
    v_mfma_f32_16x16x32_bf16 v[140:143], a[208:211], v[56:59], v[140:143]
    v_mfma_f32_16x16x32_bf16 v[160:163], v[196:199], v[56:59], v[160:163]
    v_mfma_f32_16x16x32_bf16 v[168:171], v[56:59], v[56:59], v[168:171]
    s_waitcnt vmcnt(2)
    v_mfma_f32_16x16x32_bf16 v[128:131], a[44:47], v[60:63], v[128:131]
    v_mfma_f32_16x16x32_bf16 v[132:135], a[100:103], v[60:63], v[132:135]
    v_mfma_f32_16x16x32_bf16 v[136:139], a[156:159], v[60:63], v[136:139]
    v_mfma_f32_16x16x32_bf16 v[140:143], a[212:215], v[60:63], v[140:143]
    v_mfma_f32_16x16x32_bf16 v[160:163], v[196:199], v[60:63], v[160:163]
    v_mfma_f32_16x16x32_bf16 v[168:171], v[60:63], v[60:63], v[168:171]
    s_waitcnt vmcnt(1)
    v_mfma_f32_16x16x32_bf16 v[128:131], a[48:51], v[64:67], v[128:131]
    v_mfma_f32_16x16x32_bf16 v[132:135], a[104:107], v[64:67], v[132:135]
    v_mfma_f32_16x16x32_bf16 v[136:139], a[160:163], v[64:67], v[136:139]
    v_mfma_f32_16x16x32_bf16 v[140:143], a[216:219], v[64:67], v[140:143]
    v_mfma_f32_16x16x32_bf16 v[160:163], v[196:199], v[64:67], v[160:163]
    v_mfma_f32_16x16x32_bf16 v[168:171], v[64:67], v[64:67], v[168:171]
    s_waitcnt vmcnt(0)
    v_mfma_f32_16x16x32_bf16 v[128:131], a[52:55], v[68:71], v[128:131]
    v_mfma_f32_16x16x32_bf16 v[132:135], a[108:111], v[68:71], v[132:135]
    v_mfma_f32_16x16x32_bf16 v[136:139], a[164:167], v[68:71], v[136:139]
    v_mfma_f32_16x16x32_bf16 v[140:143], a[220:223], v[68:71], v[140:143]
    v_mfma_f32_16x16x32_bf16 v[160:163], v[196:199], v[68:71], v[160:163]
    v_mfma_f32_16x16x32_bf16 v[168:171], v[68:71], v[68:71], v[168:171]
    v_mov_b32 v179, 0
    s_nop 6
    v_cndmask_b32 v180, v179, v168, s[60:61]
    v_cndmask_b32 v181, v179, v169, s[62:63]
    v_cndmask_b32 v182, v179, v170, s[64:65]
    v_cndmask_b32 v183, v179, v171, s[66:67]
    v_add_f32 v180, v180, v181
    v_add_f32 v182, v182, v183
    v_add_f32 v178, v180, v182
    v_mov_b32 v180, v178
    s_nop 1
    v_permlane16_swap_b32 v178, v180
    v_add_f32 v178, v178, v180
    v_mov_b32 v180, v178
    s_nop 1
    v_permlane32_swap_b32 v178, v180
    v_add_f32 v178, v178, v180
    v_mul_f32 v176, s39, v160
    v_mov_b32 v177, s38
    v_fmac_f32 v177, s39, v178
    v_fma_f32 v177, -v176, v176, v177
    v_max_f32 v177, s38, v177
    v_rsq_f32 v177, v177
    v_fma_f32 v128, -v176, v200, v128
    v_fma_f32 v129, -v176, v201, v129
    v_fma_f32 v130, -v176, v202, v130
    v_fma_f32 v131, -v176, v203, v131
    v_fma_f32 v132, -v176, v204, v132
    v_fma_f32 v133, -v176, v205, v133
    v_fma_f32 v134, -v176, v206, v134
    v_fma_f32 v135, -v176, v207, v135
    v_mul_f32 v128, v128, v177
    v_mul_f32 v129, v129, v177
    v_mul_f32 v130, v130, v177
    v_mul_f32 v131, v131, v177
    v_mul_f32 v132, v132, v177
    v_mul_f32 v133, v133, v177
    v_mul_f32 v134, v134, v177
    v_mul_f32 v135, v135, v177
    v_mul_f32 v184, s40, v128
    v_mul_f32 v185, s40, v129
    v_mul_f32 v186, s40, v130
    v_mul_f32 v187, s40, v131
    v_exp_f32 v184, -v184
    v_exp_f32 v185, -v185
    v_exp_f32 v186, -v186
    v_exp_f32 v187, -v187
    v_add_f32 v184, 1.0, v184
    v_add_f32 v185, 1.0, v185
    v_add_f32 v186, 1.0, v186
    v_add_f32 v187, 1.0, v187
    v_rcp_f32 v184, v184
    v_rcp_f32 v185, v185
    v_rcp_f32 v186, v186
    v_rcp_f32 v187, v187
    v_mul_f32 v128, v128, v132
    v_mul_f32 v129, v129, v133
    v_mul_f32 v130, v130, v134
    v_mul_f32 v131, v131, v135
    v_mul_f32 v128, v128, v184
    v_mul_f32 v129, v129, v185
    v_mul_f32 v130, v130, v186
    v_mul_f32 v131, v131, v187
    v_cvt_pk_bf16_f32 v188, v128, v129
    v_cvt_pk_bf16_f32 v189, v130, v131
    v_fma_f32 v136, -v176, v208, v136
    v_fma_f32 v137, -v176, v209, v137
    v_fma_f32 v138, -v176, v210, v138
    v_fma_f32 v139, -v176, v211, v139
    v_fma_f32 v140, -v176, v212, v140
    v_fma_f32 v141, -v176, v213, v141
    v_fma_f32 v142, -v176, v214, v142
    v_fma_f32 v143, -v176, v215, v143
    v_mul_f32 v136, v136, v177
    v_mul_f32 v137, v137, v177
    v_mul_f32 v138, v138, v177
    v_mul_f32 v139, v139, v177
    v_mul_f32 v140, v140, v177
    v_mul_f32 v141, v141, v177
    v_mul_f32 v142, v142, v177
    v_mul_f32 v143, v143, v177
    v_mul_f32 v184, s40, v136
    v_mul_f32 v185, s40, v137
    v_mul_f32 v186, s40, v138
    v_mul_f32 v187, s40, v139
    v_exp_f32 v184, -v184
    v_exp_f32 v185, -v185
    v_exp_f32 v186, -v186
    v_exp_f32 v187, -v187
    v_add_f32 v184, 1.0, v184
    v_add_f32 v185, 1.0, v185
    v_add_f32 v186, 1.0, v186
    v_add_f32 v187, 1.0, v187
    v_rcp_f32 v184, v184
    v_rcp_f32 v185, v185
    v_rcp_f32 v186, v186
    v_rcp_f32 v187, v187
    v_mul_f32 v136, v136, v140
    v_mul_f32 v137, v137, v141
    v_mul_f32 v138, v138, v142
    v_mul_f32 v139, v139, v143
    v_mul_f32 v136, v136, v184
    v_mul_f32 v137, v137, v185
    v_mul_f32 v138, v138, v186
    v_mul_f32 v139, v139, v187
    v_cvt_pk_bf16_f32 v190, v136, v137
    v_cvt_pk_bf16_f32 v191, v138, v139
    s_add_u32 s42, s41, 0
    buffer_store_dwordx4 v[188:191], v1, s[8:11], s42 offen sc1
    s_lshl_b32 s77, s30, 8
    s_add_u32 s77, s77, 32768
    s_lshl_b32 s78, s31, 2
    s_add_u32 s77, s77, s78
    s_waitcnt vmcnt(0)
    s_barrier
    s_cmp_eq_u32 s3, 0
    s_cbranch_scc0 Lsf_94
    v_mov_b32 v6, 0
    v_mov_b32 v7, 1
    s_mov_b64 exec, 1
    buffer_store_dword v7, v6, s[8:11], s77 offen sc1
    s_mov_b64 exec, -1
Lsf_94:
    s_add_u32 s73, s73, 1
    s_cmp_lt_u32 s73, 32
    s_cbranch_scc0 L_exit
    s_barrier
    s_branch W_ffn1
W_ffn20:
    s_sub_u32 s29, s72, 156
    s_mul_hi_u32 s28, s29, 306783379
    s_mul_i32 s31, s28, 14
    s_sub_u32 s31, s29, s31
    s_mov_b32 s77, 3072
    s_cmp_eq_u32 s3, 0
    s_cbranch_scc0 Lwc_95_s
    v_mov_b32 v6, 0
Lwc_95:
    buffer_load_dword v7, v6, s[8:11], s77 offen sc1
    s_waitcnt vmcnt(0)
    v_readfirstlane_b32 s78, v7
    s_cmp_ge_u32 s78, 224
    s_cbranch_scc1 Lwc_95_s
    s_sleep 2
    s_sub_u32 s76, s76, 1
    s_cbranch_scc0 Lwc_95
    s_branch L_exit
Lwc_95_s:
    s_barrier
    v_lshlrev_b32 v1, 4, v0
    s_lshl_b32 s32, s31, 1
    s_mul_i32 s32, s32, 56
    s_mul_i32 s33, s3, 14
    s_add_u32 s32, s32, s33
    s_lshl_b32 s32, s32, 10
    s_add_u32 s32, s32, 29360128
    s_add_u32 s34, s32, 0
    buffer_load_dwordx4 a[0:3], v1, s[8:11], s34 offen offset:0 sc1
    buffer_load_dwordx4 a[4:7], v1, s[8:11], s34 offen offset:1024 sc1
    buffer_load_dwordx4 a[8:11], v1, s[8:11], s34 offen offset:2048 sc1
    buffer_load_dwordx4 a[12:15], v1, s[8:11], s34 offen offset:3072 sc1
    s_add_u32 s34, s32, 4096
    buffer_load_dwordx4 a[16:19], v1, s[8:11], s34 offen offset:0 sc1
    buffer_load_dwordx4 a[20:23], v1, s[8:11], s34 offen offset:1024 sc1
    buffer_load_dwordx4 a[24:27], v1, s[8:11], s34 offen offset:2048 sc1
    buffer_load_dwordx4 a[28:31], v1, s[8:11], s34 offen offset:3072 sc1
    s_add_u32 s34, s32, 8192
    buffer_load_dwordx4 a[32:35], v1, s[8:11], s34 offen offset:0 sc1
    buffer_load_dwordx4 a[36:39], v1, s[8:11], s34 offen offset:1024 sc1
    buffer_load_dwordx4 a[40:43], v1, s[8:11], s34 offen offset:2048 sc1
    buffer_load_dwordx4 a[44:47], v1, s[8:11], s34 offen offset:3072 sc1
    s_add_u32 s34, s32, 12288
    buffer_load_dwordx4 a[48:51], v1, s[8:11], s34 offen offset:0 sc1
    buffer_load_dwordx4 a[52:55], v1, s[8:11], s34 offen offset:1024 sc1
    s_add_u32 s34, s32, 57344
    buffer_load_dwordx4 a[56:59], v1, s[8:11], s34 offen offset:0 sc1
    buffer_load_dwordx4 a[60:63], v1, s[8:11], s34 offen offset:1024 sc1
    buffer_load_dwordx4 a[64:67], v1, s[8:11], s34 offen offset:2048 sc1
    buffer_load_dwordx4 a[68:71], v1, s[8:11], s34 offen offset:3072 sc1
    s_add_u32 s34, s32, 61440
    buffer_load_dwordx4 a[72:75], v1, s[8:11], s34 offen offset:0 sc1
    buffer_load_dwordx4 a[76:79], v1, s[8:11], s34 offen offset:1024 sc1
    buffer_load_dwordx4 a[80:83], v1, s[8:11], s34 offen offset:2048 sc1
    buffer_load_dwordx4 a[84:87], v1, s[8:11], s34 offen offset:3072 sc1
    s_add_u32 s34, s32, 65536
    buffer_load_dwordx4 a[88:91], v1, s[8:11], s34 offen offset:0 sc1
    buffer_load_dwordx4 a[92:95], v1, s[8:11], s34 offen offset:1024 sc1
    buffer_load_dwordx4 a[96:99], v1, s[8:11], s34 offen offset:2048 sc1
    buffer_load_dwordx4 a[100:103], v1, s[8:11], s34 offen offset:3072 sc1
    s_add_u32 s34, s32, 69632
    buffer_load_dwordx4 a[104:107], v1, s[8:11], s34 offen offset:0 sc1
    buffer_load_dwordx4 a[108:111], v1, s[8:11], s34 offen offset:1024 sc1
W_ffn2:
    s_lshl_b32 s30, s73, 2
    s_add_u32 s30, s30, s28
    s_lshr_b32 s77, s30, 1
    s_lshl_b32 s77, s77, 8
    s_add_u32 s77, s77, 32768
    s_cmp_eq_u32 s3, 0
    s_cbranch_scc0 Lwf_96_s
    v_lshlrev_b32 v6, 2, v0
    v_min_u32 v6, 220, v6
Lwf_96:
    buffer_load_dword v7, v6, s[8:11], s77 offen sc1
    s_waitcnt vmcnt(0)
    v_cmp_eq_u32 vcc, 0, v7
    s_cbranch_vccz Lwf_96_s
    s_sleep 1
    s_sub_u32 s76, s76, 1
    s_cbranch_scc0 Lwf_96
    s_branch L_exit
Lwf_96_s:
    s_barrier
    s_waitcnt vmcnt(0)
    s_lshl_b32 s35, s30, 1
    s_mul_i32 s35, s35, 56
    s_add_u32 s35, s35, s33
    s_lshl_b32 s35, s35, 10
    s_add_u32 s35, s35, 117440512
    s_add_u32 s34, s35, 0
    buffer_load_dwordx4 v[16:19], v1, s[8:11], s34 offen sc1
    s_add_u32 s34, s35, 57344
    buffer_load_dwordx4 v[72:75], v1, s[8:11], s34 offen sc1
    s_add_u32 s34, s35, 1024
    buffer_load_dwordx4 v[20:23], v1, s[8:11], s34 offen sc1
    s_add_u32 s34, s35, 58368
    buffer_load_dwordx4 v[76:79], v1, s[8:11], s34 offen sc1
    s_add_u32 s34, s35, 2048
    buffer_load_dwordx4 v[24:27], v1, s[8:11], s34 offen sc1
    s_add_u32 s34, s35, 59392
    buffer_load_dwordx4 v[80:83], v1, s[8:11], s34 offen sc1
    s_add_u32 s34, s35, 3072
    buffer_load_dwordx4 v[28:31], v1, s[8:11], s34 offen sc1
    s_add_u32 s34, s35, 60416
    buffer_load_dwordx4 v[84:87], v1, s[8:11], s34 offen sc1
    s_add_u32 s34, s35, 4096
    buffer_load_dwordx4 v[32:35], v1, s[8:11], s34 offen sc1
    s_add_u32 s34, s35, 61440
    buffer_load_dwordx4 v[88:91], v1, s[8:11], s34 offen sc1
    s_add_u32 s34, s35, 5120
    buffer_load_dwordx4 v[36:39], v1, s[8:11], s34 offen sc1
    s_add_u32 s34, s35, 62464
    buffer_load_dwordx4 v[92:95], v1, s[8:11], s34 offen sc1
    s_add_u32 s34, s35, 6144
    buffer_load_dwordx4 v[40:43], v1, s[8:11], s34 offen sc1
    s_add_u32 s34, s35, 63488
    buffer_load_dwordx4 v[96:99], v1, s[8:11], s34 offen sc1
    s_add_u32 s34, s35, 7168
    buffer_load_dwordx4 v[44:47], v1, s[8:11], s34 offen sc1
    s_add_u32 s34, s35, 64512
    buffer_load_dwordx4 v[100:103], v1, s[8:11], s34 offen sc1
    s_add_u32 s34, s35, 8192
    buffer_load_dwordx4 v[48:51], v1, s[8:11], s34 offen sc1
    s_add_u32 s34, s35, 65536
    buffer_load_dwordx4 v[104:107], v1, s[8:11], s34 offen sc1
    s_add_u32 s34, s35, 9216
    buffer_load_dwordx4 v[52:55], v1, s[8:11], s34 offen sc1
    s_add_u32 s34, s35, 66560
    buffer_load_dwordx4 v[108:111], v1, s[8:11], s34 offen sc1
    s_add_u32 s34, s35, 10240
    buffer_load_dwordx4 v[56:59], v1, s[8:11], s34 offen sc1
    s_add_u32 s34, s35, 67584
    buffer_load_dwordx4 v[112:115], v1, s[8:11], s34 offen sc1
    s_add_u32 s34, s35, 11264
    buffer_load_dwordx4 v[60:63], v1, s[8:11], s34 offen sc1
    s_add_u32 s34, s35, 68608
    buffer_load_dwordx4 v[116:119], v1, s[8:11], s34 offen sc1
    s_add_u32 s34, s35, 12288
    buffer_load_dwordx4 v[64:67], v1, s[8:11], s34 offen sc1
    s_add_u32 s34, s35, 69632
    buffer_load_dwordx4 v[120:123], v1, s[8:11], s34 offen sc1
    s_add_u32 s34, s35, 13312
    buffer_load_dwordx4 v[68:71], v1, s[8:11], s34 offen sc1
    s_add_u32 s34, s35, 70656
    buffer_load_dwordx4 v[124:127], v1, s[8:11], s34 offen sc1
    s_lshr_b32 s36, s3, 1
    s_and_b32 s37, s3, 1
    s_lshl_b32 s38, s30, 1
    s_add_u32 s38, s38, s37
    s_mul_i32 s39, s38, 14
    s_add_u32 s39, s39, s31
    s_lshl_b32 s39, s39, 10
    s_lshl_b32 s40, s36, 3
    s_add_u32 s39, s39, s40
    s_add_u32 s39, s39, 3145728
    buffer_load_dwordx2 v[8:9], v1, s[8:11], s39 offen sc1
    s_waitcnt vmcnt(25)
    v_mfma_f32_16x16x32_bf16 v[128:131], a[0:3], v[16:19], 0
    v_mfma_f32_16x16x32_bf16 v[132:135], a[0:3], v[72:75], 0
    v_mfma_f32_16x16x32_bf16 v[136:139], a[56:59], v[16:19], 0
    v_mfma_f32_16x16x32_bf16 v[140:143], a[56:59], v[72:75], 0
    v_mfma_f32_16x16x32_bf16 v[128:131], a[4:7], v[20:23], v[128:131]
    v_mfma_f32_16x16x32_bf16 v[132:135], a[4:7], v[76:79], v[132:135]
    v_mfma_f32_16x16x32_bf16 v[136:139], a[60:63], v[20:23], v[136:139]
    v_mfma_f32_16x16x32_bf16 v[140:143], a[60:63], v[76:79], v[140:143]
    s_waitcnt vmcnt(21)
    v_mfma_f32_16x16x32_bf16 v[128:131], a[8:11], v[24:27], v[128:131]
    v_mfma_f32_16x16x32_bf16 v[132:135], a[8:11], v[80:83], v[132:135]
    v_mfma_f32_16x16x32_bf16 v[136:139], a[64:67], v[24:27], v[136:139]
    v_mfma_f32_16x16x32_bf16 v[140:143], a[64:67], v[80:83], v[140:143]
    v_mfma_f32_16x16x32_bf16 v[128:131], a[12:15], v[28:31], v[128:131]
    v_mfma_f32_16x16x32_bf16 v[132:135], a[12:15], v[84:87], v[132:135]
    v_mfma_f32_16x16x32_bf16 v[136:139], a[68:71], v[28:31], v[136:139]
    v_mfma_f32_16x16x32_bf16 v[140:143], a[68:71], v[84:87], v[140:143]
    s_waitcnt vmcnt(17)
    v_mfma_f32_16x16x32_bf16 v[128:131], a[16:19], v[32:35], v[128:131]
    v_mfma_f32_16x16x32_bf16 v[132:135], a[16:19], v[88:91], v[132:135]
    v_mfma_f32_16x16x32_bf16 v[136:139], a[72:75], v[32:35], v[136:139]
    v_mfma_f32_16x16x32_bf16 v[140:143], a[72:75], v[88:91], v[140:143]
    v_mfma_f32_16x16x32_bf16 v[128:131], a[20:23], v[36:39], v[128:131]
    v_mfma_f32_16x16x32_bf16 v[132:135], a[20:23], v[92:95], v[132:135]
    v_mfma_f32_16x16x32_bf16 v[136:139], a[76:79], v[36:39], v[136:139]
    v_mfma_f32_16x16x32_bf16 v[140:143], a[76:79], v[92:95], v[140:143]
    s_waitcnt vmcnt(13)
    v_mfma_f32_16x16x32_bf16 v[128:131], a[24:27], v[40:43], v[128:131]
    v_mfma_f32_16x16x32_bf16 v[132:135], a[24:27], v[96:99], v[132:135]
    v_mfma_f32_16x16x32_bf16 v[136:139], a[80:83], v[40:43], v[136:139]
    v_mfma_f32_16x16x32_bf16 v[140:143], a[80:83], v[96:99], v[140:143]
    v_mfma_f32_16x16x32_bf16 v[128:131], a[28:31], v[44:47], v[128:131]
    v_mfma_f32_16x16x32_bf16 v[132:135], a[28:31], v[100:103], v[132:135]
    v_mfma_f32_16x16x32_bf16 v[136:139], a[84:87], v[44:47], v[136:139]
    v_mfma_f32_16x16x32_bf16 v[140:143], a[84:87], v[100:103], v[140:143]
    s_waitcnt vmcnt(9)
    v_mfma_f32_16x16x32_bf16 v[128:131], a[32:35], v[48:51], v[128:131]
    v_mfma_f32_16x16x32_bf16 v[132:135], a[32:35], v[104:107], v[132:135]
    v_mfma_f32_16x16x32_bf16 v[136:139], a[88:91], v[48:51], v[136:139]
    v_mfma_f32_16x16x32_bf16 v[140:143], a[88:91], v[104:107], v[140:143]
    v_mfma_f32_16x16x32_bf16 v[128:131], a[36:39], v[52:55], v[128:131]
    v_mfma_f32_16x16x32_bf16 v[132:135], a[36:39], v[108:111], v[132:135]
    v_mfma_f32_16x16x32_bf16 v[136:139], a[92:95], v[52:55], v[136:139]
    v_mfma_f32_16x16x32_bf16 v[140:143], a[92:95], v[108:111], v[140:143]
    s_waitcnt vmcnt(5)
    v_mfma_f32_16x16x32_bf16 v[128:131], a[40:43], v[56:59], v[128:131]
    v_mfma_f32_16x16x32_bf16 v[132:135], a[40:43], v[112:115], v[132:135]
    v_mfma_f32_16x16x32_bf16 v[136:139], a[96:99], v[56:59], v[136:139]
    v_mfma_f32_16x16x32_bf16 v[140:143], a[96:99], v[112:115], v[140:143]
    v_mfma_f32_16x16x32_bf16 v[128:131], a[44:47], v[60:63], v[128:131]
    v_mfma_f32_16x16x32_bf16 v[132:135], a[44:47], v[116:119], v[132:135]
    v_mfma_f32_16x16x32_bf16 v[136:139], a[100:103], v[60:63], v[136:139]
    v_mfma_f32_16x16x32_bf16 v[140:143], a[100:103], v[116:119], v[140:143]
    s_waitcnt vmcnt(1)
    v_mfma_f32_16x16x32_bf16 v[128:131], a[48:51], v[64:67], v[128:131]
    v_mfma_f32_16x16x32_bf16 v[132:135], a[48:51], v[120:123], v[132:135]
    v_mfma_f32_16x16x32_bf16 v[136:139], a[104:107], v[64:67], v[136:139]
    v_mfma_f32_16x16x32_bf16 v[140:143], a[104:107], v[120:123], v[140:143]
    v_mfma_f32_16x16x32_bf16 v[128:131], a[52:55], v[68:71], v[128:131]
    v_mfma_f32_16x16x32_bf16 v[132:135], a[52:55], v[124:127], v[132:135]
    v_mfma_f32_16x16x32_bf16 v[136:139], a[108:111], v[68:71], v[136:139]
    v_mfma_f32_16x16x32_bf16 v[140:143], a[108:111], v[124:127], v[140:143]
    s_lshl_b32 s40, s3, 12
    v_add_u32 v2, s40, v1
    ds_write_b128 v2, v[128:131] offset:0
    ds_write_b128 v2, v[132:135] offset:1024
    ds_write_b128 v2, v[136:139] offset:2048
    s_nop 2
    ds_write_b128 v2, v[140:143] offset:3072
    s_waitcnt lgkmcnt(0)
    s_barrier
    s_lshl_b32 s40, s3, 10
    v_add_u32 v2, s40, v1
    ds_read_b128 v[148:151], v2 offset:0
    ds_read_b128 v[152:155], v2 offset:4096
    ds_read_b128 v[156:159], v2 offset:8192
    ds_read_b128 v[160:163], v2 offset:12288
    v_and_b32 v4, 15, v0
    v_lshrrev_b32 v5, 4, v0
    s_lshl_b32 s40, s38, 4
    v_add_u32 v4, s40, v4
    v_mul_u32_u24 v4, 896, v4
    v_lshl_add_u32 v4, v5, 3, v4
    s_lshl_b32 s40, s31, 1
    s_add_u32 s40, s40, s36
    s_lshl_b32 s40, s40, 5
    s_waitcnt lgkmcnt(0) vmcnt(0)
    v_add_f32 v148, v148, v152
    v_add_f32 v156, v156, v160
    v_add_f32 v149, v149, v153
    v_add_f32 v157, v157, v161
    v_add_f32 v150, v150, v154
    v_add_f32 v158, v158, v162
    v_add_f32 v151, v151, v155
    v_add_f32 v159, v159, v163
    v_add_f32 v148, v148, v156
    v_add_f32 v149, v149, v157
    v_add_f32 v150, v150, v158
    v_add_f32 v151, v151, v159
    v_lshlrev_b32 v152, 16, v8
    v_and_b32 v153, 0xffff0000, v8
    v_add_f32 v148, v148, v152
    v_add_f32 v149, v149, v153
    v_cvt_pk_bf16_f32 v154, v148, v149
    v_lshlrev_b32 v152, 16, v9
    v_and_b32 v153, 0xffff0000, v9
    v_add_f32 v150, v150, v152
    v_add_f32 v151, v151, v153
    v_cvt_pk_bf16_f32 v155, v150, v151
    buffer_store_dwordx2 v[154:155], v4, s[24:27], s40 offen sc1
    s_waitcnt vmcnt(0)
    s_add_u32 s73, s73, 1
    s_cmp_lt_u32 s73, 16
    s_cbranch_scc0 L_exit
    s_barrier
    s_branch W_ffn2
L_exit:
    s_waitcnt vmcnt(0) lgkmcnt(0)
L_exit0:
    s_endpgm

.section .rodata,"a"
.p2align 6
.amdhsa_kernel sequential_preLN__memory_aug_recurrent_mem_tr__swiglu_ffn__prompt_kernel
  .amdhsa_next_free_vgpr 512
  .amdhsa_next_free_sgpr 96
  .amdhsa_accum_offset 256
  .amdhsa_group_segment_fixed_size 0
  .amdhsa_kernarg_size 112
  .amdhsa_user_sgpr_count 2
  .amdhsa_user_sgpr_kernarg_segment_ptr 1
  .amdhsa_system_sgpr_workgroup_id_x 1
.end_amdhsa_kernel
```
